```python
import torch

def _softmax(x, axis=-1):
    return torch.softmax(x, dim=axis)
def _gelu(x):
    return torch.nn.functional.gelu(x, approximate="tanh")
def _silu(x):
    return torch.nn.functional.silu(x)
def _sigmoid(x):
    return torch.sigmoid(x)
def _layernorm(x, axis=-1, eps=1e-5):
    m = x.mean(dim=axis, keepdim=True)
    v = x.var(dim=axis, keepdim=True, unbiased=False)
    return (x - m) / torch.sqrt(v + eps)
def _scatter_add(tgt, idx, src, axis=0):
    return tgt.clone().index_add_(axis, idx, src)
def _segment_sum(src, seg, n):
    out = torch.zeros((n,) + src.shape[1:], dtype=src.dtype)
    return out.index_add_(0, seg, src)
def _pad(x, pw):
    flat = tuple(v for pair in reversed(pw) for v in pair)
    return torch.nn.functional.pad(x, flat)

kernel_name = 'standalone__modern_conv_block_replknet__vision'

def setup_inputs():

    _w = (lambda a: (lambda t: t.to(torch.bfloat16) if t.is_floating_point() else t)(torch.as_tensor(a)))
    H = W = 512
    C = 96
    K = 1
    return {
        "x": _w((lambda *s: torch.randn(*s, dtype=torch.bfloat16) * 0.05)(1, H, W, C)),
        "dw_large": _w((lambda *s: torch.randn(*s, dtype=torch.bfloat16) * 0.4)(K, K, C) * (1.0 / K)),
        "dw_small": _w((lambda *s: torch.randn(*s, dtype=torch.bfloat16) * 0.4)(5, 5, C) * 0.2),
        "w1": _w((lambda *s: torch.randn(*s, dtype=torch.bfloat16) * 0.4)(C, 4 * C) * (C ** -0.5)),
        "w2": _w((lambda *s: torch.randn(*s, dtype=torch.bfloat16) * 0.1)(4 * C, C) * ((4 * C) ** -0.5)),
    }

def reference(x, dw_large, dw_small, w1, w2):
    B, H, W, C = x.shape
    Kl = dw_large.shape[0]
    pl = (Kl - 1) // 2
    xpl = _pad(x, ((0,0),(pl,pl),(pl,pl),(0,0)))
    out = torch.zeros_like(x)
    for i in range(Kl):
        for j in range(Kl):
            out = out + xpl[:, i:i+H, j:j+W, :] * dw_large[i, j][None, None, None, :]
    Ks = dw_small.shape[0]
    ps = (Ks - 1) // 2
    xps = _pad(x, ((0,0),(ps,ps),(ps,ps),(0,0)))
    for i in range(Ks):
        for j in range(Ks):
            out = out + xps[:, i:i+H, j:j+W, :] * dw_small[i, j][None, None, None, :]
    h = _layernorm(out, axis=-1)
    h = _gelu(torch.einsum('bhwc,ce->bhwe', h, w1))
    h = torch.einsum('bhwe,ec->bhwc', h, w2)
    return x + h
```

```asm
; @launch grid=(256,1,1) block=(512,1,1) lds=163840
.amdgcn_target "amdgcn-amd-amdhsa--gfx950"
.text
.globl standalone__modern_conv_block_replknet__vision_kernel
.p2align 8
.type standalone__modern_conv_block_replknet__vision_kernel,@function
standalone__modern_conv_block_replknet__vision_kernel:
    s_cmp_ge_u32 s2, 256
    s_cbranch_scc1 L_exit
    s_load_dwordx4 s[60:63], s[0:1], 0
    s_load_dwordx4 s[64:67], s[0:1], 16
    s_load_dwordx4 s[68:71], s[0:1], 32
    s_load_dwordx2 s[48:49], s[0:1], 56
    s_getpc_b64 s[74:75]
L_pc:
    v_lshlrev_b32 v2, 7, v0
    v_min_u32 v2, L_exit-L_pc, v2
    v_mov_b32 v3, s75
    v_add_co_u32 v2, vcc, s74, v2
    s_nop 1
    v_addc_co_u32 v3, vcc, 0, v3, vcc
    global_load_dword v239, v[2:3], off
    s_mov_b32 s19, 0
L_restart:
    v_lshrrev_b32 v1, 6, v0
    v_and_b32 v0, 63, v0
    v_readfirstlane_b32 s24, v1
    s_and_b32 s72, s2, 7
    s_lshr_b32 s73, s2, 3
    s_lshl_b32 s73, s73, 4
    s_lshl_b32 s72, s72, 6
    s_mul_i32 s22, s72, 98304
    s_sub_u32 s78, s73, 2
    s_sub_u32 s16, s22, 196608
    v_lshrrev_b32 v1, 1, v0
    v_mul_u32_u24 v1, 192, v1
    v_and_b32 v2, 1, v0
    v_lshl_add_u32 v242, v2, 4, v1
    s_cmp_lt_u32 s24, 4
    s_cbranch_scc1 L_roleX
    s_lshr_b32 s74, s2, 3
    s_add_u32 s74, s74, s24
    s_and_b32 s74, s74, 3
    s_mul_i32 s74, s74, 6144
    s_add_u32 s77, s74, 77056
    v_add_u32 v1, 0, v0
    v_mul_u32_u24 v2, 171, v1
    v_lshrrev_b32 v2, 11, v2
    v_lshrrev_b32 v2, 2, v2
    v_sub_u32 v2, 0, v2
    v_and_b32 v2, 3, v2
    v_xor_b32 v1, v1, v2
    v_lshlrev_b32 v244, 4, v1
    v_add_u32 v1, 64, v0
    v_mul_u32_u24 v2, 171, v1
    v_lshrrev_b32 v2, 11, v2
    v_lshrrev_b32 v2, 2, v2
    v_sub_u32 v2, 0, v2
    v_and_b32 v2, 3, v2
    v_xor_b32 v1, v1, v2
    v_lshlrev_b32 v245, 4, v1
    v_add_u32 v1, 128, v0
    v_mul_u32_u24 v2, 171, v1
    v_lshrrev_b32 v2, 11, v2
    v_lshrrev_b32 v2, 2, v2
    v_sub_u32 v2, 0, v2
    v_and_b32 v2, 3, v2
    v_xor_b32 v1, v1, v2
    v_lshlrev_b32 v246, 4, v1
    s_waitcnt lgkmcnt(0)
    s_mov_b32 s4, s68
    s_and_b32 s5, s69, 0xffff
    s_mov_b32 s6, 73728
    s_mov_b32 s7, 0x20000
    s_mov_b32 s12, s64
    s_and_b32 s13, s65, 0xffff
    s_mov_b32 s14, 4800
    s_mov_b32 s15, 0x20000
    s_mul_i32 s75, s24, 24
    s_lshl_b32 s76, s24, 10
    s_add_u32 s76, s76, 150784
    s_mov_b32 m0, s76
    s_bfm_b64 exec, 50, 0
    buffer_load_dwordx4 v242, s[12:15], s75 offen offset:0 lds
    s_mov_b32 s12, s62
    s_and_b32 s13, s63, 0xffff
    s_mov_b32 s14, 192
    s_add_u32 m0, s76, 800
    s_mov_b64 exec, 3
    buffer_load_dwordx4 v242, s[12:15], s75 offen offset:0 lds
    s_mov_b64 exec, -1
    s_lshr_b32 s53, s2, 5
    s_cmp_ge_u32 s53, 6
    s_cselect_b32 s54, 6, 0
    s_sub_u32 s53, s53, s54
    s_lshr_b32 s54, s53, 1
    s_mul_i32 s54, s54, 18432
    s_mul_i32 s55, s53, 3072
    s_add_u32 s54, s54, s55
    s_add_u32 s31, s74, s54
    s_add_u32 s54, s77, s54
    s_add_u32 m0, s54, 0
    s_nop 0
    buffer_load_dwordx4 v244, s[4:7], s31 offen offset:0 lds
    s_add_u32 m0, s54, 1024
    s_nop 0
    buffer_load_dwordx4 v245, s[4:7], s31 offen offset:0 lds
    s_add_u32 m0, s54, 2048
    s_nop 0
    buffer_load_dwordx4 v246, s[4:7], s31 offen offset:0 lds
    s_add_u32 s53, s53, 1
    s_cmp_ge_u32 s53, 6
    s_cselect_b32 s54, 6, 0
    s_sub_u32 s53, s53, s54
    s_lshr_b32 s54, s53, 1
    s_mul_i32 s54, s54, 18432
    s_mul_i32 s55, s53, 3072
    s_add_u32 s54, s54, s55
    s_add_u32 s31, s74, s54
    s_add_u32 s54, s77, s54
    s_add_u32 m0, s54, 0
    s_nop 0
    buffer_load_dwordx4 v244, s[4:7], s31 offen offset:0 lds
    s_add_u32 m0, s54, 1024
    s_nop 0
    buffer_load_dwordx4 v245, s[4:7], s31 offen offset:0 lds
    s_add_u32 m0, s54, 2048
    s_nop 0
    buffer_load_dwordx4 v246, s[4:7], s31 offen offset:0 lds
    s_add_u32 s53, s53, 1
    s_cmp_ge_u32 s53, 6
    s_cselect_b32 s54, 6, 0
    s_sub_u32 s53, s53, s54
    s_lshr_b32 s54, s53, 1
    s_mul_i32 s54, s54, 18432
    s_mul_i32 s55, s53, 3072
    s_add_u32 s54, s54, s55
    s_add_u32 s31, s74, s54
    s_add_u32 s54, s77, s54
    s_add_u32 m0, s54, 0
    s_nop 0
    buffer_load_dwordx4 v244, s[4:7], s31 offen offset:0 lds
    s_add_u32 m0, s54, 1024
    s_nop 0
    buffer_load_dwordx4 v245, s[4:7], s31 offen offset:0 lds
    s_add_u32 m0, s54, 2048
    s_nop 0
    buffer_load_dwordx4 v246, s[4:7], s31 offen offset:0 lds
    s_add_u32 s53, s53, 1
    s_cmp_ge_u32 s53, 6
    s_cselect_b32 s54, 6, 0
    s_sub_u32 s53, s53, s54
    s_lshr_b32 s54, s53, 1
    s_mul_i32 s54, s54, 18432
    s_mul_i32 s55, s53, 3072
    s_add_u32 s54, s54, s55
    s_add_u32 s31, s74, s54
    s_add_u32 s54, s77, s54
    s_add_u32 m0, s54, 0
    s_nop 0
    buffer_load_dwordx4 v244, s[4:7], s31 offen offset:0 lds
    s_add_u32 m0, s54, 1024
    s_nop 0
    buffer_load_dwordx4 v245, s[4:7], s31 offen offset:0 lds
    s_add_u32 m0, s54, 2048
    s_nop 0
    buffer_load_dwordx4 v246, s[4:7], s31 offen offset:0 lds
    s_add_u32 s53, s53, 1
    s_cmp_ge_u32 s53, 6
    s_cselect_b32 s54, 6, 0
    s_sub_u32 s53, s53, s54
    s_lshr_b32 s54, s53, 1
    s_mul_i32 s54, s54, 18432
    s_mul_i32 s55, s53, 3072
    s_add_u32 s54, s54, s55
    s_add_u32 s31, s74, s54
    s_add_u32 s54, s77, s54
    s_add_u32 m0, s54, 0
    s_nop 0
    buffer_load_dwordx4 v244, s[4:7], s31 offen offset:0 lds
    s_add_u32 m0, s54, 1024
    s_nop 0
    buffer_load_dwordx4 v245, s[4:7], s31 offen offset:0 lds
    s_add_u32 m0, s54, 2048
    s_nop 0
    buffer_load_dwordx4 v246, s[4:7], s31 offen offset:0 lds
    s_add_u32 s53, s53, 1
    s_cmp_ge_u32 s53, 6
    s_cselect_b32 s54, 6, 0
    s_sub_u32 s53, s53, s54
    s_lshr_b32 s54, s53, 1
    s_mul_i32 s54, s54, 18432
    s_mul_i32 s55, s53, 3072
    s_add_u32 s54, s54, s55
    s_add_u32 s31, s74, s54
    s_add_u32 s54, s77, s54
    s_add_u32 m0, s54, 0
    s_nop 0
    buffer_load_dwordx4 v244, s[4:7], s31 offen offset:0 lds
    s_add_u32 m0, s54, 1024
    s_nop 0
    buffer_load_dwordx4 v245, s[4:7], s31 offen offset:0 lds
    s_add_u32 m0, s54, 2048
    s_nop 0
    buffer_load_dwordx4 v246, s[4:7], s31 offen offset:0 lds
    s_barrier
    s_mov_b32 s4, s60
    s_and_b32 s5, s61, 0xffff
    s_mov_b32 s6, 50331648
    s_mov_b32 s7, 0x20000
    s_add_u32 s79, s24, 0
    s_min_u32 s79, s79, 14
    s_lshl_b32 s40, s79, 10
    s_lshl_b32 s79, s79, 6
    v_add_u32 v1, s79, v0
    v_mul_u32_u24 v2, 2185, v1
    v_lshrrev_b32 v2, 19, v2
    v_mul_u32_u24 v240, 240, v2
    v_sub_u32 v1, v1, v240
    v_mul_u32_u24 v240, 171, v1
    v_lshrrev_b32 v240, 11, v240
    v_mul_u32_u24 v241, 12, v240
    v_sub_u32 v1, v1, v241
    v_bfrev_b32 v241, v240
    v_bfe_u32 v241, v241, 28, 2
    v_xor_b32 v1, v1, v241
    v_add_u32 v240, s78, v240
    v_cmp_gt_u32 vcc, 512, v240
    v_mul_u32_u24 v2, 98304, v2
    v_mul_u32_u24 v240, 192, v240
    v_lshl_add_u32 v1, v1, 4, v2
    v_add_u32 v1, v1, v240
    v_bfrev_b32 v2, 1
    v_cndmask_b32 v52, v2, v1, vcc
    s_add_u32 s79, s24, 8
    s_min_u32 s79, s79, 14
    s_lshl_b32 s41, s79, 10
    s_lshl_b32 s79, s79, 6
    v_add_u32 v1, s79, v0
    v_mul_u32_u24 v2, 2185, v1
    v_lshrrev_b32 v2, 19, v2
    v_mul_u32_u24 v240, 240, v2
    v_sub_u32 v1, v1, v240
    v_mul_u32_u24 v240, 171, v1
    v_lshrrev_b32 v240, 11, v240
    v_mul_u32_u24 v241, 12, v240
    v_sub_u32 v1, v1, v241
    v_bfrev_b32 v241, v240
    v_bfe_u32 v241, v241, 28, 2
    v_xor_b32 v1, v1, v241
    v_add_u32 v240, s78, v240
    v_cmp_gt_u32 vcc, 512, v240
    v_mul_u32_u24 v2, 98304, v2
    v_mul_u32_u24 v240, 192, v240
    v_lshl_add_u32 v1, v1, 4, v2
    v_add_u32 v1, v1, v240
    v_bfrev_b32 v2, 1
    v_cndmask_b32 v53, v2, v1, vcc
    s_branch L_common
L_roleX:
    s_add_u32 s79, s24, 0
    s_lshl_b32 s40, s79, 10
    s_lshl_b32 s79, s79, 6
    v_add_u32 v1, s79, v0
    v_mul_u32_u24 v2, 2185, v1
    v_lshrrev_b32 v2, 19, v2
    v_mul_u32_u24 v240, 240, v2
    v_sub_u32 v1, v1, v240
    v_mul_u32_u24 v240, 171, v1
    v_lshrrev_b32 v240, 11, v240
    v_mul_u32_u24 v241, 12, v240
    v_sub_u32 v1, v1, v241
    v_bfrev_b32 v241, v240
    v_bfe_u32 v241, v241, 28, 2
    v_xor_b32 v1, v1, v241
    v_add_u32 v240, s78, v240
    v_cmp_gt_u32 vcc, 512, v240
    v_mul_u32_u24 v2, 98304, v2
    v_mul_u32_u24 v240, 192, v240
    v_lshl_add_u32 v1, v1, 4, v2
    v_add_u32 v1, v1, v240
    v_bfrev_b32 v2, 1
    v_cndmask_b32 v52, v2, v1, vcc
    v_add_u32 v248, s16, v52
    s_add_u32 s79, s24, 4
    s_lshl_b32 s17, s79, 10
    s_lshl_b32 s79, s79, 6
    v_add_u32 v1, s79, v0
    v_mul_u32_u24 v2, 2185, v1
    v_lshrrev_b32 v2, 19, v2
    v_mul_u32_u24 v240, 240, v2
    v_sub_u32 v1, v1, v240
    v_mul_u32_u24 v240, 171, v1
    v_lshrrev_b32 v240, 11, v240
    v_mul_u32_u24 v241, 12, v240
    v_sub_u32 v1, v1, v241
    v_bfrev_b32 v241, v240
    v_bfe_u32 v241, v241, 28, 2
    v_xor_b32 v1, v1, v241
    v_add_u32 v240, s78, v240
    v_cmp_gt_u32 vcc, 512, v240
    v_mul_u32_u24 v2, 98304, v2
    v_mul_u32_u24 v240, 192, v240
    v_lshl_add_u32 v1, v1, 4, v2
    v_add_u32 v1, v1, v240
    v_bfrev_b32 v2, 1
    v_cndmask_b32 v246, v2, v1, vcc
    v_add_u32 v249, s16, v246
    s_add_u32 s79, s24, 8
    s_lshl_b32 s41, s79, 10
    s_lshl_b32 s79, s79, 6
    v_add_u32 v1, s79, v0
    v_mul_u32_u24 v2, 2185, v1
    v_lshrrev_b32 v2, 19, v2
    v_mul_u32_u24 v240, 240, v2
    v_sub_u32 v1, v1, v240
    v_mul_u32_u24 v240, 171, v1
    v_lshrrev_b32 v240, 11, v240
    v_mul_u32_u24 v241, 12, v240
    v_sub_u32 v1, v1, v241
    v_bfrev_b32 v241, v240
    v_bfe_u32 v241, v241, 28, 2
    v_xor_b32 v1, v1, v241
    v_add_u32 v240, s78, v240
    v_cmp_gt_u32 vcc, 512, v240
    v_mul_u32_u24 v2, 98304, v2
    v_mul_u32_u24 v240, 192, v240
    v_lshl_add_u32 v1, v1, 4, v2
    v_add_u32 v1, v1, v240
    v_bfrev_b32 v2, 1
    v_cndmask_b32 v53, v2, v1, vcc
    v_add_u32 v250, s16, v53
    s_add_u32 s79, s24, 12
    s_min_u32 s79, s79, 14
    s_lshl_b32 s18, s79, 10
    s_lshl_b32 s79, s79, 6
    v_add_u32 v1, s79, v0
    v_mul_u32_u24 v2, 2185, v1
    v_lshrrev_b32 v2, 19, v2
    v_mul_u32_u24 v240, 240, v2
    v_sub_u32 v1, v1, v240
    v_mul_u32_u24 v240, 171, v1
    v_lshrrev_b32 v240, 11, v240
    v_mul_u32_u24 v241, 12, v240
    v_sub_u32 v1, v1, v241
    v_bfrev_b32 v241, v240
    v_bfe_u32 v241, v241, 28, 2
    v_xor_b32 v1, v1, v241
    v_add_u32 v240, s78, v240
    v_cmp_gt_u32 vcc, 512, v240
    v_mul_u32_u24 v2, 98304, v2
    v_mul_u32_u24 v240, 192, v240
    v_lshl_add_u32 v1, v1, 4, v2
    v_add_u32 v1, v1, v240
    v_bfrev_b32 v2, 1
    v_cndmask_b32 v247, v2, v1, vcc
    v_add_u32 v251, s16, v247
    s_waitcnt lgkmcnt(0)
    s_mov_b32 s4, s60
    s_and_b32 s5, s61, 0xffff
    s_mov_b32 s6, 50331648
    s_mov_b32 s7, 0x20000
    s_mov_b32 s12, s64
    s_and_b32 s13, s65, 0xffff
    s_mov_b32 s14, 4800
    s_mov_b32 s15, 0x20000
    s_mul_i32 s75, s24, 24
    s_lshl_b32 s76, s24, 10
    s_add_u32 s76, s76, 150784
    s_mov_b32 m0, s76
    s_bfm_b64 exec, 50, 0
    buffer_load_dwordx4 v242, s[12:15], s75 offen offset:0 lds
    s_mov_b32 s12, s62
    s_and_b32 s13, s63, 0xffff
    s_mov_b32 s14, 192
    s_add_u32 m0, s76, 800
    s_mov_b64 exec, 3
    buffer_load_dwordx4 v242, s[12:15], s75 offen offset:0 lds
    s_mov_b64 exec, -1
    s_mov_b32 s25, 0x44e944e9
    s_mov_b32 s27, 0x37803780
    v_lshl_add_u32 v1, s24, 6, v0
    v_lshlrev_b32 v192, 4, v1
    v_add_u32 v192, 151488, v192
    v_lshlrev_b32 v2, 6, v1
    v_lshl_or_b32 v1, v1, 22, v2
    v_add_u32 v176, 0xc0004, v1
    v_add_u32 v177, 0x100010, v176
    v_add_u32 v178, 0x200020, v176
    v_add_u32 v179, 0x300030, v176
    v_add_u32 v180, 0x40004000, v176
    v_add_u32 v181, 0x40104010, v176
    v_add_u32 v182, 0x40204020, v176
    v_add_u32 v183, 0x40304030, v176
    v_add_u32 v184, 0x80008000, v176
    v_add_u32 v185, 0x80108010, v176
    v_add_u32 v186, 0x80208020, v176
    v_add_u32 v187, 0x80308030, v176
    v_add_u32 v188, 0xc000c000, v176
    v_add_u32 v189, 0xc010c010, v176
    v_add_u32 v190, 0xc020c020, v176
    v_add_u32 v191, 0xc030c030, v176
    v_pk_fma_f16 v128, v176, v176, s25
    v_pk_fma_f16 v129, v177, v177, s25
    v_pk_fma_f16 v130, v178, v178, s25
    v_pk_fma_f16 v131, v179, v179, s25
    v_pk_fma_f16 v132, v180, v180, s25
    v_pk_fma_f16 v133, v181, v181, s25
    v_pk_fma_f16 v134, v182, v182, s25
    v_pk_fma_f16 v135, v183, v183, s25
    v_pk_mul_f16 v128, v128, v176
    v_pk_mul_f16 v129, v129, v177
    v_pk_mul_f16 v130, v130, v178
    v_pk_mul_f16 v131, v131, v179
    v_pk_mul_f16 v132, v132, v180
    v_pk_mul_f16 v133, v133, v181
    v_pk_mul_f16 v134, v134, v182
    v_pk_mul_f16 v135, v135, v183
    v_exp_f16_sdwa v128, -v128 dst_sel:WORD_0 dst_unused:UNUSED_PRESERVE src0_sel:WORD_0
    v_exp_f16_sdwa v129, -v129 dst_sel:WORD_0 dst_unused:UNUSED_PRESERVE src0_sel:WORD_0
    v_exp_f16_sdwa v130, -v130 dst_sel:WORD_0 dst_unused:UNUSED_PRESERVE src0_sel:WORD_0
    v_exp_f16_sdwa v131, -v131 dst_sel:WORD_0 dst_unused:UNUSED_PRESERVE src0_sel:WORD_0
    v_exp_f16_sdwa v132, -v132 dst_sel:WORD_0 dst_unused:UNUSED_PRESERVE src0_sel:WORD_0
    v_exp_f16_sdwa v133, -v133 dst_sel:WORD_0 dst_unused:UNUSED_PRESERVE src0_sel:WORD_0
    v_exp_f16_sdwa v134, -v134 dst_sel:WORD_0 dst_unused:UNUSED_PRESERVE src0_sel:WORD_0
    v_exp_f16_sdwa v135, -v135 dst_sel:WORD_0 dst_unused:UNUSED_PRESERVE src0_sel:WORD_0
    v_exp_f16_sdwa v128, -v128 dst_sel:WORD_1 dst_unused:UNUSED_PRESERVE src0_sel:WORD_1
    v_exp_f16_sdwa v129, -v129 dst_sel:WORD_1 dst_unused:UNUSED_PRESERVE src0_sel:WORD_1
    v_exp_f16_sdwa v130, -v130 dst_sel:WORD_1 dst_unused:UNUSED_PRESERVE src0_sel:WORD_1
    v_exp_f16_sdwa v131, -v131 dst_sel:WORD_1 dst_unused:UNUSED_PRESERVE src0_sel:WORD_1
    v_exp_f16_sdwa v132, -v132 dst_sel:WORD_1 dst_unused:UNUSED_PRESERVE src0_sel:WORD_1
    v_exp_f16_sdwa v133, -v133 dst_sel:WORD_1 dst_unused:UNUSED_PRESERVE src0_sel:WORD_1
    v_exp_f16_sdwa v134, -v134 dst_sel:WORD_1 dst_unused:UNUSED_PRESERVE src0_sel:WORD_1
    v_exp_f16_sdwa v135, -v135 dst_sel:WORD_1 dst_unused:UNUSED_PRESERVE src0_sel:WORD_1
    v_pk_fma_f16 v128, v128, s27, s27
    v_pk_fma_f16 v129, v129, s27, s27
    v_pk_fma_f16 v130, v130, s27, s27
    v_pk_fma_f16 v131, v131, s27, s27
    v_pk_fma_f16 v132, v132, s27, s27
    v_pk_fma_f16 v133, v133, s27, s27
    v_pk_fma_f16 v134, v134, s27, s27
    v_pk_fma_f16 v135, v135, s27, s27
    v_rcp_f16_sdwa v128, v128 dst_sel:WORD_0 dst_unused:UNUSED_PRESERVE src0_sel:WORD_0
    v_rcp_f16_sdwa v129, v129 dst_sel:WORD_0 dst_unused:UNUSED_PRESERVE src0_sel:WORD_0
    v_rcp_f16_sdwa v130, v130 dst_sel:WORD_0 dst_unused:UNUSED_PRESERVE src0_sel:WORD_0
    v_rcp_f16_sdwa v131, v131 dst_sel:WORD_0 dst_unused:UNUSED_PRESERVE src0_sel:WORD_0
    v_rcp_f16_sdwa v132, v132 dst_sel:WORD_0 dst_unused:UNUSED_PRESERVE src0_sel:WORD_0
    v_rcp_f16_sdwa v133, v133 dst_sel:WORD_0 dst_unused:UNUSED_PRESERVE src0_sel:WORD_0
    v_rcp_f16_sdwa v134, v134 dst_sel:WORD_0 dst_unused:UNUSED_PRESERVE src0_sel:WORD_0
    v_rcp_f16_sdwa v135, v135 dst_sel:WORD_0 dst_unused:UNUSED_PRESERVE src0_sel:WORD_0
    v_rcp_f16_sdwa v128, v128 dst_sel:WORD_1 dst_unused:UNUSED_PRESERVE src0_sel:WORD_1
    v_rcp_f16_sdwa v129, v129 dst_sel:WORD_1 dst_unused:UNUSED_PRESERVE src0_sel:WORD_1
    v_rcp_f16_sdwa v130, v130 dst_sel:WORD_1 dst_unused:UNUSED_PRESERVE src0_sel:WORD_1
    v_rcp_f16_sdwa v131, v131 dst_sel:WORD_1 dst_unused:UNUSED_PRESERVE src0_sel:WORD_1
    v_rcp_f16_sdwa v132, v132 dst_sel:WORD_1 dst_unused:UNUSED_PRESERVE src0_sel:WORD_1
    v_rcp_f16_sdwa v133, v133 dst_sel:WORD_1 dst_unused:UNUSED_PRESERVE src0_sel:WORD_1
    v_rcp_f16_sdwa v134, v134 dst_sel:WORD_1 dst_unused:UNUSED_PRESERVE src0_sel:WORD_1
    v_rcp_f16_sdwa v135, v135 dst_sel:WORD_1 dst_unused:UNUSED_PRESERVE src0_sel:WORD_1
    v_fma_mix_f32 v144, v128, v176, 0 op_sel_hi:[1,1,0]
    v_fma_mix_f32 v128, v128, v176, 0 op_sel:[1,1,0] op_sel_hi:[1,1,0]
    v_fma_mix_f32 v145, v129, v177, 0 op_sel_hi:[1,1,0]
    v_fma_mix_f32 v129, v129, v177, 0 op_sel:[1,1,0] op_sel_hi:[1,1,0]
    v_fma_mix_f32 v146, v130, v178, 0 op_sel_hi:[1,1,0]
    v_fma_mix_f32 v130, v130, v178, 0 op_sel:[1,1,0] op_sel_hi:[1,1,0]
    v_fma_mix_f32 v147, v131, v179, 0 op_sel_hi:[1,1,0]
    v_fma_mix_f32 v131, v131, v179, 0 op_sel:[1,1,0] op_sel_hi:[1,1,0]
    v_fma_mix_f32 v148, v132, v180, 0 op_sel_hi:[1,1,0]
    v_fma_mix_f32 v132, v132, v180, 0 op_sel:[1,1,0] op_sel_hi:[1,1,0]
    v_fma_mix_f32 v149, v133, v181, 0 op_sel_hi:[1,1,0]
    v_fma_mix_f32 v133, v133, v181, 0 op_sel:[1,1,0] op_sel_hi:[1,1,0]
    v_fma_mix_f32 v150, v134, v182, 0 op_sel_hi:[1,1,0]
    v_fma_mix_f32 v134, v134, v182, 0 op_sel:[1,1,0] op_sel_hi:[1,1,0]
    v_fma_mix_f32 v151, v135, v183, 0 op_sel_hi:[1,1,0]
    v_fma_mix_f32 v135, v135, v183, 0 op_sel:[1,1,0] op_sel_hi:[1,1,0]
    v_cvt_pk_bf16_f32 v176, v144, v128
    v_cvt_pk_bf16_f32 v177, v145, v129
    v_cvt_pk_bf16_f32 v178, v146, v130
    v_cvt_pk_bf16_f32 v179, v147, v131
    v_cvt_pk_bf16_f32 v180, v148, v132
    v_cvt_pk_bf16_f32 v181, v149, v133
    v_cvt_pk_bf16_f32 v182, v150, v134
    v_cvt_pk_bf16_f32 v183, v151, v135
    s_barrier
    s_add_u32 m0, s40, 0
    s_nop 0
    buffer_load_dwordx4 v248, s[4:7], 0 offen offset:0 nt lds
    s_add_u32 m0, s17, 0
    s_nop 0
    buffer_load_dwordx4 v249, s[4:7], 0 offen offset:0 nt lds
    s_add_u32 m0, s41, 0
    s_nop 0
    buffer_load_dwordx4 v250, s[4:7], 0 offen offset:0 nt lds
    s_add_u32 m0, s18, 0
    s_nop 0
    buffer_load_dwordx4 v251, s[4:7], 0 offen offset:0 nt lds
    s_add_u32 m0, s40, 15368
    s_add_u32 s31, s16, 393216
    buffer_load_dwordx4 v52, s[4:7], s31 offen offset:0 nt lds
    s_add_u32 m0, s17, 15368
    s_add_u32 s31, s16, 393216
    buffer_load_dwordx4 v246, s[4:7], s31 offen offset:0 nt lds
    s_add_u32 m0, s41, 15368
    s_add_u32 s31, s16, 393216
    buffer_load_dwordx4 v53, s[4:7], s31 offen offset:0 nt lds
    s_add_u32 m0, s18, 15368
    s_add_u32 s31, s16, 393216
    buffer_load_dwordx4 v247, s[4:7], s31 offen offset:0 nt lds
    s_add_u32 m0, s40, 30784
    s_add_u32 s31, s16, 786432
    buffer_load_dwordx4 v52, s[4:7], s31 offen offset:0 nt lds
    s_add_u32 m0, s17, 30784
    s_add_u32 s31, s16, 786432
    buffer_load_dwordx4 v246, s[4:7], s31 offen offset:0 nt lds
    s_add_u32 m0, s41, 30784
    s_add_u32 s31, s16, 786432
    buffer_load_dwordx4 v53, s[4:7], s31 offen offset:0 nt lds
    s_add_u32 m0, s18, 30784
    s_add_u32 s31, s16, 786432
    buffer_load_dwordx4 v247, s[4:7], s31 offen offset:0 nt lds
    s_add_u32 m0, s40, 46152
    s_add_u32 s31, s16, 1179648
    buffer_load_dwordx4 v52, s[4:7], s31 offen offset:0 nt lds
    s_add_u32 m0, s17, 46152
    s_add_u32 s31, s16, 1179648
    buffer_load_dwordx4 v246, s[4:7], s31 offen offset:0 nt lds
    s_add_u32 m0, s41, 46152
    s_add_u32 s31, s16, 1179648
    buffer_load_dwordx4 v53, s[4:7], s31 offen offset:0 nt lds
    s_add_u32 m0, s18, 46152
    s_add_u32 s31, s16, 1179648
    buffer_load_dwordx4 v247, s[4:7], s31 offen offset:0 nt lds
    s_add_u32 m0, s40, 61696
    s_add_u32 s31, s16, 1572864
    buffer_load_dwordx4 v52, s[4:7], s31 offen offset:0 nt lds
    s_add_u32 m0, s17, 61696
    s_add_u32 s31, s16, 1572864
    buffer_load_dwordx4 v246, s[4:7], s31 offen offset:0 nt lds
    s_add_u32 m0, s41, 61696
    s_add_u32 s31, s16, 1572864
    buffer_load_dwordx4 v53, s[4:7], s31 offen offset:0 nt lds
    s_add_u32 m0, s18, 61696
    s_add_u32 s31, s16, 1572864
    buffer_load_dwordx4 v247, s[4:7], s31 offen offset:0 nt lds
L_common:
    v_and_b32 v1, 1, v0
    v_lshlrev_b32 v1, 4, v1
    v_mov_b32 v2, 0x3f80
    v_lshlrev_b32 v1, v1, v2
    v_bfe_u32 v2, v0, 2, 2
    v_lshrrev_b32 v252, 4, v0
    v_sub_u32 v2, v2, v252
    v_bfe_u32 v252, v0, 1, 1
    v_lshl_add_u32 v2, v2, 1, v252
    v_mov_b32 v56, 0
    v_mov_b32 v57, 0
    v_mov_b32 v60, 0
    v_mov_b32 v61, 0
    v_cmp_eq_u32 vcc, 0, v2
    s_nop 1
    v_cndmask_b32 v58, 0, v1, vcc
    v_cmp_eq_u32 vcc, 1, v2
    s_nop 1
    v_cndmask_b32 v59, 0, v1, vcc
    s_mov_b32 s8, s70
    s_and_b32 s9, s71, 0xffff
    s_mov_b32 s10, 0
    s_mov_b32 s11, 0x20000
    s_mov_b32 s36, s66
    s_and_b32 s37, s67, 0xffff
    s_mov_b32 s38, 73728
    s_mov_b32 s39, 0x20000
    s_mov_b32 s44, s48
    s_and_b32 s45, s49, 0xffff
    s_mov_b32 s46, 36864
    s_mov_b32 s47, 0x20000
    s_add_u32 s16, s16, 1572864
    s_sub_u32 s79, s24, 6
    s_cmp_ge_u32 s24, 6
    s_cselect_b32 s79, s79, s24
    s_lshl_b32 s34, s79, 10
    s_add_u32 s34, s34, 126208
    s_lshl_b32 s55, s79, 10
    v_lshlrev_b32 v1, 4, v0
    v_add_u32 v51, s55, v1
    s_lshl_b32 s79, s79, 4
    v_lshrrev_b32 v1, 2, v0
    v_add_u32 v1, s79, v1
    v_mul_u32_u24 v1, 768, v1
    v_lshrrev_b32 v2, 5, v0
    v_lshlrev_b32 v2, 1, v2
    v_and_b32 v3, 3, v0
    v_xor_b32 v2, v2, v3
    v_lshl_add_u32 v54, v2, 4, v1
    v_lshlrev_b32 v3, 4, v0
    v_bfe_u32 v240, v0, 2, 2
    v_and_b32 v241, 3, v0
    v_lshrrev_b32 v242, 4, v0
    v_lshlrev_b32 v243, 1, v241
    v_add_u32 v243, s76, v243
    v_and_b32 v1, 1, v242
    v_lshlrev_b32 v1, 2, v1
    v_sub_u32 v1, v1, v240
    v_lshrrev_b32 v2, 1, v242
    v_mul_u32_u24 v2, 5, v2
    v_mov_b32 v254, 167936
    v_add_u32 v252, 0, v1
    v_cmp_gt_u32 vcc, 5, v252
    v_add_u32 v253, v252, v2
    v_lshl_add_u32 v255, v253, 5, v243
    v_cndmask_b32 v244, v254, v255, vcc
    v_cmp_eq_u32 vcc, 2, v253
    v_mov_b32 v255, 0xffff0000
    s_nop 0
    v_cndmask_b32 v248, 0, v255, vcc
    v_cmp_eq_u32 vcc, 2, v252
    s_nop 1
    v_cndmask_b32 v248, 0, v248, vcc
    v_add_u32 v252, 1, v1
    v_cmp_gt_u32 vcc, 5, v252
    v_add_u32 v253, v252, v2
    v_lshl_add_u32 v255, v253, 5, v243
    v_cndmask_b32 v245, v254, v255, vcc
    v_cmp_eq_u32 vcc, 2, v253
    v_mov_b32 v255, 0xffff0000
    s_nop 0
    v_cndmask_b32 v249, 0, v255, vcc
    v_cmp_eq_u32 vcc, 2, v252
    s_nop 1
    v_cndmask_b32 v249, 0, v249, vcc
    v_add_u32 v252, 2, v1
    v_cmp_gt_u32 vcc, 5, v252
    v_add_u32 v253, v252, v2
    v_lshl_add_u32 v255, v253, 5, v243
    v_cndmask_b32 v246, v254, v255, vcc
    v_cmp_eq_u32 vcc, 2, v253
    v_mov_b32 v255, 0xffff0000
    s_nop 0
    v_cndmask_b32 v250, 0, v255, vcc
    v_cmp_eq_u32 vcc, 2, v252
    s_nop 1
    v_cndmask_b32 v250, 0, v250, vcc
    v_add_u32 v252, 3, v1
    v_cmp_gt_u32 vcc, 5, v252
    v_add_u32 v253, v252, v2
    v_lshl_add_u32 v255, v253, 5, v243
    v_cndmask_b32 v247, v254, v255, vcc
    v_cmp_eq_u32 vcc, 2, v253
    v_mov_b32 v255, 0xffff0000
    s_nop 0
    v_cndmask_b32 v251, 0, v255, vcc
    v_cmp_eq_u32 vcc, 2, v252
    s_nop 1
    v_cndmask_b32 v251, 0, v251, vcc
    v_lshlrev_b32 v1, 1, v242
    v_sub_u32 v1, v1, v240
    v_add_u32 v252, 0, v1
    v_cmp_gt_u32 vcc, 5, v252
    v_add_u32 v253, 20, v252
    v_lshl_add_u32 v255, v253, 5, v243
    v_cndmask_b32 v224, v254, v255, vcc
    v_add_u32 v252, 1, v1
    v_cmp_gt_u32 vcc, 5, v252
    v_add_u32 v253, 20, v252
    v_lshl_add_u32 v255, v253, 5, v243
    v_cndmask_b32 v225, v254, v255, vcc
    s_waitcnt vmcnt(18) lgkmcnt(0)
    ds_read_u16 v8, v244 offset:0
    ds_read_u16 v9, v245 offset:0
    ds_read_u16 v10, v246 offset:0
    ds_read_u16 v11, v247 offset:0
    ds_read_u16 v12, v244 offset:320
    ds_read_u16 v13, v245 offset:320
    ds_read_u16 v14, v246 offset:320
    ds_read_u16 v15, v247 offset:320
    ds_read_u16 v232, v224 offset:0
    ds_read_u16 v233, v225 offset:0
    ds_read_u16 v226, v243 offset:800
    s_waitcnt lgkmcnt(4)
    ds_read_u16 v20, v244 offset:8
    ds_read_u16 v21, v245 offset:8
    ds_read_u16 v22, v246 offset:8
    ds_read_u16 v23, v247 offset:8
    ds_read_u16 v24, v244 offset:328
    ds_read_u16 v25, v245 offset:328
    ds_read_u16 v26, v246 offset:328
    ds_read_u16 v27, v247 offset:328
    ds_read_u16 v234, v224 offset:8
    ds_read_u16 v235, v225 offset:8
    ds_read_u16 v227, v243 offset:808
    s_waitcnt lgkmcnt(4)
    ds_read_u16 v32, v244 offset:16
    ds_read_u16 v33, v245 offset:16
    ds_read_u16 v34, v246 offset:16
    ds_read_u16 v35, v247 offset:16
    ds_read_u16 v36, v244 offset:336
    ds_read_u16 v37, v245 offset:336
    ds_read_u16 v38, v246 offset:336
    ds_read_u16 v39, v247 offset:336
    ds_read_u16 v236, v224 offset:16
    ds_read_u16 v237, v225 offset:16
    ds_read_u16 v228, v243 offset:816
    s_mov_b32 s25, 0x44e944e9
    s_mov_b32 s26, 0x3f803f80
    s_mov_b32 s27, 0x37803780
    s_mov_b32 s28, 0x3c2aaaab
    s_mov_b32 s29, 0x3727c5ac
    s_mov_b32 s30, 0x3ef00000
    s_mov_b32 s42, 0xfff8fff8
    s_mov_b64 s[56:57], 0
    s_movk_i32 s43, 0x207
    s_mov_b32 s20, 0x409d2000
    s_mov_b32 s21, 0
    s_mov_b32 s23, 0
    v_mul_u32_u24 v40, 0x5555, v241
    v_mul_u32_u24 v1, 15360, v240
    v_and_b32 v2, 1, v240
    v_lshl_add_u32 v1, v2, 3, v1
    v_bfe_u32 v2, v240, 1, 1
    v_lshl_add_u32 v1, v2, 6, v1
    v_lshrrev_b32 v2, 2, v240
    v_lshl_add_u32 v1, v2, 8, v1
    v_add_u32 v252, 1, v240
    v_mul_u32_u24 v253, 15360, v252
    v_and_b32 v2, 1, v252
    v_lshl_add_u32 v253, v2, 3, v253
    v_bfe_u32 v2, v252, 1, 1
    v_lshl_add_u32 v253, v2, 6, v253
    v_lshrrev_b32 v2, 2, v252
    v_lshl_add_u32 v253, v2, 8, v253
    v_sub_u32 v45, v253, v1
    v_lshlrev_b32 v2, 2, v241
    v_lshl_add_u32 v2, v242, 1, v2
    v_mul_u32_u24 v2, 192, v2
    v_add_u32 v1, v1, v2
    v_lshrrev_b32 v2, 1, v242
    v_add_u32 v2, v2, v241
    v_bfrev_b32 v2, v2
    v_lshrrev_b32 v2, 30, v2
    v_mul_u32_u24 v252, 192, v242
    v_sub_u32 v44, 384, v252
    s_mul_i32 s79, s24, 3
    s_add_u32 s79, s79, 0
    s_lshr_b32 s78, s79, 1
    s_and_b32 s79, s79, 1
    s_lshl_b32 s79, s79, 3
    v_xor_b32 v253, s78, v2
    v_lshl_add_u32 v253, v253, 4, v1
    v_add_u32 v41, s79, v253
    s_mul_i32 s79, s24, 3
    s_add_u32 s79, s79, 1
    s_lshr_b32 s78, s79, 1
    s_and_b32 s79, s79, 1
    s_lshl_b32 s79, s79, 3
    v_xor_b32 v253, s78, v2
    v_lshl_add_u32 v253, v253, 4, v1
    v_add_u32 v42, s79, v253
    s_mul_i32 s79, s24, 3
    s_add_u32 s79, s79, 2
    s_lshr_b32 s78, s79, 1
    s_and_b32 s79, s79, 1
    s_lshl_b32 s79, s79, 3
    v_xor_b32 v253, s78, v2
    v_lshl_add_u32 v253, v253, 4, v1
    v_add_u32 v43, s79, v253
    s_and_b32 s75, s24, 3
    s_lshr_b32 s79, s24, 2
    s_lshl_b32 s79, s79, 3
    s_add_u32 s75, s75, s79
    s_lshl_b32 s79, s75, 9
    s_add_u32 s79, s79, s73
    s_mul_i32 s59, s79, 192
    v_and_b32 v2, 7, v0
    v_bfe_u32 v1, v0, 3, 1
    v_lshl_add_u32 v253, v1, 11, v2
    v_mul_u32_u24 v253, 192, v253
    v_lshl_add_u32 v253, v242, 4, v253
    v_add_u32 v55, s59, v253
    v_lshlrev_b32 v1, 2, v1
    s_add_u32 s79, s75, 2
    v_add_u32 v1, s79, v1
    v_lshrrev_b32 v252, 2, v1
    v_mul_u32_u24 v253, 15360, v252
    v_and_b32 v254, 1, v252
    v_lshl_add_u32 v253, v254, 3, v253
    v_bfe_u32 v254, v252, 1, 1
    v_lshl_add_u32 v253, v254, 6, v253
    v_lshrrev_b32 v254, 2, v252
    v_lshl_add_u32 v253, v254, 8, v253
    v_and_b32 v1, 3, v1
    v_mul_u32_u24 v1, 3840, v1
    v_add_u32 v253, v253, v1
    v_add_u32 v1, 2, v2
    v_bfrev_b32 v252, v1
    v_bfe_u32 v252, v252, 28, 2
    v_xor_b32 v252, v252, v242
    v_mul_u32_u24 v1, 192, v1
    v_add_u32 v1, v1, v253
    v_lshl_add_u32 v47, v252, 4, v1
    v_add_u32 v1, 10, v2
    v_bfrev_b32 v252, v1
    v_bfe_u32 v252, v252, 28, 2
    v_xor_b32 v252, v252, v242
    v_mul_u32_u24 v1, 192, v1
    v_add_u32 v1, v1, v253
    v_lshl_add_u32 v48, v252, 4, v1
    v_lshl_add_u32 v1, v242, 3, v240
    v_lshlrev_b32 v1, 6, v1
    v_lshl_add_u32 v1, v241, 3, v1
    v_and_b32 v2, 1, v242
    v_lshl_add_u32 v1, v2, 5, v1
    v_xor_b32 v2, 32, v1
    v_add_u32 v49, 126208, v1
    v_add_u32 v62, 126208, v2
    v_add_u32 v50, 77056, v3
    s_waitcnt lgkmcnt(0)
    v_and_b32 v1, 1, v241
    v_lshlrev_b32 v1, 4, v1
    v_cmp_gt_u32 vcc, 2, v241
    s_nop 1
    v_cndmask_b32 v2, 0, -1, vcc
    v_not_b32 v253, v2
    v_lshlrev_b32 v252, v1, v232
    v_and_b32 v4, v252, v2
    v_and_b32 v5, v252, v253
    v_lshlrev_b32 v252, v1, v233
    v_and_b32 v6, v252, v2
    v_and_b32 v7, v252, v253
    v_lshlrev_b32 v252, 16, v226
    v_and_or_b32 v12, v252, v248, v12
    v_and_or_b32 v13, v252, v249, v13
    v_and_or_b32 v14, v252, v250, v14
    v_and_or_b32 v15, v252, v251, v15
    v_lshlrev_b32 v252, v1, v234
    v_and_b32 v16, v252, v2
    v_and_b32 v17, v252, v253
    v_lshlrev_b32 v252, v1, v235
    v_and_b32 v18, v252, v2
    v_and_b32 v19, v252, v253
    v_lshlrev_b32 v252, 16, v227
    v_and_or_b32 v24, v252, v248, v24
    v_and_or_b32 v25, v252, v249, v25
    v_and_or_b32 v26, v252, v250, v26
    v_and_or_b32 v27, v252, v251, v27
    v_lshlrev_b32 v252, v1, v236
    v_and_b32 v28, v252, v2
    v_and_b32 v29, v252, v253
    v_lshlrev_b32 v252, v1, v237
    v_and_b32 v30, v252, v2
    v_and_b32 v31, v252, v253
    v_lshlrev_b32 v252, 16, v228
    v_and_or_b32 v36, v252, v248, v36
    v_and_or_b32 v37, v252, v249, v37
    v_and_or_b32 v38, v252, v250, v38
    v_and_or_b32 v39, v252, v251, v39
    s_cmp_lt_u32 s24, 4
    s_cbranch_scc1 L_join
    v_and_b32 v1, 15, v0
    v_lshrrev_b32 v2, 2, v1
    v_sub_u32 v2, 0, v2
    v_and_b32 v2, 3, v2
    v_xor_b32 v2, v2, v242
    v_mul_u32_u24 v1, 192, v1
    v_lshl_add_u32 v1, v2, 4, v1
    v_add_u32 v244, s77, v1
    s_sub_u32 s50, s74, 12288
    s_add_u32 s52, s74, 12288
    s_add_u32 s53, s52, 4096
    s_cmp_ge_u32 s74, 12288
    s_cselect_b32 s50, s50, 0x40000000
    s_add_u32 s51, s50, 4096
    v_lshlrev_b32 v3, 4, v0
    v_add_u32 v2, s77, v3
    s_waitcnt vmcnt(0)
    ds_read_b128 v[64:67], v244 offset:0
    ds_read_b128 v[68:71], v244 offset:3072
    ds_read_b128 v[72:75], v244 offset:64
    ds_read_b128 v[76:79], v244 offset:3136
    ds_read_b128 v[80:83], v244 offset:128
    ds_read_b128 v[84:87], v244 offset:3200
    s_waitcnt vmcnt(0)
    ds_read_b128 v[88:91], v244 offset:24576
    ds_read_b128 v[92:95], v244 offset:27648
    ds_read_b128 v[96:99], v244 offset:24640
    ds_read_b128 v[100:103], v244 offset:27712
    ds_read_b128 v[104:107], v244 offset:24704
    ds_read_b128 v[108:111], v244 offset:27776
    s_waitcnt vmcnt(0) lgkmcnt(6)
    ds_read_b128 v[112:115], v244 offset:49152
    ds_read_b128 v[116:119], v244 offset:52224
    ds_read_b128 v[120:123], v244 offset:49216
    ds_read_b128 v[124:127], v244 offset:52288
    ds_read_b128 v[128:131], v244 offset:49280
    ds_read_b128 v[132:135], v244 offset:52352
    s_waitcnt lgkmcnt(0)
    v_mfma_f32_16x16x32_bf16 v[136:139], v[64:67], v[58:61], 0
    v_mfma_f32_16x16x32_bf16 v[140:143], v[68:71], v[58:61], 0
    v_mfma_f32_16x16x32_bf16 v[144:147], v[64:67], v[56:59], 0
    v_mfma_f32_16x16x32_bf16 v[148:151], v[68:71], v[56:59], 0
    v_mfma_f32_16x16x32_bf16 v[152:155], v[72:75], v[58:61], 0
    v_mfma_f32_16x16x32_bf16 v[156:159], v[76:79], v[58:61], 0
    v_mfma_f32_16x16x32_bf16 v[160:163], v[72:75], v[56:59], 0
    v_mfma_f32_16x16x32_bf16 v[164:167], v[76:79], v[56:59], 0
    s_nop 0
    v_cvt_pk_bf16_f32 v184, v136, v137
    v_cvt_pk_bf16_f32 v185, v138, v139
    v_cvt_pk_bf16_f32 v186, v140, v141
    v_cvt_pk_bf16_f32 v187, v142, v143
    v_cvt_pk_bf16_f32 v188, v144, v145
    v_cvt_pk_bf16_f32 v189, v146, v147
    v_cvt_pk_bf16_f32 v190, v148, v149
    v_cvt_pk_bf16_f32 v191, v150, v151
    ds_write_b128 v2, v[184:187] offset:0
    ds_write_b128 v2, v[188:191] offset:1024
    v_mfma_f32_16x16x32_bf16 v[168:171], v[80:83], v[58:61], 0
    v_mfma_f32_16x16x32_bf16 v[172:175], v[84:87], v[58:61], 0
    v_mfma_f32_16x16x32_bf16 v[176:179], v[80:83], v[56:59], 0
    v_mfma_f32_16x16x32_bf16 v[180:183], v[84:87], v[56:59], 0
    v_cvt_pk_bf16_f32 v192, v152, v153
    v_cvt_pk_bf16_f32 v193, v154, v155
    v_cvt_pk_bf16_f32 v194, v156, v157
    v_cvt_pk_bf16_f32 v195, v158, v159
    v_cvt_pk_bf16_f32 v196, v160, v161
    v_cvt_pk_bf16_f32 v197, v162, v163
    v_cvt_pk_bf16_f32 v198, v164, v165
    v_cvt_pk_bf16_f32 v199, v166, v167
    ds_write_b128 v2, v[192:195] offset:2048
    ds_write_b128 v2, v[196:199] offset:3072
    v_mfma_f32_16x16x32_bf16 v[136:139], v[88:91], v[58:61], 0
    v_mfma_f32_16x16x32_bf16 v[140:143], v[92:95], v[58:61], 0
    v_mfma_f32_16x16x32_bf16 v[144:147], v[88:91], v[56:59], 0
    v_mfma_f32_16x16x32_bf16 v[148:151], v[92:95], v[56:59], 0
    v_cvt_pk_bf16_f32 v200, v168, v169
    v_cvt_pk_bf16_f32 v201, v170, v171
    v_cvt_pk_bf16_f32 v202, v172, v173
    v_cvt_pk_bf16_f32 v203, v174, v175
    v_cvt_pk_bf16_f32 v204, v176, v177
    v_cvt_pk_bf16_f32 v205, v178, v179
    v_cvt_pk_bf16_f32 v206, v180, v181
    v_cvt_pk_bf16_f32 v207, v182, v183
    ds_write_b128 v2, v[200:203] offset:4096
    ds_write_b128 v2, v[204:207] offset:5120
    v_mfma_f32_16x16x32_bf16 v[152:155], v[96:99], v[58:61], 0
    v_mfma_f32_16x16x32_bf16 v[156:159], v[100:103], v[58:61], 0
    v_mfma_f32_16x16x32_bf16 v[160:163], v[96:99], v[56:59], 0
    v_mfma_f32_16x16x32_bf16 v[164:167], v[100:103], v[56:59], 0
    s_waitcnt lgkmcnt(4)
    v_cvt_pk_bf16_f32 v184, v136, v137
    v_cvt_pk_bf16_f32 v185, v138, v139
    v_cvt_pk_bf16_f32 v186, v140, v141
    v_cvt_pk_bf16_f32 v187, v142, v143
    v_cvt_pk_bf16_f32 v188, v144, v145
    v_cvt_pk_bf16_f32 v189, v146, v147
    v_cvt_pk_bf16_f32 v190, v148, v149
    v_cvt_pk_bf16_f32 v191, v150, v151
    ds_write_b128 v2, v[184:187] offset:24576
    ds_write_b128 v2, v[188:191] offset:25600
    buffer_store_dwordx4 v[184:187], v3, s[44:47], s50 offen offset:0
    buffer_store_dwordx4 v[188:191], v3, s[44:47], s50 offen offset:1024
    v_mfma_f32_16x16x32_bf16 v[168:171], v[104:107], v[58:61], 0
    v_mfma_f32_16x16x32_bf16 v[172:175], v[108:111], v[58:61], 0
    v_mfma_f32_16x16x32_bf16 v[176:179], v[104:107], v[56:59], 0
    v_mfma_f32_16x16x32_bf16 v[180:183], v[108:111], v[56:59], 0
    s_waitcnt lgkmcnt(4)
    v_cvt_pk_bf16_f32 v192, v152, v153
    v_cvt_pk_bf16_f32 v193, v154, v155
    v_cvt_pk_bf16_f32 v194, v156, v157
    v_cvt_pk_bf16_f32 v195, v158, v159
    v_cvt_pk_bf16_f32 v196, v160, v161
    v_cvt_pk_bf16_f32 v197, v162, v163
    v_cvt_pk_bf16_f32 v198, v164, v165
    v_cvt_pk_bf16_f32 v199, v166, v167
    ds_write_b128 v2, v[192:195] offset:26624
    ds_write_b128 v2, v[196:199] offset:27648
    buffer_store_dwordx4 v[192:195], v3, s[44:47], s50 offen offset:2048
    buffer_store_dwordx4 v[196:199], v3, s[44:47], s50 offen offset:3072
    v_mfma_f32_16x16x32_bf16 v[136:139], v[112:115], v[58:61], 0
    v_mfma_f32_16x16x32_bf16 v[140:143], v[116:119], v[58:61], 0
    v_mfma_f32_16x16x32_bf16 v[144:147], v[112:115], v[56:59], 0
    v_mfma_f32_16x16x32_bf16 v[148:151], v[116:119], v[56:59], 0
    s_waitcnt lgkmcnt(4)
    v_cvt_pk_bf16_f32 v200, v168, v169
    v_cvt_pk_bf16_f32 v201, v170, v171
    v_cvt_pk_bf16_f32 v202, v172, v173
    v_cvt_pk_bf16_f32 v203, v174, v175
    v_cvt_pk_bf16_f32 v204, v176, v177
    v_cvt_pk_bf16_f32 v205, v178, v179
    v_cvt_pk_bf16_f32 v206, v180, v181
    v_cvt_pk_bf16_f32 v207, v182, v183
    ds_write_b128 v2, v[200:203] offset:28672
    ds_write_b128 v2, v[204:207] offset:29696
    buffer_store_dwordx4 v[200:203], v3, s[44:47], s51 offen offset:0
    buffer_store_dwordx4 v[204:207], v3, s[44:47], s51 offen offset:1024
    v_mfma_f32_16x16x32_bf16 v[152:155], v[120:123], v[58:61], 0
    v_mfma_f32_16x16x32_bf16 v[156:159], v[124:127], v[58:61], 0
    v_mfma_f32_16x16x32_bf16 v[160:163], v[120:123], v[56:59], 0
    v_mfma_f32_16x16x32_bf16 v[164:167], v[124:127], v[56:59], 0
    s_waitcnt lgkmcnt(4)
    v_cvt_pk_bf16_f32 v184, v136, v137
    v_cvt_pk_bf16_f32 v185, v138, v139
    v_cvt_pk_bf16_f32 v186, v140, v141
    v_cvt_pk_bf16_f32 v187, v142, v143
    v_cvt_pk_bf16_f32 v188, v144, v145
    v_cvt_pk_bf16_f32 v189, v146, v147
    v_cvt_pk_bf16_f32 v190, v148, v149
    v_cvt_pk_bf16_f32 v191, v150, v151
    buffer_store_dwordx4 v[184:187], v3, s[44:47], s52 offen offset:0
    buffer_store_dwordx4 v[188:191], v3, s[44:47], s52 offen offset:1024
    v_mfma_f32_16x16x32_bf16 v[168:171], v[128:131], v[58:61], 0
    v_mfma_f32_16x16x32_bf16 v[172:175], v[132:135], v[58:61], 0
    v_mfma_f32_16x16x32_bf16 v[176:179], v[128:131], v[56:59], 0
    v_mfma_f32_16x16x32_bf16 v[180:183], v[132:135], v[56:59], 0
    s_waitcnt lgkmcnt(0)
    v_cvt_pk_bf16_f32 v192, v152, v153
    v_cvt_pk_bf16_f32 v193, v154, v155
    v_cvt_pk_bf16_f32 v194, v156, v157
    v_cvt_pk_bf16_f32 v195, v158, v159
    v_cvt_pk_bf16_f32 v196, v160, v161
    v_cvt_pk_bf16_f32 v197, v162, v163
    v_cvt_pk_bf16_f32 v198, v164, v165
    v_cvt_pk_bf16_f32 v199, v166, v167
    buffer_store_dwordx4 v[192:195], v3, s[44:47], s52 offen offset:2048
    buffer_store_dwordx4 v[196:199], v3, s[44:47], s52 offen offset:3072
    v_cvt_pk_bf16_f32 v200, v168, v169
    v_cvt_pk_bf16_f32 v201, v170, v171
    v_cvt_pk_bf16_f32 v202, v172, v173
    v_cvt_pk_bf16_f32 v203, v174, v175
    v_cvt_pk_bf16_f32 v204, v176, v177
    v_cvt_pk_bf16_f32 v205, v178, v179
    v_cvt_pk_bf16_f32 v206, v180, v181
    v_cvt_pk_bf16_f32 v207, v182, v183
    buffer_store_dwordx4 v[200:203], v3, s[44:47], s53 offen offset:0
    buffer_store_dwordx4 v[204:207], v3, s[44:47], s53 offen offset:1024
    s_waitcnt lgkmcnt(0)
    s_barrier
    s_branch L_conv0
L_join:
    v_pk_fma_f16 v128, v184, v184, s25
    v_pk_fma_f16 v129, v185, v185, s25
    v_pk_fma_f16 v130, v186, v186, s25
    v_pk_fma_f16 v131, v187, v187, s25
    v_pk_fma_f16 v132, v188, v188, s25
    v_pk_fma_f16 v133, v189, v189, s25
    v_pk_fma_f16 v134, v190, v190, s25
    v_pk_fma_f16 v135, v191, v191, s25
    v_pk_mul_f16 v128, v128, v184
    v_pk_mul_f16 v129, v129, v185
    v_pk_mul_f16 v130, v130, v186
    v_pk_mul_f16 v131, v131, v187
    v_pk_mul_f16 v132, v132, v188
    v_pk_mul_f16 v133, v133, v189
    v_pk_mul_f16 v134, v134, v190
    v_pk_mul_f16 v135, v135, v191
    v_exp_f16_sdwa v128, -v128 dst_sel:WORD_0 dst_unused:UNUSED_PRESERVE src0_sel:WORD_0
    v_exp_f16_sdwa v129, -v129 dst_sel:WORD_0 dst_unused:UNUSED_PRESERVE src0_sel:WORD_0
    v_exp_f16_sdwa v130, -v130 dst_sel:WORD_0 dst_unused:UNUSED_PRESERVE src0_sel:WORD_0
    v_exp_f16_sdwa v131, -v131 dst_sel:WORD_0 dst_unused:UNUSED_PRESERVE src0_sel:WORD_0
    v_exp_f16_sdwa v132, -v132 dst_sel:WORD_0 dst_unused:UNUSED_PRESERVE src0_sel:WORD_0
    v_exp_f16_sdwa v133, -v133 dst_sel:WORD_0 dst_unused:UNUSED_PRESERVE src0_sel:WORD_0
    v_exp_f16_sdwa v134, -v134 dst_sel:WORD_0 dst_unused:UNUSED_PRESERVE src0_sel:WORD_0
    v_exp_f16_sdwa v135, -v135 dst_sel:WORD_0 dst_unused:UNUSED_PRESERVE src0_sel:WORD_0
    v_exp_f16_sdwa v128, -v128 dst_sel:WORD_1 dst_unused:UNUSED_PRESERVE src0_sel:WORD_1
    v_exp_f16_sdwa v129, -v129 dst_sel:WORD_1 dst_unused:UNUSED_PRESERVE src0_sel:WORD_1
    v_exp_f16_sdwa v130, -v130 dst_sel:WORD_1 dst_unused:UNUSED_PRESERVE src0_sel:WORD_1
    v_exp_f16_sdwa v131, -v131 dst_sel:WORD_1 dst_unused:UNUSED_PRESERVE src0_sel:WORD_1
    v_exp_f16_sdwa v132, -v132 dst_sel:WORD_1 dst_unused:UNUSED_PRESERVE src0_sel:WORD_1
    v_exp_f16_sdwa v133, -v133 dst_sel:WORD_1 dst_unused:UNUSED_PRESERVE src0_sel:WORD_1
    v_exp_f16_sdwa v134, -v134 dst_sel:WORD_1 dst_unused:UNUSED_PRESERVE src0_sel:WORD_1
    v_exp_f16_sdwa v135, -v135 dst_sel:WORD_1 dst_unused:UNUSED_PRESERVE src0_sel:WORD_1
    v_pk_fma_f16 v128, v128, s27, s27
    v_pk_fma_f16 v129, v129, s27, s27
    v_pk_fma_f16 v130, v130, s27, s27
    v_pk_fma_f16 v131, v131, s27, s27
    v_pk_fma_f16 v132, v132, s27, s27
    v_pk_fma_f16 v133, v133, s27, s27
    v_pk_fma_f16 v134, v134, s27, s27
    v_pk_fma_f16 v135, v135, s27, s27
    v_rcp_f16_sdwa v128, v128 dst_sel:WORD_0 dst_unused:UNUSED_PRESERVE src0_sel:WORD_0
    v_rcp_f16_sdwa v129, v129 dst_sel:WORD_0 dst_unused:UNUSED_PRESERVE src0_sel:WORD_0
    v_rcp_f16_sdwa v130, v130 dst_sel:WORD_0 dst_unused:UNUSED_PRESERVE src0_sel:WORD_0
    v_rcp_f16_sdwa v131, v131 dst_sel:WORD_0 dst_unused:UNUSED_PRESERVE src0_sel:WORD_0
    v_rcp_f16_sdwa v132, v132 dst_sel:WORD_0 dst_unused:UNUSED_PRESERVE src0_sel:WORD_0
    v_rcp_f16_sdwa v133, v133 dst_sel:WORD_0 dst_unused:UNUSED_PRESERVE src0_sel:WORD_0
    v_rcp_f16_sdwa v134, v134 dst_sel:WORD_0 dst_unused:UNUSED_PRESERVE src0_sel:WORD_0
    v_rcp_f16_sdwa v135, v135 dst_sel:WORD_0 dst_unused:UNUSED_PRESERVE src0_sel:WORD_0
    v_rcp_f16_sdwa v128, v128 dst_sel:WORD_1 dst_unused:UNUSED_PRESERVE src0_sel:WORD_1
    v_rcp_f16_sdwa v129, v129 dst_sel:WORD_1 dst_unused:UNUSED_PRESERVE src0_sel:WORD_1
    v_rcp_f16_sdwa v130, v130 dst_sel:WORD_1 dst_unused:UNUSED_PRESERVE src0_sel:WORD_1
    v_rcp_f16_sdwa v131, v131 dst_sel:WORD_1 dst_unused:UNUSED_PRESERVE src0_sel:WORD_1
    v_rcp_f16_sdwa v132, v132 dst_sel:WORD_1 dst_unused:UNUSED_PRESERVE src0_sel:WORD_1
    v_rcp_f16_sdwa v133, v133 dst_sel:WORD_1 dst_unused:UNUSED_PRESERVE src0_sel:WORD_1
    v_rcp_f16_sdwa v134, v134 dst_sel:WORD_1 dst_unused:UNUSED_PRESERVE src0_sel:WORD_1
    v_rcp_f16_sdwa v135, v135 dst_sel:WORD_1 dst_unused:UNUSED_PRESERVE src0_sel:WORD_1
    v_fma_mix_f32 v144, v128, v184, 0 op_sel_hi:[1,1,0]
    v_fma_mix_f32 v128, v128, v184, 0 op_sel:[1,1,0] op_sel_hi:[1,1,0]
    v_fma_mix_f32 v145, v129, v185, 0 op_sel_hi:[1,1,0]
    v_fma_mix_f32 v129, v129, v185, 0 op_sel:[1,1,0] op_sel_hi:[1,1,0]
    v_fma_mix_f32 v146, v130, v186, 0 op_sel_hi:[1,1,0]
    v_fma_mix_f32 v130, v130, v186, 0 op_sel:[1,1,0] op_sel_hi:[1,1,0]
    v_fma_mix_f32 v147, v131, v187, 0 op_sel_hi:[1,1,0]
    v_fma_mix_f32 v131, v131, v187, 0 op_sel:[1,1,0] op_sel_hi:[1,1,0]
    v_fma_mix_f32 v148, v132, v188, 0 op_sel_hi:[1,1,0]
    v_fma_mix_f32 v132, v132, v188, 0 op_sel:[1,1,0] op_sel_hi:[1,1,0]
    v_fma_mix_f32 v149, v133, v189, 0 op_sel_hi:[1,1,0]
    v_fma_mix_f32 v133, v133, v189, 0 op_sel:[1,1,0] op_sel_hi:[1,1,0]
    v_fma_mix_f32 v150, v134, v190, 0 op_sel_hi:[1,1,0]
    v_fma_mix_f32 v134, v134, v190, 0 op_sel:[1,1,0] op_sel_hi:[1,1,0]
    v_fma_mix_f32 v151, v135, v191, 0 op_sel_hi:[1,1,0]
    v_fma_mix_f32 v135, v135, v191, 0 op_sel:[1,1,0] op_sel_hi:[1,1,0]
    v_cvt_pk_bf16_f32 v184, v144, v128
    v_cvt_pk_bf16_f32 v185, v145, v129
    v_cvt_pk_bf16_f32 v186, v146, v130
    v_cvt_pk_bf16_f32 v187, v147, v131
    v_cvt_pk_bf16_f32 v188, v148, v132
    v_cvt_pk_bf16_f32 v189, v149, v133
    v_cvt_pk_bf16_f32 v190, v150, v134
    v_cvt_pk_bf16_f32 v191, v151, v135
    s_waitcnt vmcnt(0)
    s_barrier
    ds_write_b128 v192, v[176:179] offset:0
    ds_write_b128 v192, v[180:183] offset:4096
    ds_write_b128 v192, v[184:187] offset:8192
    ds_write_b128 v192, v[188:191] offset:12288
    v_mov_b32 v1, 150784
    v_mov_b32 v2, 0
    ds_write_b32 v1, v2 offset:0
L_conv0:
    s_add_u32 m0, s34, 0
    s_nop 0
    buffer_load_dwordx4 v54, s[36:39], 0 offen offset:0 lds
    s_add_u32 m0, s34, 5760
    s_nop 0
    buffer_load_dwordx4 v54, s[36:39], 0 offen offset:384 lds
    s_add_u32 m0, s34, 12224
    s_nop 0
    buffer_load_dwordx4 v54, s[36:39], 0 offen offset:64 lds
    s_add_u32 m0, s34, 17984
    s_nop 0
    buffer_load_dwordx4 v54, s[36:39], 0 offen offset:448 lds
    ds_read_b64 v[64:65], v47 offset:0
    ds_read_b64 v[66:67], v47 offset:8
    ds_read_b64 v[68:69], v47 offset:64
    ds_read_b64 v[70:71], v47 offset:72
    ds_read_b64 v[72:73], v47 offset:128
    ds_read_b64 v[74:75], v47 offset:136
    ds_read_b64 v[76:77], v48 offset:0
    ds_read_b64 v[78:79], v48 offset:8
    ds_read_b64 v[80:81], v48 offset:64
    ds_read_b64 v[82:83], v48 offset:72
    ds_read_b64 v[84:85], v48 offset:128
    ds_read_b64 v[86:87], v48 offset:136
    v_add_u32 v3, v41, v45
    s_waitcnt lgkmcnt(4)
    ds_read_b64 v[200:201], v41 offset:0
    ds_read_b64 v[202:203], v41 offset:192
    ds_read_b64 v[204:205], v41 offset:3840
    ds_read_b64 v[206:207], v41 offset:4032
    ds_read_b64 v[208:209], v41 offset:7680
    ds_read_b64 v[210:211], v41 offset:7872
    ds_read_b64 v[212:213], v41 offset:11520
    ds_read_b64 v[214:215], v41 offset:11712
    s_waitcnt lgkmcnt(8)
    s_barrier
    v_mfma_f32_16x16x32_bf16 v[128:131], v[58:61], v[64:67], 0
    ds_read_b64 v[216:217], v3 offset:0
    v_mfma_f32_16x16x32_bf16 v[132:135], v[56:59], v[64:67], 0
    ds_read_b64 v[218:219], v3 offset:192
    v_mfma_f32_16x16x32_bf16 v[144:147], v[58:61], v[68:71], 0
    ds_read_b64 v[220:221], v3 offset:3840
    v_mfma_f32_16x16x32_bf16 v[148:151], v[56:59], v[68:71], 0
    ds_read_b64 v[222:223], v3 offset:4032
    v_mfma_f32_16x16x32_bf16 v[160:163], v[58:61], v[72:75], 0
    ds_read_b64 v[224:225], v3 offset:7680
    v_mfma_f32_16x16x32_bf16 v[164:167], v[56:59], v[72:75], 0
    ds_read_b64 v[226:227], v3 offset:7872
    v_mfma_f32_16x16x32_bf16 v[136:139], v[58:61], v[76:79], 0
    ds_read_b64 v[228:229], v3 offset:11520
    v_mfma_f32_16x16x32_bf16 v[140:143], v[56:59], v[76:79], 0
    ds_read_b64 v[230:231], v3 offset:11712
    v_mfma_f32_16x16x32_bf16 v[152:155], v[58:61], v[80:83], 0
    v_mfma_f32_16x16x32_bf16 v[156:159], v[56:59], v[80:83], 0
    v_mfma_f32_16x16x32_bf16 v[168:171], v[58:61], v[84:87], 0
    v_mfma_f32_16x16x32_bf16 v[172:175], v[56:59], v[84:87], 0
    s_waitcnt lgkmcnt(0)
    s_setprio 2
    v_mfma_f32_16x16x32_bf16 v[112:115], v[4:7], v[216:219], 0
    v_add_u32 v3, v42, v45
    v_add_u32 v72, v41, v44
    v_add_u32 v73, v72, v45
    ds_read_b64 v[80:81], v42 offset:0
    ds_read_b64 v[82:83], v42 offset:192
    v_smfmac_f32_16x16x64_bf16 v[112:115], v[8:11], v[200:207], v40
    ds_read_b64 v[84:85], v42 offset:3840
    ds_read_b64 v[86:87], v42 offset:4032
    v_smfmac_f32_16x16x64_bf16 v[112:115], v[12:15], v[208:215], v40
    ds_read_b64 v[88:89], v42 offset:7680
    ds_read_b64 v[90:91], v42 offset:7872
    v_mfma_f32_16x16x32_bf16 v[116:119], v[4:7], v[220:223], 0
    ds_read_b64 v[92:93], v42 offset:11520
    ds_read_b64 v[94:95], v42 offset:11712
    v_smfmac_f32_16x16x64_bf16 v[116:119], v[8:11], v[204:211], v40
    ds_read_b64 v[96:97], v3 offset:0
    ds_read_b64 v[98:99], v3 offset:192
    v_smfmac_f32_16x16x64_bf16 v[116:119], v[12:15], v[212:219], v40
    ds_read_b64 v[100:101], v3 offset:3840
    ds_read_b64 v[102:103], v3 offset:4032
    v_cvt_pk_bf16_f32 v64, v112, v113
    v_cvt_pk_bf16_f32 v65, v114, v115
    ds_write_b64 v72, v[64:65] offset:7680
    v_mfma_f32_16x16x32_bf16 v[120:123], v[4:7], v[224:227], 0
    ds_read_b64 v[104:105], v3 offset:7680
    v_smfmac_f32_16x16x64_bf16 v[120:123], v[8:11], v[208:215], v40
    ds_read_b64 v[106:107], v3 offset:7872
    v_smfmac_f32_16x16x64_bf16 v[120:123], v[12:15], v[216:223], v40
    ds_read_b64 v[108:109], v3 offset:11520
    v_cvt_pk_bf16_f32 v66, v116, v117
    v_cvt_pk_bf16_f32 v67, v118, v119
    ds_write_b64 v72, v[66:67] offset:11520
    v_mfma_f32_16x16x32_bf16 v[124:127], v[4:7], v[228:231], 0
    ds_read_b64 v[110:111], v3 offset:11712
    v_smfmac_f32_16x16x64_bf16 v[124:127], v[8:11], v[212:219], v40
    v_smfmac_f32_16x16x64_bf16 v[124:127], v[12:15], v[220:227], v40
    v_cvt_pk_bf16_f32 v68, v120, v121
    v_cvt_pk_bf16_f32 v69, v122, v123
    ds_write_b64 v73, v[68:69] offset:0
    s_waitcnt lgkmcnt(1)
    s_setprio 1
    v_mfma_f32_16x16x32_bf16 v[112:115], v[16:19], v[96:99], 0
    v_add_u32 v3, v43, v45
    v_add_u32 v74, v42, v44
    v_add_u32 v75, v74, v45
    ds_read_b64 v[200:201], v43 offset:0
    ds_read_b64 v[202:203], v43 offset:192
    v_smfmac_f32_16x16x64_bf16 v[112:115], v[20:23], v[80:87], v40
    ds_read_b64 v[204:205], v43 offset:3840
    ds_read_b64 v[206:207], v43 offset:4032
    v_smfmac_f32_16x16x64_bf16 v[112:115], v[24:27], v[88:95], v40
    ds_read_b64 v[208:209], v43 offset:7680
    ds_read_b64 v[210:211], v43 offset:7872
    v_cvt_pk_bf16_f32 v70, v124, v125
    v_cvt_pk_bf16_f32 v71, v126, v127
    ds_write_b64 v73, v[70:71] offset:3840
    v_mfma_f32_16x16x32_bf16 v[116:119], v[16:19], v[100:103], 0
    ds_read_b64 v[212:213], v43 offset:11520
    ds_read_b64 v[214:215], v43 offset:11712
    v_smfmac_f32_16x16x64_bf16 v[116:119], v[20:23], v[84:91], v40
    ds_read_b64 v[216:217], v3 offset:0
    ds_read_b64 v[218:219], v3 offset:192
    v_smfmac_f32_16x16x64_bf16 v[116:119], v[24:27], v[92:99], v40
    ds_read_b64 v[220:221], v3 offset:3840
    ds_read_b64 v[222:223], v3 offset:4032
    v_cvt_pk_bf16_f32 v64, v112, v113
    v_cvt_pk_bf16_f32 v65, v114, v115
    ds_write_b64 v74, v[64:65] offset:7680
    v_mfma_f32_16x16x32_bf16 v[120:123], v[16:19], v[104:107], 0
    ds_read_b64 v[224:225], v3 offset:7680
    v_smfmac_f32_16x16x64_bf16 v[120:123], v[20:23], v[88:95], v40
    ds_read_b64 v[226:227], v3 offset:7872
    v_smfmac_f32_16x16x64_bf16 v[120:123], v[24:27], v[96:103], v40
    ds_read_b64 v[228:229], v3 offset:11520
    v_cvt_pk_bf16_f32 v66, v116, v117
    v_cvt_pk_bf16_f32 v67, v118, v119
    ds_write_b64 v74, v[66:67] offset:11520
    v_mfma_f32_16x16x32_bf16 v[124:127], v[16:19], v[108:111], 0
    ds_read_b64 v[230:231], v3 offset:11712
    v_smfmac_f32_16x16x64_bf16 v[124:127], v[20:23], v[92:99], v40
    v_smfmac_f32_16x16x64_bf16 v[124:127], v[24:27], v[100:107], v40
    v_cvt_pk_bf16_f32 v68, v120, v121
    v_cvt_pk_bf16_f32 v69, v122, v123
    ds_write_b64 v75, v[68:69] offset:0
    s_waitcnt lgkmcnt(1)
    s_setprio 0
    v_mfma_f32_16x16x32_bf16 v[112:115], v[28:31], v[216:219], 0
    v_add_u32 v72, v43, v44
    v_add_u32 v73, v72, v45
    v_smfmac_f32_16x16x64_bf16 v[112:115], v[32:35], v[200:207], v40
    v_smfmac_f32_16x16x64_bf16 v[112:115], v[36:39], v[208:215], v40
    v_cvt_pk_bf16_f32 v70, v124, v125
    v_cvt_pk_bf16_f32 v71, v126, v127
    ds_write_b64 v75, v[70:71] offset:3840
    v_mfma_f32_16x16x32_bf16 v[116:119], v[28:31], v[220:223], 0
    v_smfmac_f32_16x16x64_bf16 v[116:119], v[32:35], v[204:211], v40
    v_smfmac_f32_16x16x64_bf16 v[116:119], v[36:39], v[212:219], v40
    s_nop 1
    v_cvt_pk_bf16_f32 v64, v112, v113
    v_cvt_pk_bf16_f32 v65, v114, v115
    ds_write_b64 v72, v[64:65] offset:7680
    v_mfma_f32_16x16x32_bf16 v[120:123], v[28:31], v[224:227], 0
    v_smfmac_f32_16x16x64_bf16 v[120:123], v[32:35], v[208:215], v40
    v_smfmac_f32_16x16x64_bf16 v[120:123], v[36:39], v[216:223], v40
    v_cvt_pk_bf16_f32 v66, v116, v117
    v_cvt_pk_bf16_f32 v67, v118, v119
    ds_write_b64 v72, v[66:67] offset:11520
    v_mfma_f32_16x16x32_bf16 v[124:127], v[28:31], v[228:231], 0
    v_smfmac_f32_16x16x64_bf16 v[124:127], v[32:35], v[212:219], v40
    v_smfmac_f32_16x16x64_bf16 v[124:127], v[36:39], v[220:227], v40
    s_nop 1
    v_cvt_pk_bf16_f32 v68, v120, v121
    v_cvt_pk_bf16_f32 v69, v122, v123
    ds_write_b64 v73, v[68:69] offset:0
    s_nop 2
    v_cvt_pk_bf16_f32 v70, v124, v125
    v_cvt_pk_bf16_f32 v71, v126, v127
    ds_write_b64 v73, v[70:71] offset:3840
    s_waitcnt vmcnt(0) lgkmcnt(0)
    s_barrier
    ds_read_b64_tr_b16 v[176:177], v49 offset:0
    ds_read_b64_tr_b16 v[178:179], v49 offset:256
    ds_read_b64_tr_b16 v[180:181], v62 offset:0
    ds_read_b64_tr_b16 v[182:183], v62 offset:256
    ds_read_b64_tr_b16 v[184:185], v49 offset:2048
    ds_read_b64_tr_b16 v[186:187], v49 offset:2304
    ds_read_b64_tr_b16 v[188:189], v62 offset:2048
    ds_read_b64_tr_b16 v[190:191], v62 offset:2304
    ds_read_b64_tr_b16 v[192:193], v49 offset:4096
    ds_read_b64_tr_b16 v[194:195], v49 offset:4352
    ds_read_b64_tr_b16 v[196:197], v62 offset:4096
    ds_read_b64_tr_b16 v[198:199], v62 offset:4352
    s_waitcnt lgkmcnt(2)
    ds_read_b64 v[64:65], v47 offset:0
    ds_read_b64 v[66:67], v47 offset:8
    ds_read_b64 v[68:69], v47 offset:64
    ds_read_b64 v[70:71], v47 offset:72
    ds_read_b64 v[72:73], v47 offset:128
    ds_read_b64 v[74:75], v47 offset:136
    ds_read_b64 v[76:77], v48 offset:0
    ds_read_b64 v[78:79], v48 offset:8
    ds_read_b64 v[80:81], v48 offset:64
    ds_read_b64 v[82:83], v48 offset:72
    ds_read_b64 v[84:85], v48 offset:128
    ds_read_b64 v[86:87], v48 offset:136
    s_cmp_lg_u32 s19, 0
    s_cbranch_scc1 L_stats_s
    s_branch L_stats
.p2align 6
L_stats:
    s_setprio 3
    s_waitcnt lgkmcnt(10)
    v_dot2_f32_bf16 v0, v64, s26, 0
    v_dot2_f32_bf16 v2, v64, v64, 0
    v_dot2_f32_bf16 v0, v65, s26, v0
    v_dot2_f32_bf16 v2, v65, v65, v2
    v_dot2_f32_bf16 v0, v66, s26, v0
    v_dot2_f32_bf16 v2, v66, v66, v2
    v_dot2_f32_bf16 v0, v67, s26, v0
    v_dot2_f32_bf16 v2, v67, v67, v2
    s_waitcnt lgkmcnt(8)
    v_dot2_f32_bf16 v0, v68, s26, v0
    v_dot2_f32_bf16 v2, v68, v68, v2
    v_dot2_f32_bf16 v0, v69, s26, v0
    v_dot2_f32_bf16 v2, v69, v69, v2
    v_dot2_f32_bf16 v0, v70, s26, v0
    v_dot2_f32_bf16 v2, v70, v70, v2
    v_dot2_f32_bf16 v0, v71, s26, v0
    v_dot2_f32_bf16 v2, v71, v71, v2
    s_waitcnt lgkmcnt(6)
    v_dot2_f32_bf16 v0, v72, s26, v0
    v_dot2_f32_bf16 v2, v72, v72, v2
    v_dot2_f32_bf16 v0, v73, s26, v0
    v_dot2_f32_bf16 v2, v73, v73, v2
    v_dot2_f32_bf16 v0, v74, s26, v0
    v_dot2_f32_bf16 v2, v74, v74, v2
    v_dot2_f32_bf16 v0, v75, s26, v0
    v_dot2_f32_bf16 v2, v75, v75, v2
    s_waitcnt lgkmcnt(4)
    v_dot2_f32_bf16 v1, v76, s26, 0
    v_dot2_f32_bf16 v3, v76, v76, 0
    v_dot2_f32_bf16 v1, v77, s26, v1
    v_dot2_f32_bf16 v3, v77, v77, v3
    v_dot2_f32_bf16 v1, v78, s26, v1
    v_dot2_f32_bf16 v3, v78, v78, v3
    v_dot2_f32_bf16 v1, v79, s26, v1
    v_dot2_f32_bf16 v3, v79, v79, v3
    s_waitcnt lgkmcnt(2)
    v_dot2_f32_bf16 v1, v80, s26, v1
    v_dot2_f32_bf16 v3, v80, v80, v3
    v_dot2_f32_bf16 v1, v81, s26, v1
    v_dot2_f32_bf16 v3, v81, v81, v3
    v_dot2_f32_bf16 v1, v82, s26, v1
    v_dot2_f32_bf16 v3, v82, v82, v3
    v_dot2_f32_bf16 v1, v83, s26, v1
    v_dot2_f32_bf16 v3, v83, v83, v3
    s_waitcnt lgkmcnt(0)
    v_dot2_f32_bf16 v1, v84, s26, v1
    v_dot2_f32_bf16 v3, v84, v84, v3
    v_dot2_f32_bf16 v1, v85, s26, v1
    v_dot2_f32_bf16 v3, v85, v85, v3
    v_dot2_f32_bf16 v1, v86, s26, v1
    v_dot2_f32_bf16 v3, v86, v86, v3
    v_dot2_f32_bf16 v1, v87, s26, v1
    v_dot2_f32_bf16 v3, v87, v87, v3
    s_nop 1
    v_permlane32_swap_b32 v0, v1
    v_permlane32_swap_b32 v2, v3
    v_add_f32 v0, v0, v1
    v_add_f32 v2, v2, v3
    s_nop 1
    v_permlane16_swap_b32 v0, v2
    v_add_f32 v0, v0, v2
    v_mov_b32 v1, v0
    v_mov_b32 v2, s29
    s_nop 0
    v_permlane16_swap_b32 v0, v1
    v_mul_f32 v0, s28, v0
    v_fma_f32 v1, v1, s28, v2
    v_fma_f32 v1, -v0, v0, v1
    v_max_f32 v1, v1, v2
    v_rsq_f32 v1, v1
    s_nop 0
    v_mul_f32 v1, s30, v1
    v_cvt_pk_bf16_f32 v2, 0, v1
    v_mul_f32 v0, -v0, v2
    v_mov_b32 v3, v2
    v_mov_b32 v1, v0
    s_nop 0
    v_permlane32_swap_b32 v2, v3
    v_permlane32_swap_b32 v0, v1
    v_lshrrev_b32 v224, 16, v2
    v_lshrrev_b32 v225, 16, v3
    s_setprio 2
    v_dot2_f32_bf16 v88, v64, v224, v0
    v_dot2_f32_bf16 v89, v64, v2, v0
    v_dot2_f32_bf16 v90, v65, v224, v0
    v_dot2_f32_bf16 v91, v65, v2, v0
    v_dot2_f32_bf16 v92, v66, v224, v0
    v_dot2_f32_bf16 v93, v66, v2, v0
    v_dot2_f32_bf16 v94, v67, v224, v0
    v_dot2_f32_bf16 v95, v67, v2, v0
    v_dot2_f32_bf16 v96, v68, v224, v0
    v_dot2_f32_bf16 v97, v68, v2, v0
    v_dot2_f32_bf16 v98, v69, v224, v0
    v_dot2_f32_bf16 v99, v69, v2, v0
    v_dot2_f32_bf16 v100, v70, v224, v0
    v_dot2_f32_bf16 v101, v70, v2, v0
    v_dot2_f32_bf16 v102, v71, v224, v0
    v_dot2_f32_bf16 v103, v71, v2, v0
    v_cvt_pk_bf16_f32 v64, v88, v89
    v_cvt_pk_bf16_f32 v65, v90, v91
    v_cvt_pk_bf16_f32 v66, v92, v93
    v_cvt_pk_bf16_f32 v67, v94, v95
    s_setprio 1
    v_dot2_f32_bf16 v104, v72, v224, v0
    v_dot2_f32_bf16 v105, v72, v2, v0
    v_dot2_f32_bf16 v106, v73, v224, v0
    v_dot2_f32_bf16 v107, v73, v2, v0
    v_dot2_f32_bf16 v108, v74, v224, v0
    v_dot2_f32_bf16 v109, v74, v2, v0
    v_dot2_f32_bf16 v110, v75, v224, v0
    v_dot2_f32_bf16 v111, v75, v2, v0
    v_cvt_pk_bf16_f32 v68, v96, v97
    v_cvt_pk_bf16_f32 v69, v98, v99
    v_cvt_pk_bf16_f32 v70, v100, v101
    v_cvt_pk_bf16_f32 v71, v102, v103
    v_dot2_f32_bf16 v88, v76, v225, v1
    v_dot2_f32_bf16 v89, v76, v3, v1
    v_dot2_f32_bf16 v90, v77, v225, v1
    v_dot2_f32_bf16 v91, v77, v3, v1
    v_dot2_f32_bf16 v92, v78, v225, v1
    v_dot2_f32_bf16 v93, v78, v3, v1
    v_dot2_f32_bf16 v94, v79, v225, v1
    v_dot2_f32_bf16 v95, v79, v3, v1
    v_cvt_pk_bf16_f32 v72, v104, v105
    v_cvt_pk_bf16_f32 v73, v106, v107
    v_cvt_pk_bf16_f32 v74, v108, v109
    v_cvt_pk_bf16_f32 v75, v110, v111
    s_setprio 0
    v_dot2_f32_bf16 v96, v80, v225, v1
    v_dot2_f32_bf16 v97, v80, v3, v1
    v_dot2_f32_bf16 v98, v81, v225, v1
    v_dot2_f32_bf16 v99, v81, v3, v1
    v_dot2_f32_bf16 v100, v82, v225, v1
    v_dot2_f32_bf16 v101, v82, v3, v1
    v_dot2_f32_bf16 v102, v83, v225, v1
    v_dot2_f32_bf16 v103, v83, v3, v1
    v_cvt_pk_bf16_f32 v76, v88, v89
    v_cvt_pk_bf16_f32 v77, v90, v91
    v_cvt_pk_bf16_f32 v78, v92, v93
    v_cvt_pk_bf16_f32 v79, v94, v95
    v_dot2_f32_bf16 v104, v84, v225, v1
    v_dot2_f32_bf16 v105, v84, v3, v1
    v_dot2_f32_bf16 v106, v85, v225, v1
    v_dot2_f32_bf16 v107, v85, v3, v1
    v_dot2_f32_bf16 v108, v86, v225, v1
    v_dot2_f32_bf16 v109, v86, v3, v1
    v_dot2_f32_bf16 v110, v87, v225, v1
    v_dot2_f32_bf16 v111, v87, v3, v1
    v_cvt_pk_bf16_f32 v80, v96, v97
    v_cvt_pk_bf16_f32 v81, v98, v99
    v_cvt_pk_bf16_f32 v82, v100, v101
    v_cvt_pk_bf16_f32 v83, v102, v103
    v_mfma_f32_16x16x32_bf16 v[112:115], v[176:179], v[64:67], 0
    v_mov_b32 v0, 0x20000
    v_mfma_f32_16x16x32_bf16 v[116:119], v[180:183], v[64:67], 0
    v_mov_b32 v1, 0x20000
    v_mfma_f32_16x16x32_bf16 v[112:115], v[184:187], v[68:71], v[112:115]
    v_cvt_pk_bf16_f32 v84, v104, v105
    v_cvt_pk_bf16_f32 v85, v106, v107
    v_cvt_pk_bf16_f32 v86, v108, v109
    v_cvt_pk_bf16_f32 v87, v110, v111
    v_mfma_f32_16x16x32_bf16 v[116:119], v[188:191], v[68:71], v[116:119]
    v_mfma_f32_16x16x32_bf16 v[112:115], v[192:195], v[72:75], v[112:115]
    v_mfma_f32_16x16x32_bf16 v[116:119], v[196:199], v[72:75], v[116:119]
    v_mfma_f32_16x16x32_bf16 v[120:123], v[176:179], v[76:79], 0
    ds_read_b64_tr_b16 v[176:177], v49 offset:6144
    ds_read_b64_tr_b16 v[178:179], v49 offset:6400
    v_mfma_f32_16x16x32_bf16 v[124:127], v[180:183], v[76:79], 0
    ds_read_b64_tr_b16 v[180:181], v62 offset:6144
    ds_read_b64_tr_b16 v[182:183], v62 offset:6400
    v_mfma_f32_16x16x32_bf16 v[120:123], v[184:187], v[80:83], v[120:123]
    ds_read_b64_tr_b16 v[184:185], v49 offset:8192
    ds_read_b64_tr_b16 v[186:187], v49 offset:8448
    v_mfma_f32_16x16x32_bf16 v[124:127], v[188:191], v[80:83], v[124:127]
    ds_read_b64_tr_b16 v[188:189], v62 offset:8192
    ds_read_b64_tr_b16 v[190:191], v62 offset:8448
    v_mfma_f32_16x16x32_bf16 v[120:123], v[192:195], v[84:87], v[120:123]
    ds_read_b64_tr_b16 v[192:193], v49 offset:10240
    ds_read_b64_tr_b16 v[194:195], v49 offset:10496
    v_mfma_f32_16x16x32_bf16 v[124:127], v[196:199], v[84:87], v[124:127]
    ds_read_b64_tr_b16 v[196:197], v62 offset:10240
    ds_read_b64_tr_b16 v[198:199], v62 offset:10496
    s_waitcnt vmcnt(3) lgkmcnt(0)
    s_barrier
    s_sub_u32 m0, s34, 6144
    s_movk_i32 s79, 6144
    buffer_load_dwordx4 v51, s[44:47], s79 offen offset:0 lds
    s_add_u32 m0, s34, -128
    s_setprio 0
    buffer_load_dwordx4 v54, s[36:39], 0 offen offset:128 lds
    v_cvt_pk_f16_f32 v88, v112, v113
    v_cvt_pk_f16_f32 v89, v114, v115
    v_cvt_pk_f16_f32 v90, v116, v117
    v_cvt_pk_f16_f32 v91, v118, v119
    v_cvt_pk_f16_f32 v92, v120, v121
    v_cvt_pk_f16_f32 v93, v122, v123
    v_cvt_pk_f16_f32 v94, v124, v125
    v_cvt_pk_f16_f32 v95, v126, v127
    v_mfma_f32_16x16x32_bf16 v[112:115], v[176:179], v[64:67], 0
    s_setprio 1
    v_and_b32 v88, s42, v88
    v_and_b32 v89, s42, v89
    v_and_b32 v90, s42, v90
    v_and_b32 v91, s42, v91
    v_mfma_f32_16x16x32_bf16 v[120:123], v[176:179], v[76:79], 0
    s_add_u32 m0, s34, 5632
    ds_read_b64_tr_b16 v[176:177], v49 offset:12288
    ds_read_b64_tr_b16 v[178:179], v49 offset:12544
    ds_read_b128 v[200:203], v50 offset:0
    buffer_load_dwordx4 v54, s[36:39], 0 offen offset:512 lds
    v_and_b32 v92, s42, v92
    v_pk_fma_f16 v109, v93, v93, s25
    v_pk_fma_f16 v110, v94, v94, s25
    v_pk_fma_f16 v111, v95, v95, s25
    v_lshrrev_b32_sdwa v0, 2, v88 dst_sel:WORD_0 dst_unused:UNUSED_PRESERVE src0_sel:DWORD src1_sel:WORD_0
    v_lshrrev_b32_sdwa v1, 2, v88 dst_sel:WORD_0 dst_unused:UNUSED_PRESERVE src0_sel:DWORD src1_sel:WORD_1
    v_mfma_f32_16x16x32_bf16 v[116:119], v[180:183], v[64:67], 0
    ds_read_u16 v104, v0 offset:20416
    ds_read_u16 v88, v1 offset:20416
    buffer_store_dwordx4 v[232:235], v55, s[8:11], s22 offen offset:0 sc0 sc1 nt
    v_pk_mul_f16 v109, v109, v93
    v_pk_mul_f16 v110, v110, v94
    v_pk_mul_f16 v111, v111, v95
    v_exp_f16_sdwa v109, -v109 dst_sel:WORD_0 dst_unused:UNUSED_PRESERVE src0_sel:WORD_0
    v_mfma_f32_16x16x32_bf16 v[124:127], v[180:183], v[76:79], 0
    ds_read_b64_tr_b16 v[180:181], v62 offset:12288
    ds_read_b64_tr_b16 v[182:183], v62 offset:12544
    ds_read_b128 v[204:207], v50 offset:1024
    s_setprio 2
    v_exp_f16_sdwa v110, -v110 dst_sel:WORD_0 dst_unused:UNUSED_PRESERVE src0_sel:WORD_0
    v_exp_f16_sdwa v111, -v111 dst_sel:WORD_0 dst_unused:UNUSED_PRESERVE src0_sel:WORD_0
    v_lshrrev_b32_sdwa v0, 2, v89 dst_sel:WORD_0 dst_unused:UNUSED_PRESERVE src0_sel:DWORD src1_sel:WORD_0
    v_lshrrev_b32_sdwa v1, 2, v89 dst_sel:WORD_0 dst_unused:UNUSED_PRESERVE src0_sel:DWORD src1_sel:WORD_1
    v_mfma_f32_16x16x32_bf16 v[112:115], v[184:187], v[68:71], v[112:115]
    ds_read_u16 v105, v0 offset:20416
    ds_read_u16 v89, v1 offset:20416
    s_add_u32 m0, s40, 0
    s_add_u32 s31, s16, 0
    buffer_load_dwordx4 v52, s[4:7], s31 offen offset:0 nt lds
    v_exp_f16_sdwa v109, -v109 dst_sel:WORD_1 dst_unused:UNUSED_PRESERVE src0_sel:WORD_1
    v_exp_f16_sdwa v110, -v110 dst_sel:WORD_1 dst_unused:UNUSED_PRESERVE src0_sel:WORD_1
    v_mfma_f32_16x16x32_bf16 v[120:123], v[184:187], v[80:83], v[120:123]
    ds_read_b64_tr_b16 v[184:185], v49 offset:14336
    ds_read_b64_tr_b16 v[186:187], v49 offset:14592
    ds_read_b128 v[208:211], v50 offset:2048
    v_exp_f16_sdwa v111, -v111 dst_sel:WORD_1 dst_unused:UNUSED_PRESERVE src0_sel:WORD_1
    v_pk_fma_f16 v109, v109, s27, s27
    v_lshrrev_b32_sdwa v0, 2, v90 dst_sel:WORD_0 dst_unused:UNUSED_PRESERVE src0_sel:DWORD src1_sel:WORD_0
    v_lshrrev_b32_sdwa v1, 2, v90 dst_sel:WORD_0 dst_unused:UNUSED_PRESERVE src0_sel:DWORD src1_sel:WORD_1
    v_mfma_f32_16x16x32_bf16 v[116:119], v[188:191], v[68:71], v[116:119]
    ds_read_u16 v106, v0 offset:20416
    ds_read_u16 v90, v1 offset:20416
    v_pk_fma_f16 v110, v110, s27, s27
    v_pk_fma_f16 v111, v111, s27, s27
    v_rcp_f16_sdwa v109, v109 dst_sel:WORD_0 dst_unused:UNUSED_PRESERVE src0_sel:WORD_0
    v_mfma_f32_16x16x32_bf16 v[124:127], v[188:191], v[80:83], v[124:127]
    ds_read_b64_tr_b16 v[188:189], v62 offset:14336
    ds_read_b64_tr_b16 v[190:191], v62 offset:14592
    ds_read_b128 v[212:215], v50 offset:3072
    s_setprio 3
    v_rcp_f16_sdwa v110, v110 dst_sel:WORD_0 dst_unused:UNUSED_PRESERVE src0_sel:WORD_0
    v_rcp_f16_sdwa v111, v111 dst_sel:WORD_0 dst_unused:UNUSED_PRESERVE src0_sel:WORD_0
    v_lshrrev_b32_sdwa v0, 2, v91 dst_sel:WORD_0 dst_unused:UNUSED_PRESERVE src0_sel:DWORD src1_sel:WORD_0
    v_lshrrev_b32_sdwa v1, 2, v91 dst_sel:WORD_0 dst_unused:UNUSED_PRESERVE src0_sel:DWORD src1_sel:WORD_1
    v_mfma_f32_16x16x32_bf16 v[112:115], v[192:195], v[72:75], v[112:115]
    ds_read_u16 v107, v0 offset:20416
    ds_read_u16 v91, v1 offset:20416
    v_rcp_f16_sdwa v109, v109 dst_sel:WORD_1 dst_unused:UNUSED_PRESERVE src0_sel:WORD_1
    v_rcp_f16_sdwa v110, v110 dst_sel:WORD_1 dst_unused:UNUSED_PRESERVE src0_sel:WORD_1
    v_mfma_f32_16x16x32_bf16 v[120:123], v[192:195], v[84:87], v[120:123]
    s_add_u32 m0, s41, 0
    ds_read_b64_tr_b16 v[192:193], v49 offset:16384
    ds_read_b64_tr_b16 v[194:195], v49 offset:16640
    ds_read_b128 v[216:219], v50 offset:4096
    buffer_load_dwordx4 v53, s[4:7], s31 offen offset:0 nt lds
    v_rcp_f16_sdwa v111, v111 dst_sel:WORD_1 dst_unused:UNUSED_PRESERVE src0_sel:WORD_1
    v_fma_mix_f32 v224, v109, v93, 0 op_sel_hi:[1,1,0]
    v_fma_mix_f32 v109, v109, v93, 0 op_sel:[1,1,0] op_sel_hi:[1,1,0]
    v_lshrrev_b32_sdwa v0, 2, v92 dst_sel:WORD_0 dst_unused:UNUSED_PRESERVE src0_sel:DWORD src1_sel:WORD_0
    v_lshrrev_b32_sdwa v1, 2, v92 dst_sel:WORD_0 dst_unused:UNUSED_PRESERVE src0_sel:DWORD src1_sel:WORD_1
    v_mfma_f32_16x16x32_bf16 v[116:119], v[196:199], v[72:75], v[116:119]
    ds_read_u16 v108, v0 offset:20416
    ds_read_u16 v92, v1 offset:20416
    v_fma_mix_f32 v225, v110, v94, 0 op_sel_hi:[1,1,0]
    v_fma_mix_f32 v110, v110, v94, 0 op_sel:[1,1,0] op_sel_hi:[1,1,0]
    v_fma_mix_f32 v226, v111, v95, 0 op_sel_hi:[1,1,0]
    v_mfma_f32_16x16x32_bf16 v[124:127], v[196:199], v[84:87], v[124:127]
    ds_read_b64_tr_b16 v[196:197], v62 offset:16384
    ds_read_b64_tr_b16 v[198:199], v62 offset:16640
    ds_read_b128 v[220:223], v50 offset:5120
    v_fma_mix_f32 v111, v111, v95, 0 op_sel:[1,1,0] op_sel_hi:[1,1,0]
    v_cvt_pk_bf16_f32 v93, v224, v109
    v_cvt_pk_bf16_f32 v94, v225, v110
    v_cvt_pk_bf16_f32 v95, v226, v111
    s_waitcnt lgkmcnt(3)
    v_lshl_or_b32 v88, v88, 16, v104
    v_lshl_or_b32 v89, v89, 16, v105
    v_lshl_or_b32 v90, v90, 16, v106
    v_lshl_or_b32 v91, v91, 16, v107
    v_lshl_or_b32 v92, v92, 16, v108
    s_waitcnt lgkmcnt(0)
    v_mfma_f32_16x16x32_bf16 v[128:131], v[200:203], v[88:91], v[128:131]
    s_setprio 3
    v_cvt_pk_f16_f32 v96, v112, v113
    v_cvt_pk_f16_f32 v97, v114, v115
    v_cvt_pk_f16_f32 v98, v116, v117
    v_cvt_pk_f16_f32 v99, v118, v119
    v_mfma_f32_16x16x32_bf16 v[136:139], v[200:203], v[92:95], v[136:139]
    ds_read_b128 v[200:203], v50 offset:36864
    v_cvt_pk_f16_f32 v100, v120, v121
    v_cvt_pk_f16_f32 v101, v122, v123
    v_cvt_pk_f16_f32 v102, v124, v125
    v_cvt_pk_f16_f32 v103, v126, v127
    v_mfma_f32_16x16x32_bf16 v[112:115], v[176:179], v[64:67], 0
    s_setprio 2
    v_and_b32 v96, s42, v96
    v_and_b32 v97, s42, v97
    v_and_b32 v98, s42, v98
    v_mfma_f32_16x16x32_bf16 v[120:123], v[176:179], v[76:79], 0
    ds_read_b64_tr_b16 v[176:177], v49 offset:18432
    ds_read_b64_tr_b16 v[178:179], v49 offset:18688
    v_and_b32 v99, s42, v99
    v_and_b32 v100, s42, v100
    v_lshrrev_b32_sdwa v0, 2, v96 dst_sel:WORD_0 dst_unused:UNUSED_PRESERVE src0_sel:DWORD src1_sel:WORD_0
    v_lshrrev_b32_sdwa v1, 2, v96 dst_sel:WORD_0 dst_unused:UNUSED_PRESERVE src0_sel:DWORD src1_sel:WORD_1
    v_mfma_f32_16x16x32_bf16 v[116:119], v[180:183], v[64:67], 0
    ds_read_u16 v104, v0 offset:20416
    ds_read_u16 v96, v1 offset:20416
    v_pk_fma_f16 v109, v101, v101, s25
    v_pk_fma_f16 v110, v102, v102, s25
    v_mfma_f32_16x16x32_bf16 v[124:127], v[180:183], v[76:79], 0
    ds_read_b64_tr_b16 v[180:181], v62 offset:18432
    ds_read_b64_tr_b16 v[182:183], v62 offset:18688
    v_pk_fma_f16 v111, v103, v103, s25
    v_pk_mul_f16 v109, v109, v101
    v_mfma_f32_16x16x32_bf16 v[112:115], v[184:187], v[68:71], v[112:115]
    s_add_u32 m0, s40, 15368
    s_add_u32 s31, s16, 393216
    buffer_load_dwordx4 v52, s[4:7], s31 offen offset:0 nt lds
    v_pk_mul_f16 v110, v110, v102
    v_pk_mul_f16 v111, v111, v103
    v_mfma_f32_16x16x32_bf16 v[120:123], v[184:187], v[80:83], v[120:123]
    ds_read_b64_tr_b16 v[184:185], v49 offset:20480
    ds_read_b64_tr_b16 v[186:187], v49 offset:20736
    v_exp_f16_sdwa v109, -v109 dst_sel:WORD_0 dst_unused:UNUSED_PRESERVE src0_sel:WORD_0
    v_lshrrev_b32_sdwa v0, 2, v97 dst_sel:WORD_0 dst_unused:UNUSED_PRESERVE src0_sel:DWORD src1_sel:WORD_0
    v_lshrrev_b32_sdwa v1, 2, v97 dst_sel:WORD_0 dst_unused:UNUSED_PRESERVE src0_sel:DWORD src1_sel:WORD_1
    v_mfma_f32_16x16x32_bf16 v[116:119], v[188:191], v[68:71], v[116:119]
    ds_read_u16 v105, v0 offset:20416
    ds_read_u16 v97, v1 offset:20416
    s_setprio 1
    v_exp_f16_sdwa v110, -v110 dst_sel:WORD_0 dst_unused:UNUSED_PRESERVE src0_sel:WORD_0
    v_mfma_f32_16x16x32_bf16 v[124:127], v[188:191], v[80:83], v[124:127]
    ds_read_b64_tr_b16 v[188:189], v62 offset:20480
    ds_read_b64_tr_b16 v[190:191], v62 offset:20736
    v_exp_f16_sdwa v111, -v111 dst_sel:WORD_0 dst_unused:UNUSED_PRESERVE src0_sel:WORD_0
    v_mfma_f32_16x16x32_bf16 v[112:115], v[192:195], v[72:75], v[112:115]
    v_exp_f16_sdwa v109, -v109 dst_sel:WORD_1 dst_unused:UNUSED_PRESERVE src0_sel:WORD_1
    v_mfma_f32_16x16x32_bf16 v[120:123], v[192:195], v[84:87], v[120:123]
    s_add_u32 m0, s41, 15368
    ds_read_b64_tr_b16 v[192:193], v49 offset:22528
    ds_read_b64_tr_b16 v[194:195], v49 offset:22784
    buffer_load_dwordx4 v53, s[4:7], s31 offen offset:0 nt lds
    v_exp_f16_sdwa v110, -v110 dst_sel:WORD_1 dst_unused:UNUSED_PRESERVE src0_sel:WORD_1
    v_lshrrev_b32_sdwa v0, 2, v98 dst_sel:WORD_0 dst_unused:UNUSED_PRESERVE src0_sel:DWORD src1_sel:WORD_0
    v_lshrrev_b32_sdwa v1, 2, v98 dst_sel:WORD_0 dst_unused:UNUSED_PRESERVE src0_sel:DWORD src1_sel:WORD_1
    v_mfma_f32_16x16x32_bf16 v[116:119], v[196:199], v[72:75], v[116:119]
    ds_read_u16 v106, v0 offset:20416
    ds_read_u16 v98, v1 offset:20416
    v_exp_f16_sdwa v111, -v111 dst_sel:WORD_1 dst_unused:UNUSED_PRESERVE src0_sel:WORD_1
    v_mfma_f32_16x16x32_bf16 v[124:127], v[196:199], v[84:87], v[124:127]
    ds_read_b64_tr_b16 v[196:197], v62 offset:22528
    ds_read_b64_tr_b16 v[198:199], v62 offset:22784
    v_pk_fma_f16 v109, v109, s27, s27
    v_pk_fma_f16 v110, v110, s27, s27
    v_mfma_f32_16x16x32_bf16 v[132:135], v[204:207], v[88:91], v[132:135]
    v_pk_fma_f16 v111, v111, s27, s27
    v_rcp_f16_sdwa v109, v109 dst_sel:WORD_0 dst_unused:UNUSED_PRESERVE src0_sel:WORD_0
    v_mfma_f32_16x16x32_bf16 v[140:143], v[204:207], v[92:95], v[140:143]
    ds_read_b128 v[204:207], v50 offset:37888
    s_setprio 0
    v_rcp_f16_sdwa v110, v110 dst_sel:WORD_0 dst_unused:UNUSED_PRESERVE src0_sel:WORD_0
    v_lshrrev_b32_sdwa v0, 2, v99 dst_sel:WORD_0 dst_unused:UNUSED_PRESERVE src0_sel:DWORD src1_sel:WORD_0
    v_lshrrev_b32_sdwa v1, 2, v99 dst_sel:WORD_0 dst_unused:UNUSED_PRESERVE src0_sel:DWORD src1_sel:WORD_1
    v_mfma_f32_16x16x32_bf16 v[144:147], v[208:211], v[88:91], v[144:147]
    ds_read_u16 v107, v0 offset:20416
    ds_read_u16 v99, v1 offset:20416
    v_rcp_f16_sdwa v111, v111 dst_sel:WORD_0 dst_unused:UNUSED_PRESERVE src0_sel:WORD_0
    v_mfma_f32_16x16x32_bf16 v[152:155], v[208:211], v[92:95], v[152:155]
    ds_read_b128 v[208:211], v50 offset:38912
    v_rcp_f16_sdwa v109, v109 dst_sel:WORD_1 dst_unused:UNUSED_PRESERVE src0_sel:WORD_1
    v_mfma_f32_16x16x32_bf16 v[148:151], v[212:215], v[88:91], v[148:151]
    v_rcp_f16_sdwa v110, v110 dst_sel:WORD_1 dst_unused:UNUSED_PRESERVE src0_sel:WORD_1
    v_mfma_f32_16x16x32_bf16 v[156:159], v[212:215], v[92:95], v[156:159]
    ds_read_b128 v[212:215], v50 offset:39936
    v_rcp_f16_sdwa v111, v111 dst_sel:WORD_1 dst_unused:UNUSED_PRESERVE src0_sel:WORD_1
    v_lshrrev_b32_sdwa v0, 2, v100 dst_sel:WORD_0 dst_unused:UNUSED_PRESERVE src0_sel:DWORD src1_sel:WORD_0
    v_lshrrev_b32_sdwa v1, 2, v100 dst_sel:WORD_0 dst_unused:UNUSED_PRESERVE src0_sel:DWORD src1_sel:WORD_1
    v_mfma_f32_16x16x32_bf16 v[160:163], v[216:219], v[88:91], v[160:163]
    ds_read_u16 v108, v0 offset:20416
    ds_read_u16 v100, v1 offset:20416
    v_fma_mix_f32 v224, v109, v101, 0 op_sel_hi:[1,1,0]
    v_mfma_f32_16x16x32_bf16 v[168:171], v[216:219], v[92:95], v[168:171]
    ds_read_b128 v[216:219], v50 offset:40960
    v_fma_mix_f32 v109, v109, v101, 0 op_sel:[1,1,0] op_sel_hi:[1,1,0]
    v_fma_mix_f32 v225, v110, v102, 0 op_sel_hi:[1,1,0]
    v_mfma_f32_16x16x32_bf16 v[164:167], v[220:223], v[88:91], v[164:167]
    v_fma_mix_f32 v110, v110, v102, 0 op_sel:[1,1,0] op_sel_hi:[1,1,0]
    v_fma_mix_f32 v226, v111, v103, 0 op_sel_hi:[1,1,0]
    v_mfma_f32_16x16x32_bf16 v[172:175], v[220:223], v[92:95], v[172:175]
    ds_read_b128 v[220:223], v50 offset:41984
    v_fma_mix_f32 v111, v111, v103, 0 op_sel:[1,1,0] op_sel_hi:[1,1,0]
    v_cvt_pk_bf16_f32 v101, v224, v109
    v_cvt_pk_bf16_f32 v102, v225, v110
    v_cvt_pk_bf16_f32 v103, v226, v111
    s_waitcnt lgkmcnt(2)
    v_lshl_or_b32 v96, v96, 16, v104
    v_lshl_or_b32 v97, v97, 16, v105
    v_lshl_or_b32 v98, v98, 16, v106
    v_lshl_or_b32 v99, v99, 16, v107
    v_lshl_or_b32 v100, v100, 16, v108
    s_waitcnt vmcnt(5) lgkmcnt(0)
    s_barrier
    v_mfma_f32_16x16x32_bf16 v[128:131], v[200:203], v[96:99], v[128:131]
    s_sub_u32 m0, s34, 12288
    s_movk_i32 s79, 12288
    buffer_load_dwordx4 v51, s[44:47], s79 offen offset:0 lds
    s_add_u32 m0, s34, 12096
    s_setprio 0
    buffer_load_dwordx4 v54, s[36:39], 0 offen offset:192 lds
    v_cvt_pk_f16_f32 v88, v112, v113
    v_cvt_pk_f16_f32 v89, v114, v115
    v_cvt_pk_f16_f32 v90, v116, v117
    v_cvt_pk_f16_f32 v91, v118, v119
    v_mfma_f32_16x16x32_bf16 v[136:139], v[200:203], v[100:103], v[136:139]
    ds_read_b128 v[200:203], v50 offset:6144
    v_cvt_pk_f16_f32 v92, v120, v121
    v_cvt_pk_f16_f32 v93, v122, v123
    v_cvt_pk_f16_f32 v94, v124, v125
    v_cvt_pk_f16_f32 v95, v126, v127
    v_mfma_f32_16x16x32_bf16 v[112:115], v[176:179], v[64:67], 0
    s_setprio 1
    v_and_b32 v88, s42, v88
    v_and_b32 v89, s42, v89
    v_and_b32 v90, s42, v90
    v_mfma_f32_16x16x32_bf16 v[120:123], v[176:179], v[76:79], 0
    s_add_u32 m0, s34, 17856
    ds_read_b64_tr_b16 v[176:177], v49 offset:0
    ds_read_b64_tr_b16 v[178:179], v49 offset:256
    buffer_load_dwordx4 v54, s[36:39], 0 offen offset:576 lds
    v_and_b32 v91, s42, v91
    v_and_b32 v92, s42, v92
    v_lshrrev_b32_sdwa v0, 2, v88 dst_sel:WORD_0 dst_unused:UNUSED_PRESERVE src0_sel:DWORD src1_sel:WORD_0
    v_lshrrev_b32_sdwa v1, 2, v88 dst_sel:WORD_0 dst_unused:UNUSED_PRESERVE src0_sel:DWORD src1_sel:WORD_1
    v_mfma_f32_16x16x32_bf16 v[116:119], v[180:183], v[64:67], 0
    ds_read_u16 v104, v0 offset:20416
    ds_read_u16 v88, v1 offset:20416
    buffer_store_dwordx4 v[236:239], v55, s[8:11], s22 offen offset:1536 sc0 sc1 nt
    v_pk_fma_f16 v109, v93, v93, s25
    v_pk_fma_f16 v110, v94, v94, s25
    v_mfma_f32_16x16x32_bf16 v[124:127], v[180:183], v[76:79], 0
    ds_read_b64_tr_b16 v[180:181], v62 offset:0
    ds_read_b64_tr_b16 v[182:183], v62 offset:256
    v_pk_fma_f16 v111, v95, v95, s25
    v_pk_mul_f16 v109, v109, v93
    v_mfma_f32_16x16x32_bf16 v[112:115], v[184:187], v[68:71], v[112:115]
    s_add_u32 m0, s40, 30784
    s_add_u32 s31, s16, 786432
    buffer_load_dwordx4 v52, s[4:7], s31 offen offset:0 nt lds
    v_pk_mul_f16 v110, v110, v94
    v_pk_mul_f16 v111, v111, v95
    v_mfma_f32_16x16x32_bf16 v[120:123], v[184:187], v[80:83], v[120:123]
    ds_read_b64_tr_b16 v[184:185], v49 offset:2048
    ds_read_b64_tr_b16 v[186:187], v49 offset:2304
    v_exp_f16_sdwa v109, -v109 dst_sel:WORD_0 dst_unused:UNUSED_PRESERVE src0_sel:WORD_0
    v_lshrrev_b32_sdwa v0, 2, v89 dst_sel:WORD_0 dst_unused:UNUSED_PRESERVE src0_sel:DWORD src1_sel:WORD_0
    v_lshrrev_b32_sdwa v1, 2, v89 dst_sel:WORD_0 dst_unused:UNUSED_PRESERVE src0_sel:DWORD src1_sel:WORD_1
    v_mfma_f32_16x16x32_bf16 v[116:119], v[188:191], v[68:71], v[116:119]
    ds_read_u16 v105, v0 offset:20416
    ds_read_u16 v89, v1 offset:20416
    s_setprio 2
    v_exp_f16_sdwa v110, -v110 dst_sel:WORD_0 dst_unused:UNUSED_PRESERVE src0_sel:WORD_0
    v_mfma_f32_16x16x32_bf16 v[124:127], v[188:191], v[80:83], v[124:127]
    ds_read_b64_tr_b16 v[188:189], v62 offset:2048
    ds_read_b64_tr_b16 v[190:191], v62 offset:2304
    v_exp_f16_sdwa v111, -v111 dst_sel:WORD_0 dst_unused:UNUSED_PRESERVE src0_sel:WORD_0
    v_mfma_f32_16x16x32_bf16 v[112:115], v[192:195], v[72:75], v[112:115]
    v_exp_f16_sdwa v109, -v109 dst_sel:WORD_1 dst_unused:UNUSED_PRESERVE src0_sel:WORD_1
    v_mfma_f32_16x16x32_bf16 v[120:123], v[192:195], v[84:87], v[120:123]
    ds_read_b64_tr_b16 v[192:193], v49 offset:4096
    ds_read_b64_tr_b16 v[194:195], v49 offset:4352
    v_exp_f16_sdwa v110, -v110 dst_sel:WORD_1 dst_unused:UNUSED_PRESERVE src0_sel:WORD_1
    v_lshrrev_b32_sdwa v0, 2, v90 dst_sel:WORD_0 dst_unused:UNUSED_PRESERVE src0_sel:DWORD src1_sel:WORD_0
    v_lshrrev_b32_sdwa v1, 2, v90 dst_sel:WORD_0 dst_unused:UNUSED_PRESERVE src0_sel:DWORD src1_sel:WORD_1
    v_mfma_f32_16x16x32_bf16 v[116:119], v[196:199], v[72:75], v[116:119]
    ds_read_u16 v106, v0 offset:20416
    ds_read_u16 v90, v1 offset:20416
    v_exp_f16_sdwa v111, -v111 dst_sel:WORD_1 dst_unused:UNUSED_PRESERVE src0_sel:WORD_1
    v_mfma_f32_16x16x32_bf16 v[124:127], v[196:199], v[84:87], v[124:127]
    ds_read_b64_tr_b16 v[196:197], v62 offset:4096
    ds_read_b64_tr_b16 v[198:199], v62 offset:4352
    v_pk_fma_f16 v109, v109, s27, s27
    v_pk_fma_f16 v110, v110, s27, s27
    v_mfma_f32_16x16x32_bf16 v[132:135], v[204:207], v[96:99], v[132:135]
    v_pk_fma_f16 v111, v111, s27, s27
    v_rcp_f16_sdwa v109, v109 dst_sel:WORD_0 dst_unused:UNUSED_PRESERVE src0_sel:WORD_0
    v_mfma_f32_16x16x32_bf16 v[140:143], v[204:207], v[100:103], v[140:143]
    ds_read_b128 v[204:207], v50 offset:7168
    s_setprio 3
    v_rcp_f16_sdwa v110, v110 dst_sel:WORD_0 dst_unused:UNUSED_PRESERVE src0_sel:WORD_0
    v_lshrrev_b32_sdwa v0, 2, v91 dst_sel:WORD_0 dst_unused:UNUSED_PRESERVE src0_sel:DWORD src1_sel:WORD_0
    v_lshrrev_b32_sdwa v1, 2, v91 dst_sel:WORD_0 dst_unused:UNUSED_PRESERVE src0_sel:DWORD src1_sel:WORD_1
    v_mfma_f32_16x16x32_bf16 v[144:147], v[208:211], v[96:99], v[144:147]
    ds_read_u16 v107, v0 offset:20416
    ds_read_u16 v91, v1 offset:20416
    v_rcp_f16_sdwa v111, v111 dst_sel:WORD_0 dst_unused:UNUSED_PRESERVE src0_sel:WORD_0
    v_mfma_f32_16x16x32_bf16 v[152:155], v[208:211], v[100:103], v[152:155]
    ds_read_b128 v[208:211], v50 offset:8192
    v_rcp_f16_sdwa v109, v109 dst_sel:WORD_1 dst_unused:UNUSED_PRESERVE src0_sel:WORD_1
    v_mfma_f32_16x16x32_bf16 v[148:151], v[212:215], v[96:99], v[148:151]
    v_rcp_f16_sdwa v110, v110 dst_sel:WORD_1 dst_unused:UNUSED_PRESERVE src0_sel:WORD_1
    v_mfma_f32_16x16x32_bf16 v[156:159], v[212:215], v[100:103], v[156:159]
    ds_read_b128 v[212:215], v50 offset:9216
    v_rcp_f16_sdwa v111, v111 dst_sel:WORD_1 dst_unused:UNUSED_PRESERVE src0_sel:WORD_1
    v_lshrrev_b32_sdwa v0, 2, v92 dst_sel:WORD_0 dst_unused:UNUSED_PRESERVE src0_sel:DWORD src1_sel:WORD_0
    v_lshrrev_b32_sdwa v1, 2, v92 dst_sel:WORD_0 dst_unused:UNUSED_PRESERVE src0_sel:DWORD src1_sel:WORD_1
    v_mfma_f32_16x16x32_bf16 v[160:163], v[216:219], v[96:99], v[160:163]
    ds_read_u16 v108, v0 offset:20416
    ds_read_u16 v92, v1 offset:20416
    v_fma_mix_f32 v224, v109, v93, 0 op_sel_hi:[1,1,0]
    v_mfma_f32_16x16x32_bf16 v[168:171], v[216:219], v[100:103], v[168:171]
    ds_read_b128 v[216:219], v50 offset:10240
    v_fma_mix_f32 v109, v109, v93, 0 op_sel:[1,1,0] op_sel_hi:[1,1,0]
    v_fma_mix_f32 v225, v110, v94, 0 op_sel_hi:[1,1,0]
    v_mfma_f32_16x16x32_bf16 v[164:167], v[220:223], v[96:99], v[164:167]
    v_fma_mix_f32 v110, v110, v94, 0 op_sel:[1,1,0] op_sel_hi:[1,1,0]
    v_fma_mix_f32 v226, v111, v95, 0 op_sel_hi:[1,1,0]
    v_mfma_f32_16x16x32_bf16 v[172:175], v[220:223], v[100:103], v[172:175]
    ds_read_b128 v[220:223], v50 offset:11264
    v_fma_mix_f32 v111, v111, v95, 0 op_sel:[1,1,0] op_sel_hi:[1,1,0]
    v_cvt_pk_bf16_f32 v93, v224, v109
    v_cvt_pk_bf16_f32 v94, v225, v110
    v_cvt_pk_bf16_f32 v95, v226, v111
    s_waitcnt lgkmcnt(2)
    v_lshl_or_b32 v88, v88, 16, v104
    v_lshl_or_b32 v89, v89, 16, v105
    v_lshl_or_b32 v90, v90, 16, v106
    v_lshl_or_b32 v91, v91, 16, v107
    v_lshl_or_b32 v92, v92, 16, v108
    s_waitcnt lgkmcnt(0)
    v_mfma_f32_16x16x32_bf16 v[128:131], v[200:203], v[88:91], v[128:131]
    s_setprio 3
    v_cvt_pk_f16_f32 v96, v112, v113
    v_cvt_pk_f16_f32 v97, v114, v115
    v_cvt_pk_f16_f32 v98, v116, v117
    v_cvt_pk_f16_f32 v99, v118, v119
    v_mfma_f32_16x16x32_bf16 v[136:139], v[200:203], v[92:95], v[136:139]
    ds_read_b128 v[200:203], v50 offset:43008
    v_cvt_pk_f16_f32 v100, v120, v121
    v_cvt_pk_f16_f32 v101, v122, v123
    v_cvt_pk_f16_f32 v102, v124, v125
    v_cvt_pk_f16_f32 v103, v126, v127
    v_mfma_f32_16x16x32_bf16 v[112:115], v[176:179], v[64:67], 0
    s_setprio 2
    v_and_b32 v96, s42, v96
    v_and_b32 v97, s42, v97
    v_and_b32 v98, s42, v98
    v_mfma_f32_16x16x32_bf16 v[120:123], v[176:179], v[76:79], 0
    ds_read_b64_tr_b16 v[176:177], v49 offset:6144
    ds_read_b64_tr_b16 v[178:179], v49 offset:6400
    v_and_b32 v99, s42, v99
    v_and_b32 v100, s42, v100
    v_lshrrev_b32_sdwa v0, 2, v96 dst_sel:WORD_0 dst_unused:UNUSED_PRESERVE src0_sel:DWORD src1_sel:WORD_0
    v_lshrrev_b32_sdwa v1, 2, v96 dst_sel:WORD_0 dst_unused:UNUSED_PRESERVE src0_sel:DWORD src1_sel:WORD_1
    v_mfma_f32_16x16x32_bf16 v[116:119], v[180:183], v[64:67], 0
    ds_read_u16 v104, v0 offset:20416
    ds_read_u16 v96, v1 offset:20416
    v_pk_fma_f16 v109, v101, v101, s25
    v_pk_fma_f16 v110, v102, v102, s25
    v_mfma_f32_16x16x32_bf16 v[124:127], v[180:183], v[76:79], 0
    ds_read_b64_tr_b16 v[180:181], v62 offset:6144
    ds_read_b64_tr_b16 v[182:183], v62 offset:6400
    v_pk_fma_f16 v111, v103, v103, s25
    v_pk_mul_f16 v109, v109, v101
    v_mfma_f32_16x16x32_bf16 v[112:115], v[184:187], v[68:71], v[112:115]
    v_pk_mul_f16 v110, v110, v102
    v_pk_mul_f16 v111, v111, v103
    v_mfma_f32_16x16x32_bf16 v[120:123], v[184:187], v[80:83], v[120:123]
    s_add_u32 m0, s41, 30784
    ds_read_b64_tr_b16 v[184:185], v49 offset:8192
    ds_read_b64_tr_b16 v[186:187], v49 offset:8448
    buffer_load_dwordx4 v53, s[4:7], s31 offen offset:0 nt lds
    v_exp_f16_sdwa v109, -v109 dst_sel:WORD_0 dst_unused:UNUSED_PRESERVE src0_sel:WORD_0
    v_lshrrev_b32_sdwa v0, 2, v97 dst_sel:WORD_0 dst_unused:UNUSED_PRESERVE src0_sel:DWORD src1_sel:WORD_0
    v_lshrrev_b32_sdwa v1, 2, v97 dst_sel:WORD_0 dst_unused:UNUSED_PRESERVE src0_sel:DWORD src1_sel:WORD_1
    v_mfma_f32_16x16x32_bf16 v[116:119], v[188:191], v[68:71], v[116:119]
    ds_read_u16 v105, v0 offset:20416
    ds_read_u16 v97, v1 offset:20416
    s_setprio 1
    v_exp_f16_sdwa v110, -v110 dst_sel:WORD_0 dst_unused:UNUSED_PRESERVE src0_sel:WORD_0
    v_mfma_f32_16x16x32_bf16 v[124:127], v[188:191], v[80:83], v[124:127]
    ds_read_b64_tr_b16 v[188:189], v62 offset:8192
    ds_read_b64_tr_b16 v[190:191], v62 offset:8448
    v_exp_f16_sdwa v111, -v111 dst_sel:WORD_0 dst_unused:UNUSED_PRESERVE src0_sel:WORD_0
    v_mfma_f32_16x16x32_bf16 v[112:115], v[192:195], v[72:75], v[112:115]
    v_exp_f16_sdwa v109, -v109 dst_sel:WORD_1 dst_unused:UNUSED_PRESERVE src0_sel:WORD_1
    v_mfma_f32_16x16x32_bf16 v[120:123], v[192:195], v[84:87], v[120:123]
    ds_read_b64_tr_b16 v[192:193], v49 offset:10240
    ds_read_b64_tr_b16 v[194:195], v49 offset:10496
    v_exp_f16_sdwa v110, -v110 dst_sel:WORD_1 dst_unused:UNUSED_PRESERVE src0_sel:WORD_1
    v_lshrrev_b32_sdwa v0, 2, v98 dst_sel:WORD_0 dst_unused:UNUSED_PRESERVE src0_sel:DWORD src1_sel:WORD_0
    v_lshrrev_b32_sdwa v1, 2, v98 dst_sel:WORD_0 dst_unused:UNUSED_PRESERVE src0_sel:DWORD src1_sel:WORD_1
    v_mfma_f32_16x16x32_bf16 v[116:119], v[196:199], v[72:75], v[116:119]
    ds_read_u16 v106, v0 offset:20416
    ds_read_u16 v98, v1 offset:20416
    v_exp_f16_sdwa v111, -v111 dst_sel:WORD_1 dst_unused:UNUSED_PRESERVE src0_sel:WORD_1
    v_mfma_f32_16x16x32_bf16 v[124:127], v[196:199], v[84:87], v[124:127]
    ds_read_b64_tr_b16 v[196:197], v62 offset:10240
    ds_read_b64_tr_b16 v[198:199], v62 offset:10496
    v_pk_fma_f16 v109, v109, s27, s27
    v_pk_fma_f16 v110, v110, s27, s27
    v_mfma_f32_16x16x32_bf16 v[132:135], v[204:207], v[88:91], v[132:135]
    v_pk_fma_f16 v111, v111, s27, s27
    v_rcp_f16_sdwa v109, v109 dst_sel:WORD_0 dst_unused:UNUSED_PRESERVE src0_sel:WORD_0
    v_mfma_f32_16x16x32_bf16 v[140:143], v[204:207], v[92:95], v[140:143]
    ds_read_b128 v[204:207], v50 offset:44032
    s_setprio 0
    v_rcp_f16_sdwa v110, v110 dst_sel:WORD_0 dst_unused:UNUSED_PRESERVE src0_sel:WORD_0
    v_lshrrev_b32_sdwa v0, 2, v99 dst_sel:WORD_0 dst_unused:UNUSED_PRESERVE src0_sel:DWORD src1_sel:WORD_0
    v_lshrrev_b32_sdwa v1, 2, v99 dst_sel:WORD_0 dst_unused:UNUSED_PRESERVE src0_sel:DWORD src1_sel:WORD_1
    v_mfma_f32_16x16x32_bf16 v[144:147], v[208:211], v[88:91], v[144:147]
    ds_read_u16 v107, v0 offset:20416
    ds_read_u16 v99, v1 offset:20416
    v_rcp_f16_sdwa v111, v111 dst_sel:WORD_0 dst_unused:UNUSED_PRESERVE src0_sel:WORD_0
    v_mfma_f32_16x16x32_bf16 v[152:155], v[208:211], v[92:95], v[152:155]
    ds_read_b128 v[208:211], v50 offset:45056
    v_rcp_f16_sdwa v109, v109 dst_sel:WORD_1 dst_unused:UNUSED_PRESERVE src0_sel:WORD_1
    v_mfma_f32_16x16x32_bf16 v[148:151], v[212:215], v[88:91], v[148:151]
    v_rcp_f16_sdwa v110, v110 dst_sel:WORD_1 dst_unused:UNUSED_PRESERVE src0_sel:WORD_1
    v_mfma_f32_16x16x32_bf16 v[156:159], v[212:215], v[92:95], v[156:159]
    ds_read_b128 v[212:215], v50 offset:46080
    v_rcp_f16_sdwa v111, v111 dst_sel:WORD_1 dst_unused:UNUSED_PRESERVE src0_sel:WORD_1
    v_lshrrev_b32_sdwa v0, 2, v100 dst_sel:WORD_0 dst_unused:UNUSED_PRESERVE src0_sel:DWORD src1_sel:WORD_0
    v_lshrrev_b32_sdwa v1, 2, v100 dst_sel:WORD_0 dst_unused:UNUSED_PRESERVE src0_sel:DWORD src1_sel:WORD_1
    v_mfma_f32_16x16x32_bf16 v[160:163], v[216:219], v[88:91], v[160:163]
    ds_read_u16 v108, v0 offset:20416
    ds_read_u16 v100, v1 offset:20416
    v_fma_mix_f32 v224, v109, v101, 0 op_sel_hi:[1,1,0]
    v_mfma_f32_16x16x32_bf16 v[168:171], v[216:219], v[92:95], v[168:171]
    ds_read_b128 v[216:219], v50 offset:47104
    v_fma_mix_f32 v109, v109, v101, 0 op_sel:[1,1,0] op_sel_hi:[1,1,0]
    v_fma_mix_f32 v225, v110, v102, 0 op_sel_hi:[1,1,0]
    v_mfma_f32_16x16x32_bf16 v[164:167], v[220:223], v[88:91], v[164:167]
    v_fma_mix_f32 v110, v110, v102, 0 op_sel:[1,1,0] op_sel_hi:[1,1,0]
    v_fma_mix_f32 v226, v111, v103, 0 op_sel_hi:[1,1,0]
    v_mfma_f32_16x16x32_bf16 v[172:175], v[220:223], v[92:95], v[172:175]
    ds_read_b128 v[220:223], v50 offset:48128
    v_fma_mix_f32 v111, v111, v103, 0 op_sel:[1,1,0] op_sel_hi:[1,1,0]
    v_cvt_pk_bf16_f32 v101, v224, v109
    v_cvt_pk_bf16_f32 v102, v225, v110
    v_cvt_pk_bf16_f32 v103, v226, v111
    s_waitcnt lgkmcnt(2)
    v_lshl_or_b32 v96, v96, 16, v104
    v_lshl_or_b32 v97, v97, 16, v105
    v_lshl_or_b32 v98, v98, 16, v106
    v_lshl_or_b32 v99, v99, 16, v107
    v_lshl_or_b32 v100, v100, 16, v108
    s_waitcnt vmcnt(3) lgkmcnt(0)
    s_barrier
    v_mfma_f32_16x16x32_bf16 v[128:131], v[200:203], v[96:99], v[128:131]
    s_sub_u32 m0, s34, 6144
    s_movk_i32 s79, 18432
    buffer_load_dwordx4 v51, s[44:47], s79 offen offset:0 lds
    s_add_u32 m0, s34, -256
    s_setprio 0
    buffer_load_dwordx4 v54, s[36:39], 0 offen offset:256 lds
    v_cvt_pk_f16_f32 v88, v112, v113
    v_cvt_pk_f16_f32 v89, v114, v115
    v_cvt_pk_f16_f32 v90, v116, v117
    v_cvt_pk_f16_f32 v91, v118, v119
    v_mfma_f32_16x16x32_bf16 v[136:139], v[200:203], v[100:103], v[136:139]
    ds_read_b128 v[200:203], v50 offset:12288
    v_cvt_pk_f16_f32 v92, v120, v121
    v_cvt_pk_f16_f32 v93, v122, v123
    v_cvt_pk_f16_f32 v94, v124, v125
    v_cvt_pk_f16_f32 v95, v126, v127
    v_mfma_f32_16x16x32_bf16 v[112:115], v[176:179], v[64:67], 0
    s_setprio 1
    v_and_b32 v88, s42, v88
    v_and_b32 v89, s42, v89
    v_and_b32 v90, s42, v90
    v_mfma_f32_16x16x32_bf16 v[120:123], v[176:179], v[76:79], 0
    s_add_u32 m0, s34, 5504
    ds_read_b64_tr_b16 v[176:177], v49 offset:12288
    ds_read_b64_tr_b16 v[178:179], v49 offset:12544
    buffer_load_dwordx4 v54, s[36:39], 0 offen offset:640 lds
    v_and_b32 v91, s42, v91
    v_and_b32 v92, s42, v92
    v_lshrrev_b32_sdwa v0, 2, v88 dst_sel:WORD_0 dst_unused:UNUSED_PRESERVE src0_sel:DWORD src1_sel:WORD_0
    v_lshrrev_b32_sdwa v1, 2, v88 dst_sel:WORD_0 dst_unused:UNUSED_PRESERVE src0_sel:DWORD src1_sel:WORD_1
    v_mfma_f32_16x16x32_bf16 v[116:119], v[180:183], v[64:67], 0
    ds_read_u16 v104, v0 offset:20416
    ds_read_u16 v88, v1 offset:20416
    v_pk_fma_f16 v109, v93, v93, s25
    v_pk_fma_f16 v110, v94, v94, s25
    v_mfma_f32_16x16x32_bf16 v[124:127], v[180:183], v[76:79], 0
    ds_read_b64_tr_b16 v[180:181], v62 offset:12288
    ds_read_b64_tr_b16 v[182:183], v62 offset:12544
    v_pk_fma_f16 v111, v95, v95, s25
    v_pk_mul_f16 v109, v109, v93
    v_mfma_f32_16x16x32_bf16 v[112:115], v[184:187], v[68:71], v[112:115]
    s_add_u32 m0, s40, 46152
    s_add_u32 s31, s16, 1179648
    buffer_load_dwordx4 v52, s[4:7], s31 offen offset:0 nt lds
    v_pk_mul_f16 v110, v110, v94
    v_pk_mul_f16 v111, v111, v95
    v_mfma_f32_16x16x32_bf16 v[120:123], v[184:187], v[80:83], v[120:123]
    ds_read_b64_tr_b16 v[184:185], v49 offset:14336
    ds_read_b64_tr_b16 v[186:187], v49 offset:14592
    v_exp_f16_sdwa v109, -v109 dst_sel:WORD_0 dst_unused:UNUSED_PRESERVE src0_sel:WORD_0
    v_lshrrev_b32_sdwa v0, 2, v89 dst_sel:WORD_0 dst_unused:UNUSED_PRESERVE src0_sel:DWORD src1_sel:WORD_0
    v_lshrrev_b32_sdwa v1, 2, v89 dst_sel:WORD_0 dst_unused:UNUSED_PRESERVE src0_sel:DWORD src1_sel:WORD_1
    v_mfma_f32_16x16x32_bf16 v[116:119], v[188:191], v[68:71], v[116:119]
    ds_read_u16 v105, v0 offset:20416
    ds_read_u16 v89, v1 offset:20416
    s_setprio 2
    v_exp_f16_sdwa v110, -v110 dst_sel:WORD_0 dst_unused:UNUSED_PRESERVE src0_sel:WORD_0
    v_mfma_f32_16x16x32_bf16 v[124:127], v[188:191], v[80:83], v[124:127]
    ds_read_b64_tr_b16 v[188:189], v62 offset:14336
    ds_read_b64_tr_b16 v[190:191], v62 offset:14592
    v_exp_f16_sdwa v111, -v111 dst_sel:WORD_0 dst_unused:UNUSED_PRESERVE src0_sel:WORD_0
    v_mfma_f32_16x16x32_bf16 v[112:115], v[192:195], v[72:75], v[112:115]
    v_exp_f16_sdwa v109, -v109 dst_sel:WORD_1 dst_unused:UNUSED_PRESERVE src0_sel:WORD_1
    v_mfma_f32_16x16x32_bf16 v[120:123], v[192:195], v[84:87], v[120:123]
    ds_read_b64_tr_b16 v[192:193], v49 offset:16384
    ds_read_b64_tr_b16 v[194:195], v49 offset:16640
    v_exp_f16_sdwa v110, -v110 dst_sel:WORD_1 dst_unused:UNUSED_PRESERVE src0_sel:WORD_1
    v_lshrrev_b32_sdwa v0, 2, v90 dst_sel:WORD_0 dst_unused:UNUSED_PRESERVE src0_sel:DWORD src1_sel:WORD_0
    v_lshrrev_b32_sdwa v1, 2, v90 dst_sel:WORD_0 dst_unused:UNUSED_PRESERVE src0_sel:DWORD src1_sel:WORD_1
    v_mfma_f32_16x16x32_bf16 v[116:119], v[196:199], v[72:75], v[116:119]
    ds_read_u16 v106, v0 offset:20416
    ds_read_u16 v90, v1 offset:20416
    v_exp_f16_sdwa v111, -v111 dst_sel:WORD_1 dst_unused:UNUSED_PRESERVE src0_sel:WORD_1
    v_mfma_f32_16x16x32_bf16 v[124:127], v[196:199], v[84:87], v[124:127]
    ds_read_b64_tr_b16 v[196:197], v62 offset:16384
    ds_read_b64_tr_b16 v[198:199], v62 offset:16640
    v_pk_fma_f16 v109, v109, s27, s27
    v_pk_fma_f16 v110, v110, s27, s27
    v_mfma_f32_16x16x32_bf16 v[132:135], v[204:207], v[96:99], v[132:135]
    v_pk_fma_f16 v111, v111, s27, s27
    v_rcp_f16_sdwa v109, v109 dst_sel:WORD_0 dst_unused:UNUSED_PRESERVE src0_sel:WORD_0
    v_mfma_f32_16x16x32_bf16 v[140:143], v[204:207], v[100:103], v[140:143]
    ds_read_b128 v[204:207], v50 offset:13312
    s_setprio 3
    v_rcp_f16_sdwa v110, v110 dst_sel:WORD_0 dst_unused:UNUSED_PRESERVE src0_sel:WORD_0
    v_lshrrev_b32_sdwa v0, 2, v91 dst_sel:WORD_0 dst_unused:UNUSED_PRESERVE src0_sel:DWORD src1_sel:WORD_0
    v_lshrrev_b32_sdwa v1, 2, v91 dst_sel:WORD_0 dst_unused:UNUSED_PRESERVE src0_sel:DWORD src1_sel:WORD_1
    v_mfma_f32_16x16x32_bf16 v[144:147], v[208:211], v[96:99], v[144:147]
    ds_read_u16 v107, v0 offset:20416
    ds_read_u16 v91, v1 offset:20416
    v_rcp_f16_sdwa v111, v111 dst_sel:WORD_0 dst_unused:UNUSED_PRESERVE src0_sel:WORD_0
    v_mfma_f32_16x16x32_bf16 v[152:155], v[208:211], v[100:103], v[152:155]
    ds_read_b128 v[208:211], v50 offset:14336
    v_rcp_f16_sdwa v109, v109 dst_sel:WORD_1 dst_unused:UNUSED_PRESERVE src0_sel:WORD_1
    v_mfma_f32_16x16x32_bf16 v[148:151], v[212:215], v[96:99], v[148:151]
    v_rcp_f16_sdwa v110, v110 dst_sel:WORD_1 dst_unused:UNUSED_PRESERVE src0_sel:WORD_1
    v_mfma_f32_16x16x32_bf16 v[156:159], v[212:215], v[100:103], v[156:159]
    ds_read_b128 v[212:215], v50 offset:15360
    v_rcp_f16_sdwa v111, v111 dst_sel:WORD_1 dst_unused:UNUSED_PRESERVE src0_sel:WORD_1
    v_lshrrev_b32_sdwa v0, 2, v92 dst_sel:WORD_0 dst_unused:UNUSED_PRESERVE src0_sel:DWORD src1_sel:WORD_0
    v_lshrrev_b32_sdwa v1, 2, v92 dst_sel:WORD_0 dst_unused:UNUSED_PRESERVE src0_sel:DWORD src1_sel:WORD_1
    v_mfma_f32_16x16x32_bf16 v[160:163], v[216:219], v[96:99], v[160:163]
    ds_read_u16 v108, v0 offset:20416
    ds_read_u16 v92, v1 offset:20416
    v_fma_mix_f32 v224, v109, v93, 0 op_sel_hi:[1,1,0]
    v_mfma_f32_16x16x32_bf16 v[168:171], v[216:219], v[100:103], v[168:171]
    ds_read_b128 v[216:219], v50 offset:16384
    v_fma_mix_f32 v109, v109, v93, 0 op_sel:[1,1,0] op_sel_hi:[1,1,0]
    v_fma_mix_f32 v225, v110, v94, 0 op_sel_hi:[1,1,0]
    v_mfma_f32_16x16x32_bf16 v[164:167], v[220:223], v[96:99], v[164:167]
    v_fma_mix_f32 v110, v110, v94, 0 op_sel:[1,1,0] op_sel_hi:[1,1,0]
    v_fma_mix_f32 v226, v111, v95, 0 op_sel_hi:[1,1,0]
    v_mfma_f32_16x16x32_bf16 v[172:175], v[220:223], v[100:103], v[172:175]
    ds_read_b128 v[220:223], v50 offset:17408
    v_fma_mix_f32 v111, v111, v95, 0 op_sel:[1,1,0] op_sel_hi:[1,1,0]
    v_cvt_pk_bf16_f32 v93, v224, v109
    v_cvt_pk_bf16_f32 v94, v225, v110
    v_cvt_pk_bf16_f32 v95, v226, v111
    s_waitcnt lgkmcnt(2)
    v_lshl_or_b32 v88, v88, 16, v104
    v_lshl_or_b32 v89, v89, 16, v105
    v_lshl_or_b32 v90, v90, 16, v106
    v_lshl_or_b32 v91, v91, 16, v107
    v_lshl_or_b32 v92, v92, 16, v108
    s_waitcnt lgkmcnt(0)
    v_mfma_f32_16x16x32_bf16 v[128:131], v[200:203], v[88:91], v[128:131]
    s_setprio 3
    v_cvt_pk_f16_f32 v96, v112, v113
    v_cvt_pk_f16_f32 v97, v114, v115
    v_cvt_pk_f16_f32 v98, v116, v117
    v_cvt_pk_f16_f32 v99, v118, v119
    v_mfma_f32_16x16x32_bf16 v[136:139], v[200:203], v[92:95], v[136:139]
    ds_read_b128 v[200:203], v50 offset:36864
    v_cvt_pk_f16_f32 v100, v120, v121
    v_cvt_pk_f16_f32 v101, v122, v123
    v_cvt_pk_f16_f32 v102, v124, v125
    v_cvt_pk_f16_f32 v103, v126, v127
    v_mfma_f32_16x16x32_bf16 v[112:115], v[176:179], v[64:67], 0
    s_setprio 2
    v_and_b32 v96, s42, v96
    v_and_b32 v97, s42, v97
    v_and_b32 v98, s42, v98
    v_mfma_f32_16x16x32_bf16 v[120:123], v[176:179], v[76:79], 0
    ds_read_b64_tr_b16 v[176:177], v49 offset:18432
    ds_read_b64_tr_b16 v[178:179], v49 offset:18688
    v_and_b32 v99, s42, v99
    v_and_b32 v100, s42, v100
    v_lshrrev_b32_sdwa v0, 2, v96 dst_sel:WORD_0 dst_unused:UNUSED_PRESERVE src0_sel:DWORD src1_sel:WORD_0
    v_lshrrev_b32_sdwa v1, 2, v96 dst_sel:WORD_0 dst_unused:UNUSED_PRESERVE src0_sel:DWORD src1_sel:WORD_1
    v_mfma_f32_16x16x32_bf16 v[116:119], v[180:183], v[64:67], 0
    ds_read_u16 v104, v0 offset:20416
    ds_read_u16 v96, v1 offset:20416
    v_pk_fma_f16 v109, v101, v101, s25
    v_pk_fma_f16 v110, v102, v102, s25
    v_mfma_f32_16x16x32_bf16 v[124:127], v[180:183], v[76:79], 0
    ds_read_b64_tr_b16 v[180:181], v62 offset:18432
    ds_read_b64_tr_b16 v[182:183], v62 offset:18688
    v_pk_fma_f16 v111, v103, v103, s25
    v_pk_mul_f16 v109, v109, v101
    v_mfma_f32_16x16x32_bf16 v[112:115], v[184:187], v[68:71], v[112:115]
    v_pk_mul_f16 v110, v110, v102
    v_pk_mul_f16 v111, v111, v103
    v_mfma_f32_16x16x32_bf16 v[120:123], v[184:187], v[80:83], v[120:123]
    s_add_u32 m0, s41, 46152
    ds_read_b64_tr_b16 v[184:185], v49 offset:20480
    ds_read_b64_tr_b16 v[186:187], v49 offset:20736
    buffer_load_dwordx4 v53, s[4:7], s31 offen offset:0 nt lds
    v_exp_f16_sdwa v109, -v109 dst_sel:WORD_0 dst_unused:UNUSED_PRESERVE src0_sel:WORD_0
    v_lshrrev_b32_sdwa v0, 2, v97 dst_sel:WORD_0 dst_unused:UNUSED_PRESERVE src0_sel:DWORD src1_sel:WORD_0
    v_lshrrev_b32_sdwa v1, 2, v97 dst_sel:WORD_0 dst_unused:UNUSED_PRESERVE src0_sel:DWORD src1_sel:WORD_1
    v_mfma_f32_16x16x32_bf16 v[116:119], v[188:191], v[68:71], v[116:119]
    ds_read_u16 v105, v0 offset:20416
    ds_read_u16 v97, v1 offset:20416
    s_setprio 1
    v_exp_f16_sdwa v110, -v110 dst_sel:WORD_0 dst_unused:UNUSED_PRESERVE src0_sel:WORD_0
    v_mfma_f32_16x16x32_bf16 v[124:127], v[188:191], v[80:83], v[124:127]
    ds_read_b64_tr_b16 v[188:189], v62 offset:20480
    ds_read_b64_tr_b16 v[190:191], v62 offset:20736
    v_exp_f16_sdwa v111, -v111 dst_sel:WORD_0 dst_unused:UNUSED_PRESERVE src0_sel:WORD_0
    v_mfma_f32_16x16x32_bf16 v[112:115], v[192:195], v[72:75], v[112:115]
    v_exp_f16_sdwa v109, -v109 dst_sel:WORD_1 dst_unused:UNUSED_PRESERVE src0_sel:WORD_1
    v_mfma_f32_16x16x32_bf16 v[120:123], v[192:195], v[84:87], v[120:123]
    ds_read_b64_tr_b16 v[192:193], v49 offset:22528
    ds_read_b64_tr_b16 v[194:195], v49 offset:22784
    v_exp_f16_sdwa v110, -v110 dst_sel:WORD_1 dst_unused:UNUSED_PRESERVE src0_sel:WORD_1
    v_lshrrev_b32_sdwa v0, 2, v98 dst_sel:WORD_0 dst_unused:UNUSED_PRESERVE src0_sel:DWORD src1_sel:WORD_0
    v_lshrrev_b32_sdwa v1, 2, v98 dst_sel:WORD_0 dst_unused:UNUSED_PRESERVE src0_sel:DWORD src1_sel:WORD_1
    v_mfma_f32_16x16x32_bf16 v[116:119], v[196:199], v[72:75], v[116:119]
    ds_read_u16 v106, v0 offset:20416
    ds_read_u16 v98, v1 offset:20416
    v_exp_f16_sdwa v111, -v111 dst_sel:WORD_1 dst_unused:UNUSED_PRESERVE src0_sel:WORD_1
    v_mfma_f32_16x16x32_bf16 v[124:127], v[196:199], v[84:87], v[124:127]
    ds_read_b64_tr_b16 v[196:197], v62 offset:22528
    ds_read_b64_tr_b16 v[198:199], v62 offset:22784
    v_pk_fma_f16 v109, v109, s27, s27
    v_pk_fma_f16 v110, v110, s27, s27
    v_mfma_f32_16x16x32_bf16 v[132:135], v[204:207], v[88:91], v[132:135]
    v_pk_fma_f16 v111, v111, s27, s27
    v_rcp_f16_sdwa v109, v109 dst_sel:WORD_0 dst_unused:UNUSED_PRESERVE src0_sel:WORD_0
    v_mfma_f32_16x16x32_bf16 v[140:143], v[204:207], v[92:95], v[140:143]
    ds_read_b128 v[204:207], v50 offset:37888
    s_setprio 0
    v_rcp_f16_sdwa v110, v110 dst_sel:WORD_0 dst_unused:UNUSED_PRESERVE src0_sel:WORD_0
    v_lshrrev_b32_sdwa v0, 2, v99 dst_sel:WORD_0 dst_unused:UNUSED_PRESERVE src0_sel:DWORD src1_sel:WORD_0
    v_lshrrev_b32_sdwa v1, 2, v99 dst_sel:WORD_0 dst_unused:UNUSED_PRESERVE src0_sel:DWORD src1_sel:WORD_1
    v_mfma_f32_16x16x32_bf16 v[144:147], v[208:211], v[88:91], v[144:147]
    ds_read_u16 v107, v0 offset:20416
    ds_read_u16 v99, v1 offset:20416
    v_rcp_f16_sdwa v111, v111 dst_sel:WORD_0 dst_unused:UNUSED_PRESERVE src0_sel:WORD_0
    v_mfma_f32_16x16x32_bf16 v[152:155], v[208:211], v[92:95], v[152:155]
    ds_read_b128 v[208:211], v50 offset:38912
    v_rcp_f16_sdwa v109, v109 dst_sel:WORD_1 dst_unused:UNUSED_PRESERVE src0_sel:WORD_1
    v_mfma_f32_16x16x32_bf16 v[148:151], v[212:215], v[88:91], v[148:151]
    v_rcp_f16_sdwa v110, v110 dst_sel:WORD_1 dst_unused:UNUSED_PRESERVE src0_sel:WORD_1
    v_mfma_f32_16x16x32_bf16 v[156:159], v[212:215], v[92:95], v[156:159]
    ds_read_b128 v[212:215], v50 offset:39936
    v_rcp_f16_sdwa v111, v111 dst_sel:WORD_1 dst_unused:UNUSED_PRESERVE src0_sel:WORD_1
    v_lshrrev_b32_sdwa v0, 2, v100 dst_sel:WORD_0 dst_unused:UNUSED_PRESERVE src0_sel:DWORD src1_sel:WORD_0
    v_lshrrev_b32_sdwa v1, 2, v100 dst_sel:WORD_0 dst_unused:UNUSED_PRESERVE src0_sel:DWORD src1_sel:WORD_1
    v_mfma_f32_16x16x32_bf16 v[160:163], v[216:219], v[88:91], v[160:163]
    ds_read_u16 v108, v0 offset:20416
    ds_read_u16 v100, v1 offset:20416
    v_fma_mix_f32 v224, v109, v101, 0 op_sel_hi:[1,1,0]
    v_mfma_f32_16x16x32_bf16 v[168:171], v[216:219], v[92:95], v[168:171]
    ds_read_b128 v[216:219], v50 offset:40960
    v_fma_mix_f32 v109, v109, v101, 0 op_sel:[1,1,0] op_sel_hi:[1,1,0]
    v_fma_mix_f32 v225, v110, v102, 0 op_sel_hi:[1,1,0]
    v_mfma_f32_16x16x32_bf16 v[164:167], v[220:223], v[88:91], v[164:167]
    v_fma_mix_f32 v110, v110, v102, 0 op_sel:[1,1,0] op_sel_hi:[1,1,0]
    v_fma_mix_f32 v226, v111, v103, 0 op_sel_hi:[1,1,0]
    v_mfma_f32_16x16x32_bf16 v[172:175], v[220:223], v[92:95], v[172:175]
    ds_read_b128 v[220:223], v50 offset:41984
    v_fma_mix_f32 v111, v111, v103, 0 op_sel:[1,1,0] op_sel_hi:[1,1,0]
    v_cvt_pk_bf16_f32 v101, v224, v109
    v_cvt_pk_bf16_f32 v102, v225, v110
    v_cvt_pk_bf16_f32 v103, v226, v111
    s_waitcnt lgkmcnt(2)
    v_lshl_or_b32 v96, v96, 16, v104
    v_lshl_or_b32 v97, v97, 16, v105
    v_lshl_or_b32 v98, v98, 16, v106
    v_lshl_or_b32 v99, v99, 16, v107
    v_lshl_or_b32 v100, v100, 16, v108
    s_waitcnt vmcnt(2) lgkmcnt(0)
    s_barrier
    v_mfma_f32_16x16x32_bf16 v[128:131], v[200:203], v[96:99], v[128:131]
    s_sub_u32 m0, s34, 12288
    s_movk_i32 s79, 24576
    buffer_load_dwordx4 v51, s[44:47], s79 offen offset:0 lds
    s_add_u32 m0, s34, 11968
    s_setprio 0
    buffer_load_dwordx4 v54, s[36:39], 0 offen offset:320 lds
    v_cvt_pk_f16_f32 v88, v112, v113
    v_cvt_pk_f16_f32 v89, v114, v115
    v_cvt_pk_f16_f32 v90, v116, v117
    v_cvt_pk_f16_f32 v91, v118, v119
    v_mfma_f32_16x16x32_bf16 v[136:139], v[200:203], v[100:103], v[136:139]
    ds_read_b128 v[200:203], v50 offset:18432
    v_cvt_pk_f16_f32 v92, v120, v121
    v_cvt_pk_f16_f32 v93, v122, v123
    v_cvt_pk_f16_f32 v94, v124, v125
    v_cvt_pk_f16_f32 v95, v126, v127
    v_mfma_f32_16x16x32_bf16 v[112:115], v[176:179], v[64:67], 0
    s_setprio 1
    v_and_b32 v88, s42, v88
    v_and_b32 v89, s42, v89
    v_and_b32 v90, s42, v90
    v_mfma_f32_16x16x32_bf16 v[120:123], v[176:179], v[76:79], 0
    s_add_u32 m0, s34, 17728
    ds_read_b64_tr_b16 v[176:177], v49 offset:0
    ds_read_b64_tr_b16 v[178:179], v49 offset:256
    buffer_load_dwordx4 v54, s[36:39], 0 offen offset:704 lds
    v_and_b32 v91, s42, v91
    v_and_b32 v92, s42, v92
    v_lshrrev_b32_sdwa v0, 2, v88 dst_sel:WORD_0 dst_unused:UNUSED_PRESERVE src0_sel:DWORD src1_sel:WORD_0
    v_lshrrev_b32_sdwa v1, 2, v88 dst_sel:WORD_0 dst_unused:UNUSED_PRESERVE src0_sel:DWORD src1_sel:WORD_1
    v_mfma_f32_16x16x32_bf16 v[116:119], v[180:183], v[64:67], 0
    ds_read_u16 v104, v0 offset:20416
    ds_read_u16 v88, v1 offset:20416
    buffer_store_dwordx4 v[240:243], v55, s[8:11], s22 offen offset:64 sc0 sc1 nt
    v_pk_fma_f16 v109, v93, v93, s25
    v_pk_fma_f16 v110, v94, v94, s25
    v_mfma_f32_16x16x32_bf16 v[124:127], v[180:183], v[76:79], 0
    ds_read_b64_tr_b16 v[180:181], v62 offset:0
    ds_read_b64_tr_b16 v[182:183], v62 offset:256
    v_pk_fma_f16 v111, v95, v95, s25
    v_pk_mul_f16 v109, v109, v93
    v_mfma_f32_16x16x32_bf16 v[112:115], v[184:187], v[68:71], v[112:115]
    s_add_u32 m0, s40, 61696
    s_add_u32 s31, s16, 1572864
    buffer_load_dwordx4 v52, s[4:7], s31 offen offset:0 nt lds
    v_pk_mul_f16 v110, v110, v94
    v_pk_mul_f16 v111, v111, v95
    v_mfma_f32_16x16x32_bf16 v[120:123], v[184:187], v[80:83], v[120:123]
    ds_read_b64_tr_b16 v[184:185], v49 offset:2048
    ds_read_b64_tr_b16 v[186:187], v49 offset:2304
    v_exp_f16_sdwa v109, -v109 dst_sel:WORD_0 dst_unused:UNUSED_PRESERVE src0_sel:WORD_0
    v_lshrrev_b32_sdwa v0, 2, v89 dst_sel:WORD_0 dst_unused:UNUSED_PRESERVE src0_sel:DWORD src1_sel:WORD_0
    v_lshrrev_b32_sdwa v1, 2, v89 dst_sel:WORD_0 dst_unused:UNUSED_PRESERVE src0_sel:DWORD src1_sel:WORD_1
    v_mfma_f32_16x16x32_bf16 v[116:119], v[188:191], v[68:71], v[116:119]
    ds_read_u16 v105, v0 offset:20416
    ds_read_u16 v89, v1 offset:20416
    s_setprio 2
    v_exp_f16_sdwa v110, -v110 dst_sel:WORD_0 dst_unused:UNUSED_PRESERVE src0_sel:WORD_0
    v_mfma_f32_16x16x32_bf16 v[124:127], v[188:191], v[80:83], v[124:127]
    ds_read_b64_tr_b16 v[188:189], v62 offset:2048
    ds_read_b64_tr_b16 v[190:191], v62 offset:2304
    v_exp_f16_sdwa v111, -v111 dst_sel:WORD_0 dst_unused:UNUSED_PRESERVE src0_sel:WORD_0
    v_mfma_f32_16x16x32_bf16 v[112:115], v[192:195], v[72:75], v[112:115]
    v_exp_f16_sdwa v109, -v109 dst_sel:WORD_1 dst_unused:UNUSED_PRESERVE src0_sel:WORD_1
    v_mfma_f32_16x16x32_bf16 v[120:123], v[192:195], v[84:87], v[120:123]
    ds_read_b64_tr_b16 v[192:193], v49 offset:4096
    ds_read_b64_tr_b16 v[194:195], v49 offset:4352
    v_exp_f16_sdwa v110, -v110 dst_sel:WORD_1 dst_unused:UNUSED_PRESERVE src0_sel:WORD_1
    v_lshrrev_b32_sdwa v0, 2, v90 dst_sel:WORD_0 dst_unused:UNUSED_PRESERVE src0_sel:DWORD src1_sel:WORD_0
    v_lshrrev_b32_sdwa v1, 2, v90 dst_sel:WORD_0 dst_unused:UNUSED_PRESERVE src0_sel:DWORD src1_sel:WORD_1
    v_mfma_f32_16x16x32_bf16 v[116:119], v[196:199], v[72:75], v[116:119]
    ds_read_u16 v106, v0 offset:20416
    ds_read_u16 v90, v1 offset:20416
    v_exp_f16_sdwa v111, -v111 dst_sel:WORD_1 dst_unused:UNUSED_PRESERVE src0_sel:WORD_1
    v_mfma_f32_16x16x32_bf16 v[124:127], v[196:199], v[84:87], v[124:127]
    ds_read_b64_tr_b16 v[196:197], v62 offset:4096
    ds_read_b64_tr_b16 v[198:199], v62 offset:4352
    v_pk_fma_f16 v109, v109, s27, s27
    v_pk_fma_f16 v110, v110, s27, s27
    v_mfma_f32_16x16x32_bf16 v[132:135], v[204:207], v[96:99], v[132:135]
    v_pk_fma_f16 v111, v111, s27, s27
    v_rcp_f16_sdwa v109, v109 dst_sel:WORD_0 dst_unused:UNUSED_PRESERVE src0_sel:WORD_0
    v_mfma_f32_16x16x32_bf16 v[140:143], v[204:207], v[100:103], v[140:143]
    ds_read_b128 v[204:207], v50 offset:19456
    s_setprio 3
    v_rcp_f16_sdwa v110, v110 dst_sel:WORD_0 dst_unused:UNUSED_PRESERVE src0_sel:WORD_0
    v_lshrrev_b32_sdwa v0, 2, v91 dst_sel:WORD_0 dst_unused:UNUSED_PRESERVE src0_sel:DWORD src1_sel:WORD_0
    v_lshrrev_b32_sdwa v1, 2, v91 dst_sel:WORD_0 dst_unused:UNUSED_PRESERVE src0_sel:DWORD src1_sel:WORD_1
    v_mfma_f32_16x16x32_bf16 v[144:147], v[208:211], v[96:99], v[144:147]
    ds_read_u16 v107, v0 offset:20416
    ds_read_u16 v91, v1 offset:20416
    v_rcp_f16_sdwa v111, v111 dst_sel:WORD_0 dst_unused:UNUSED_PRESERVE src0_sel:WORD_0
    v_mfma_f32_16x16x32_bf16 v[152:155], v[208:211], v[100:103], v[152:155]
    ds_read_b128 v[208:211], v50 offset:20480
    v_rcp_f16_sdwa v109, v109 dst_sel:WORD_1 dst_unused:UNUSED_PRESERVE src0_sel:WORD_1
    v_mfma_f32_16x16x32_bf16 v[148:151], v[212:215], v[96:99], v[148:151]
    v_rcp_f16_sdwa v110, v110 dst_sel:WORD_1 dst_unused:UNUSED_PRESERVE src0_sel:WORD_1
    v_mfma_f32_16x16x32_bf16 v[156:159], v[212:215], v[100:103], v[156:159]
    ds_read_b128 v[212:215], v50 offset:21504
    v_rcp_f16_sdwa v111, v111 dst_sel:WORD_1 dst_unused:UNUSED_PRESERVE src0_sel:WORD_1
    v_lshrrev_b32_sdwa v0, 2, v92 dst_sel:WORD_0 dst_unused:UNUSED_PRESERVE src0_sel:DWORD src1_sel:WORD_0
    v_lshrrev_b32_sdwa v1, 2, v92 dst_sel:WORD_0 dst_unused:UNUSED_PRESERVE src0_sel:DWORD src1_sel:WORD_1
    v_mfma_f32_16x16x32_bf16 v[160:163], v[216:219], v[96:99], v[160:163]
    ds_read_u16 v108, v0 offset:20416
    ds_read_u16 v92, v1 offset:20416
    v_fma_mix_f32 v224, v109, v93, 0 op_sel_hi:[1,1,0]
    v_mfma_f32_16x16x32_bf16 v[168:171], v[216:219], v[100:103], v[168:171]
    ds_read_b128 v[216:219], v50 offset:22528
    v_fma_mix_f32 v109, v109, v93, 0 op_sel:[1,1,0] op_sel_hi:[1,1,0]
    v_fma_mix_f32 v225, v110, v94, 0 op_sel_hi:[1,1,0]
    v_mfma_f32_16x16x32_bf16 v[164:167], v[220:223], v[96:99], v[164:167]
    v_fma_mix_f32 v110, v110, v94, 0 op_sel:[1,1,0] op_sel_hi:[1,1,0]
    v_fma_mix_f32 v226, v111, v95, 0 op_sel_hi:[1,1,0]
    v_mfma_f32_16x16x32_bf16 v[172:175], v[220:223], v[100:103], v[172:175]
    ds_read_b128 v[220:223], v50 offset:23552
    v_fma_mix_f32 v111, v111, v95, 0 op_sel:[1,1,0] op_sel_hi:[1,1,0]
    v_cvt_pk_bf16_f32 v93, v224, v109
    v_cvt_pk_bf16_f32 v94, v225, v110
    v_cvt_pk_bf16_f32 v95, v226, v111
    s_waitcnt lgkmcnt(2)
    v_lshl_or_b32 v88, v88, 16, v104
    v_lshl_or_b32 v89, v89, 16, v105
    v_lshl_or_b32 v90, v90, 16, v106
    v_lshl_or_b32 v91, v91, 16, v107
    v_lshl_or_b32 v92, v92, 16, v108
    s_waitcnt lgkmcnt(0)
    v_mfma_f32_16x16x32_bf16 v[128:131], v[200:203], v[88:91], v[128:131]
    s_setprio 3
    v_cvt_pk_f16_f32 v96, v112, v113
    v_cvt_pk_f16_f32 v97, v114, v115
    v_cvt_pk_f16_f32 v98, v116, v117
    v_cvt_pk_f16_f32 v99, v118, v119
    v_mfma_f32_16x16x32_bf16 v[136:139], v[200:203], v[92:95], v[136:139]
    ds_read_b128 v[200:203], v50 offset:43008
    v_cvt_pk_f16_f32 v100, v120, v121
    v_cvt_pk_f16_f32 v101, v122, v123
    v_cvt_pk_f16_f32 v102, v124, v125
    v_cvt_pk_f16_f32 v103, v126, v127
    v_mfma_f32_16x16x32_bf16 v[112:115], v[176:179], v[64:67], 0
    s_setprio 2
    v_and_b32 v96, s42, v96
    v_and_b32 v97, s42, v97
    v_and_b32 v98, s42, v98
    v_mfma_f32_16x16x32_bf16 v[120:123], v[176:179], v[76:79], 0
    ds_read_b64_tr_b16 v[176:177], v49 offset:6144
    ds_read_b64_tr_b16 v[178:179], v49 offset:6400
    v_and_b32 v99, s42, v99
    v_and_b32 v100, s42, v100
    v_lshrrev_b32_sdwa v0, 2, v96 dst_sel:WORD_0 dst_unused:UNUSED_PRESERVE src0_sel:DWORD src1_sel:WORD_0
    v_lshrrev_b32_sdwa v1, 2, v96 dst_sel:WORD_0 dst_unused:UNUSED_PRESERVE src0_sel:DWORD src1_sel:WORD_1
    v_mfma_f32_16x16x32_bf16 v[116:119], v[180:183], v[64:67], 0
    ds_read_u16 v104, v0 offset:20416
    ds_read_u16 v96, v1 offset:20416
    v_pk_fma_f16 v109, v101, v101, s25
    v_pk_fma_f16 v110, v102, v102, s25
    v_mfma_f32_16x16x32_bf16 v[124:127], v[180:183], v[76:79], 0
    ds_read_b64_tr_b16 v[180:181], v62 offset:6144
    ds_read_b64_tr_b16 v[182:183], v62 offset:6400
    v_pk_fma_f16 v111, v103, v103, s25
    v_pk_mul_f16 v109, v109, v101
    v_mfma_f32_16x16x32_bf16 v[112:115], v[184:187], v[68:71], v[112:115]
    v_pk_mul_f16 v110, v110, v102
    v_pk_mul_f16 v111, v111, v103
    v_mfma_f32_16x16x32_bf16 v[120:123], v[184:187], v[80:83], v[120:123]
    s_add_u32 m0, s41, 61696
    ds_read_b64_tr_b16 v[184:185], v49 offset:8192
    ds_read_b64_tr_b16 v[186:187], v49 offset:8448
    buffer_load_dwordx4 v53, s[4:7], s31 offen offset:0 nt lds
    v_exp_f16_sdwa v109, -v109 dst_sel:WORD_0 dst_unused:UNUSED_PRESERVE src0_sel:WORD_0
    v_lshrrev_b32_sdwa v0, 2, v97 dst_sel:WORD_0 dst_unused:UNUSED_PRESERVE src0_sel:DWORD src1_sel:WORD_0
    v_lshrrev_b32_sdwa v1, 2, v97 dst_sel:WORD_0 dst_unused:UNUSED_PRESERVE src0_sel:DWORD src1_sel:WORD_1
    v_mfma_f32_16x16x32_bf16 v[116:119], v[188:191], v[68:71], v[116:119]
    ds_read_u16 v105, v0 offset:20416
    ds_read_u16 v97, v1 offset:20416
    s_setprio 1
    v_exp_f16_sdwa v110, -v110 dst_sel:WORD_0 dst_unused:UNUSED_PRESERVE src0_sel:WORD_0
    v_mfma_f32_16x16x32_bf16 v[124:127], v[188:191], v[80:83], v[124:127]
    ds_read_b64_tr_b16 v[188:189], v62 offset:8192
    ds_read_b64_tr_b16 v[190:191], v62 offset:8448
    v_exp_f16_sdwa v111, -v111 dst_sel:WORD_0 dst_unused:UNUSED_PRESERVE src0_sel:WORD_0
    v_mfma_f32_16x16x32_bf16 v[112:115], v[192:195], v[72:75], v[112:115]
    v_exp_f16_sdwa v109, -v109 dst_sel:WORD_1 dst_unused:UNUSED_PRESERVE src0_sel:WORD_1
    v_mfma_f32_16x16x32_bf16 v[120:123], v[192:195], v[84:87], v[120:123]
    ds_read_b64_tr_b16 v[192:193], v49 offset:10240
    ds_read_b64_tr_b16 v[194:195], v49 offset:10496
    v_exp_f16_sdwa v110, -v110 dst_sel:WORD_1 dst_unused:UNUSED_PRESERVE src0_sel:WORD_1
    v_lshrrev_b32_sdwa v0, 2, v98 dst_sel:WORD_0 dst_unused:UNUSED_PRESERVE src0_sel:DWORD src1_sel:WORD_0
    v_lshrrev_b32_sdwa v1, 2, v98 dst_sel:WORD_0 dst_unused:UNUSED_PRESERVE src0_sel:DWORD src1_sel:WORD_1
    v_mfma_f32_16x16x32_bf16 v[116:119], v[196:199], v[72:75], v[116:119]
    ds_read_u16 v106, v0 offset:20416
    ds_read_u16 v98, v1 offset:20416
    v_exp_f16_sdwa v111, -v111 dst_sel:WORD_1 dst_unused:UNUSED_PRESERVE src0_sel:WORD_1
    v_mfma_f32_16x16x32_bf16 v[124:127], v[196:199], v[84:87], v[124:127]
    ds_read_b64_tr_b16 v[196:197], v62 offset:10240
    ds_read_b64_tr_b16 v[198:199], v62 offset:10496
    v_pk_fma_f16 v109, v109, s27, s27
    v_pk_fma_f16 v110, v110, s27, s27
    v_mfma_f32_16x16x32_bf16 v[132:135], v[204:207], v[88:91], v[132:135]
    v_pk_fma_f16 v111, v111, s27, s27
    v_rcp_f16_sdwa v109, v109 dst_sel:WORD_0 dst_unused:UNUSED_PRESERVE src0_sel:WORD_0
    v_mfma_f32_16x16x32_bf16 v[140:143], v[204:207], v[92:95], v[140:143]
    ds_read_b128 v[204:207], v50 offset:44032
    s_setprio 0
    v_rcp_f16_sdwa v110, v110 dst_sel:WORD_0 dst_unused:UNUSED_PRESERVE src0_sel:WORD_0
    v_lshrrev_b32_sdwa v0, 2, v99 dst_sel:WORD_0 dst_unused:UNUSED_PRESERVE src0_sel:DWORD src1_sel:WORD_0
    v_lshrrev_b32_sdwa v1, 2, v99 dst_sel:WORD_0 dst_unused:UNUSED_PRESERVE src0_sel:DWORD src1_sel:WORD_1
    v_mfma_f32_16x16x32_bf16 v[144:147], v[208:211], v[88:91], v[144:147]
    ds_read_u16 v107, v0 offset:20416
    ds_read_u16 v99, v1 offset:20416
    v_rcp_f16_sdwa v111, v111 dst_sel:WORD_0 dst_unused:UNUSED_PRESERVE src0_sel:WORD_0
    v_mfma_f32_16x16x32_bf16 v[152:155], v[208:211], v[92:95], v[152:155]
    ds_read_b128 v[208:211], v50 offset:45056
    v_rcp_f16_sdwa v109, v109 dst_sel:WORD_1 dst_unused:UNUSED_PRESERVE src0_sel:WORD_1
    v_mfma_f32_16x16x32_bf16 v[148:151], v[212:215], v[88:91], v[148:151]
    v_rcp_f16_sdwa v110, v110 dst_sel:WORD_1 dst_unused:UNUSED_PRESERVE src0_sel:WORD_1
    v_mfma_f32_16x16x32_bf16 v[156:159], v[212:215], v[92:95], v[156:159]
    ds_read_b128 v[212:215], v50 offset:46080
    v_rcp_f16_sdwa v111, v111 dst_sel:WORD_1 dst_unused:UNUSED_PRESERVE src0_sel:WORD_1
    v_lshrrev_b32_sdwa v0, 2, v100 dst_sel:WORD_0 dst_unused:UNUSED_PRESERVE src0_sel:DWORD src1_sel:WORD_0
    v_lshrrev_b32_sdwa v1, 2, v100 dst_sel:WORD_0 dst_unused:UNUSED_PRESERVE src0_sel:DWORD src1_sel:WORD_1
    v_mfma_f32_16x16x32_bf16 v[160:163], v[216:219], v[88:91], v[160:163]
    ds_read_u16 v108, v0 offset:20416
    ds_read_u16 v100, v1 offset:20416
    v_fma_mix_f32 v224, v109, v101, 0 op_sel_hi:[1,1,0]
    v_mfma_f32_16x16x32_bf16 v[168:171], v[216:219], v[92:95], v[168:171]
    ds_read_b128 v[216:219], v50 offset:47104
    v_fma_mix_f32 v109, v109, v101, 0 op_sel:[1,1,0] op_sel_hi:[1,1,0]
    v_fma_mix_f32 v225, v110, v102, 0 op_sel_hi:[1,1,0]
    v_mfma_f32_16x16x32_bf16 v[164:167], v[220:223], v[88:91], v[164:167]
    v_fma_mix_f32 v110, v110, v102, 0 op_sel:[1,1,0] op_sel_hi:[1,1,0]
    v_fma_mix_f32 v226, v111, v103, 0 op_sel_hi:[1,1,0]
    v_mfma_f32_16x16x32_bf16 v[172:175], v[220:223], v[92:95], v[172:175]
    ds_read_b128 v[220:223], v50 offset:48128
    v_fma_mix_f32 v111, v111, v103, 0 op_sel:[1,1,0] op_sel_hi:[1,1,0]
    v_cvt_pk_bf16_f32 v101, v224, v109
    v_cvt_pk_bf16_f32 v102, v225, v110
    v_cvt_pk_bf16_f32 v103, v226, v111
    s_waitcnt lgkmcnt(2)
    v_lshl_or_b32 v96, v96, 16, v104
    v_lshl_or_b32 v97, v97, 16, v105
    v_lshl_or_b32 v98, v98, 16, v106
    v_lshl_or_b32 v99, v99, 16, v107
    v_lshl_or_b32 v100, v100, 16, v108
    s_waitcnt vmcnt(3) lgkmcnt(0)
    s_barrier
    v_mfma_f32_16x16x32_bf16 v[128:131], v[200:203], v[96:99], v[128:131]
    s_sub_u32 m0, s34, 6144
    s_movk_i32 s79, 30720
    buffer_load_dwordx4 v51, s[44:47], s79 offen offset:0 lds
    s_add_u32 m0, s34, 0
    s_setprio 0
    buffer_load_dwordx4 v54, s[36:39], 0 offen offset:0 lds
    v_cvt_pk_f16_f32 v88, v112, v113
    v_cvt_pk_f16_f32 v89, v114, v115
    v_cvt_pk_f16_f32 v90, v116, v117
    v_cvt_pk_f16_f32 v91, v118, v119
    v_mfma_f32_16x16x32_bf16 v[136:139], v[200:203], v[100:103], v[136:139]
    ds_read_b128 v[200:203], v50 offset:24576
    v_cvt_pk_f16_f32 v92, v120, v121
    v_cvt_pk_f16_f32 v93, v122, v123
    v_cvt_pk_f16_f32 v94, v124, v125
    v_cvt_pk_f16_f32 v95, v126, v127
    v_mfma_f32_16x16x32_bf16 v[112:115], v[176:179], v[64:67], 0
    s_setprio 1
    v_and_b32 v88, s42, v88
    v_and_b32 v89, s42, v89
    v_and_b32 v90, s42, v90
    v_mfma_f32_16x16x32_bf16 v[120:123], v[176:179], v[76:79], 0
    s_add_u32 m0, s34, 5760
    ds_read_b64_tr_b16 v[176:177], v49 offset:12288
    ds_read_b64_tr_b16 v[178:179], v49 offset:12544
    buffer_load_dwordx4 v54, s[36:39], 0 offen offset:384 lds
    v_and_b32 v91, s42, v91
    v_and_b32 v92, s42, v92
    v_lshrrev_b32_sdwa v0, 2, v88 dst_sel:WORD_0 dst_unused:UNUSED_PRESERVE src0_sel:DWORD src1_sel:WORD_0
    v_lshrrev_b32_sdwa v1, 2, v88 dst_sel:WORD_0 dst_unused:UNUSED_PRESERVE src0_sel:DWORD src1_sel:WORD_1
    v_mfma_f32_16x16x32_bf16 v[116:119], v[180:183], v[64:67], 0
    ds_read_u16 v104, v0 offset:20416
    ds_read_u16 v88, v1 offset:20416
    v_pk_fma_f16 v109, v93, v93, s25
    v_pk_fma_f16 v110, v94, v94, s25
    v_mfma_f32_16x16x32_bf16 v[124:127], v[180:183], v[76:79], 0
    ds_read_b64_tr_b16 v[180:181], v62 offset:12288
    ds_read_b64_tr_b16 v[182:183], v62 offset:12544
    v_pk_fma_f16 v111, v95, v95, s25
    v_pk_mul_f16 v109, v109, v93
    v_mfma_f32_16x16x32_bf16 v[112:115], v[184:187], v[68:71], v[112:115]
    v_pk_mul_f16 v110, v110, v94
    v_pk_mul_f16 v111, v111, v95
    v_mfma_f32_16x16x32_bf16 v[120:123], v[184:187], v[80:83], v[120:123]
    ds_read_b64_tr_b16 v[184:185], v49 offset:14336
    ds_read_b64_tr_b16 v[186:187], v49 offset:14592
    v_exp_f16_sdwa v109, -v109 dst_sel:WORD_0 dst_unused:UNUSED_PRESERVE src0_sel:WORD_0
    v_lshrrev_b32_sdwa v0, 2, v89 dst_sel:WORD_0 dst_unused:UNUSED_PRESERVE src0_sel:DWORD src1_sel:WORD_0
    v_lshrrev_b32_sdwa v1, 2, v89 dst_sel:WORD_0 dst_unused:UNUSED_PRESERVE src0_sel:DWORD src1_sel:WORD_1
    v_mfma_f32_16x16x32_bf16 v[116:119], v[188:191], v[68:71], v[116:119]
    ds_read_u16 v105, v0 offset:20416
    ds_read_u16 v89, v1 offset:20416
    s_setprio 2
    v_exp_f16_sdwa v110, -v110 dst_sel:WORD_0 dst_unused:UNUSED_PRESERVE src0_sel:WORD_0
    v_mfma_f32_16x16x32_bf16 v[124:127], v[188:191], v[80:83], v[124:127]
    ds_read_b64_tr_b16 v[188:189], v62 offset:14336
    ds_read_b64_tr_b16 v[190:191], v62 offset:14592
    v_exp_f16_sdwa v111, -v111 dst_sel:WORD_0 dst_unused:UNUSED_PRESERVE src0_sel:WORD_0
    v_mfma_f32_16x16x32_bf16 v[112:115], v[192:195], v[72:75], v[112:115]
    v_exp_f16_sdwa v109, -v109 dst_sel:WORD_1 dst_unused:UNUSED_PRESERVE src0_sel:WORD_1
    v_mfma_f32_16x16x32_bf16 v[120:123], v[192:195], v[84:87], v[120:123]
    ds_read_b64_tr_b16 v[192:193], v49 offset:16384
    ds_read_b64_tr_b16 v[194:195], v49 offset:16640
    v_exp_f16_sdwa v110, -v110 dst_sel:WORD_1 dst_unused:UNUSED_PRESERVE src0_sel:WORD_1
    v_lshrrev_b32_sdwa v0, 2, v90 dst_sel:WORD_0 dst_unused:UNUSED_PRESERVE src0_sel:DWORD src1_sel:WORD_0
    v_lshrrev_b32_sdwa v1, 2, v90 dst_sel:WORD_0 dst_unused:UNUSED_PRESERVE src0_sel:DWORD src1_sel:WORD_1
    v_mfma_f32_16x16x32_bf16 v[116:119], v[196:199], v[72:75], v[116:119]
    ds_read_u16 v106, v0 offset:20416
    ds_read_u16 v90, v1 offset:20416
    v_exp_f16_sdwa v111, -v111 dst_sel:WORD_1 dst_unused:UNUSED_PRESERVE src0_sel:WORD_1
    v_mfma_f32_16x16x32_bf16 v[124:127], v[196:199], v[84:87], v[124:127]
    ds_read_b64_tr_b16 v[196:197], v62 offset:16384
    ds_read_b64_tr_b16 v[198:199], v62 offset:16640
    v_pk_fma_f16 v109, v109, s27, s27
    v_pk_fma_f16 v110, v110, s27, s27
    v_mfma_f32_16x16x32_bf16 v[132:135], v[204:207], v[96:99], v[132:135]
    v_pk_fma_f16 v111, v111, s27, s27
    v_rcp_f16_sdwa v109, v109 dst_sel:WORD_0 dst_unused:UNUSED_PRESERVE src0_sel:WORD_0
    v_mfma_f32_16x16x32_bf16 v[140:143], v[204:207], v[100:103], v[140:143]
    ds_read_b128 v[204:207], v50 offset:25600
    s_setprio 3
    v_rcp_f16_sdwa v110, v110 dst_sel:WORD_0 dst_unused:UNUSED_PRESERVE src0_sel:WORD_0
    v_lshrrev_b32_sdwa v0, 2, v91 dst_sel:WORD_0 dst_unused:UNUSED_PRESERVE src0_sel:DWORD src1_sel:WORD_0
    v_lshrrev_b32_sdwa v1, 2, v91 dst_sel:WORD_0 dst_unused:UNUSED_PRESERVE src0_sel:DWORD src1_sel:WORD_1
    v_mfma_f32_16x16x32_bf16 v[144:147], v[208:211], v[96:99], v[144:147]
    ds_read_u16 v107, v0 offset:20416
    ds_read_u16 v91, v1 offset:20416
    v_rcp_f16_sdwa v111, v111 dst_sel:WORD_0 dst_unused:UNUSED_PRESERVE src0_sel:WORD_0
    v_mfma_f32_16x16x32_bf16 v[152:155], v[208:211], v[100:103], v[152:155]
    ds_read_b128 v[208:211], v50 offset:26624
    v_rcp_f16_sdwa v109, v109 dst_sel:WORD_1 dst_unused:UNUSED_PRESERVE src0_sel:WORD_1
    v_mfma_f32_16x16x32_bf16 v[148:151], v[212:215], v[96:99], v[148:151]
    v_rcp_f16_sdwa v110, v110 dst_sel:WORD_1 dst_unused:UNUSED_PRESERVE src0_sel:WORD_1
    v_mfma_f32_16x16x32_bf16 v[156:159], v[212:215], v[100:103], v[156:159]
    ds_read_b128 v[212:215], v50 offset:27648
    v_rcp_f16_sdwa v111, v111 dst_sel:WORD_1 dst_unused:UNUSED_PRESERVE src0_sel:WORD_1
    v_lshrrev_b32_sdwa v0, 2, v92 dst_sel:WORD_0 dst_unused:UNUSED_PRESERVE src0_sel:DWORD src1_sel:WORD_0
    v_lshrrev_b32_sdwa v1, 2, v92 dst_sel:WORD_0 dst_unused:UNUSED_PRESERVE src0_sel:DWORD src1_sel:WORD_1
    v_mfma_f32_16x16x32_bf16 v[160:163], v[216:219], v[96:99], v[160:163]
    ds_read_u16 v108, v0 offset:20416
    ds_read_u16 v92, v1 offset:20416
    v_fma_mix_f32 v224, v109, v93, 0 op_sel_hi:[1,1,0]
    v_mfma_f32_16x16x32_bf16 v[168:171], v[216:219], v[100:103], v[168:171]
    ds_read_b128 v[216:219], v50 offset:28672
    v_fma_mix_f32 v109, v109, v93, 0 op_sel:[1,1,0] op_sel_hi:[1,1,0]
    v_fma_mix_f32 v225, v110, v94, 0 op_sel_hi:[1,1,0]
    v_mfma_f32_16x16x32_bf16 v[164:167], v[220:223], v[96:99], v[164:167]
    v_fma_mix_f32 v110, v110, v94, 0 op_sel:[1,1,0] op_sel_hi:[1,1,0]
    v_fma_mix_f32 v226, v111, v95, 0 op_sel_hi:[1,1,0]
    v_mfma_f32_16x16x32_bf16 v[172:175], v[220:223], v[100:103], v[172:175]
    ds_read_b128 v[220:223], v50 offset:29696
    v_fma_mix_f32 v111, v111, v95, 0 op_sel:[1,1,0] op_sel_hi:[1,1,0]
    v_cvt_pk_bf16_f32 v93, v224, v109
    v_cvt_pk_bf16_f32 v94, v225, v110
    v_cvt_pk_bf16_f32 v95, v226, v111
    s_waitcnt lgkmcnt(2)
    v_lshl_or_b32 v88, v88, 16, v104
    v_lshl_or_b32 v89, v89, 16, v105
    v_lshl_or_b32 v90, v90, 16, v106
    v_lshl_or_b32 v91, v91, 16, v107
    v_lshl_or_b32 v92, v92, 16, v108
    s_waitcnt lgkmcnt(0)
    v_mfma_f32_16x16x32_bf16 v[128:131], v[200:203], v[88:91], v[128:131]
    s_setprio 3
    v_cvt_pk_f16_f32 v96, v112, v113
    v_cvt_pk_f16_f32 v97, v114, v115
    v_cvt_pk_f16_f32 v98, v116, v117
    v_cvt_pk_f16_f32 v99, v118, v119
    v_mfma_f32_16x16x32_bf16 v[136:139], v[200:203], v[92:95], v[136:139]
    ds_read_b128 v[200:203], v50 offset:36864
    v_cvt_pk_f16_f32 v100, v120, v121
    v_cvt_pk_f16_f32 v101, v122, v123
    v_cvt_pk_f16_f32 v102, v124, v125
    v_cvt_pk_f16_f32 v103, v126, v127
    v_mfma_f32_16x16x32_bf16 v[112:115], v[176:179], v[64:67], 0
    s_setprio 2
    v_and_b32 v96, s42, v96
    v_and_b32 v97, s42, v97
    v_and_b32 v98, s42, v98
    v_mfma_f32_16x16x32_bf16 v[120:123], v[176:179], v[76:79], 0
    ds_read_b64_tr_b16 v[176:177], v49 offset:18432
    ds_read_b64_tr_b16 v[178:179], v49 offset:18688
    v_and_b32 v99, s42, v99
    v_and_b32 v100, s42, v100
    v_lshrrev_b32_sdwa v0, 2, v96 dst_sel:WORD_0 dst_unused:UNUSED_PRESERVE src0_sel:DWORD src1_sel:WORD_0
    v_lshrrev_b32_sdwa v1, 2, v96 dst_sel:WORD_0 dst_unused:UNUSED_PRESERVE src0_sel:DWORD src1_sel:WORD_1
    v_mfma_f32_16x16x32_bf16 v[116:119], v[180:183], v[64:67], 0
    ds_read_u16 v104, v0 offset:20416
    ds_read_u16 v96, v1 offset:20416
    v_pk_fma_f16 v109, v101, v101, s25
    v_pk_fma_f16 v110, v102, v102, s25
    v_mfma_f32_16x16x32_bf16 v[124:127], v[180:183], v[76:79], 0
    ds_read_b64_tr_b16 v[180:181], v62 offset:18432
    ds_read_b64_tr_b16 v[182:183], v62 offset:18688
    v_pk_fma_f16 v111, v103, v103, s25
    v_pk_mul_f16 v109, v109, v101
    v_mfma_f32_16x16x32_bf16 v[112:115], v[184:187], v[68:71], v[112:115]
    v_pk_mul_f16 v110, v110, v102
    v_pk_mul_f16 v111, v111, v103
    v_mfma_f32_16x16x32_bf16 v[120:123], v[184:187], v[80:83], v[120:123]
    ds_read_b64_tr_b16 v[184:185], v49 offset:20480
    ds_read_b64_tr_b16 v[186:187], v49 offset:20736
    v_exp_f16_sdwa v109, -v109 dst_sel:WORD_0 dst_unused:UNUSED_PRESERVE src0_sel:WORD_0
    v_lshrrev_b32_sdwa v0, 2, v97 dst_sel:WORD_0 dst_unused:UNUSED_PRESERVE src0_sel:DWORD src1_sel:WORD_0
    v_lshrrev_b32_sdwa v1, 2, v97 dst_sel:WORD_0 dst_unused:UNUSED_PRESERVE src0_sel:DWORD src1_sel:WORD_1
    v_mfma_f32_16x16x32_bf16 v[116:119], v[188:191], v[68:71], v[116:119]
    ds_read_u16 v105, v0 offset:20416
    ds_read_u16 v97, v1 offset:20416
    s_setprio 1
    v_exp_f16_sdwa v110, -v110 dst_sel:WORD_0 dst_unused:UNUSED_PRESERVE src0_sel:WORD_0
    v_mfma_f32_16x16x32_bf16 v[124:127], v[188:191], v[80:83], v[124:127]
    ds_read_b64_tr_b16 v[188:189], v62 offset:20480
    ds_read_b64_tr_b16 v[190:191], v62 offset:20736
    v_exp_f16_sdwa v111, -v111 dst_sel:WORD_0 dst_unused:UNUSED_PRESERVE src0_sel:WORD_0
    v_mfma_f32_16x16x32_bf16 v[112:115], v[192:195], v[72:75], v[112:115]
    v_exp_f16_sdwa v109, -v109 dst_sel:WORD_1 dst_unused:UNUSED_PRESERVE src0_sel:WORD_1
    v_mfma_f32_16x16x32_bf16 v[120:123], v[192:195], v[84:87], v[120:123]
    ds_read_b64_tr_b16 v[192:193], v49 offset:22528
    ds_read_b64_tr_b16 v[194:195], v49 offset:22784
    v_exp_f16_sdwa v110, -v110 dst_sel:WORD_1 dst_unused:UNUSED_PRESERVE src0_sel:WORD_1
    v_lshrrev_b32_sdwa v0, 2, v98 dst_sel:WORD_0 dst_unused:UNUSED_PRESERVE src0_sel:DWORD src1_sel:WORD_0
    v_lshrrev_b32_sdwa v1, 2, v98 dst_sel:WORD_0 dst_unused:UNUSED_PRESERVE src0_sel:DWORD src1_sel:WORD_1
    v_mfma_f32_16x16x32_bf16 v[116:119], v[196:199], v[72:75], v[116:119]
    ds_read_u16 v106, v0 offset:20416
    ds_read_u16 v98, v1 offset:20416
    v_exp_f16_sdwa v111, -v111 dst_sel:WORD_1 dst_unused:UNUSED_PRESERVE src0_sel:WORD_1
    v_mfma_f32_16x16x32_bf16 v[124:127], v[196:199], v[84:87], v[124:127]
    ds_read_b64_tr_b16 v[196:197], v62 offset:22528
    ds_read_b64_tr_b16 v[198:199], v62 offset:22784
    v_pk_fma_f16 v109, v109, s27, s27
    v_pk_fma_f16 v110, v110, s27, s27
    v_mfma_f32_16x16x32_bf16 v[132:135], v[204:207], v[88:91], v[132:135]
    v_pk_fma_f16 v111, v111, s27, s27
    v_rcp_f16_sdwa v109, v109 dst_sel:WORD_0 dst_unused:UNUSED_PRESERVE src0_sel:WORD_0
    v_mfma_f32_16x16x32_bf16 v[140:143], v[204:207], v[92:95], v[140:143]
    ds_read_b128 v[204:207], v50 offset:37888
    s_setprio 0
    v_rcp_f16_sdwa v110, v110 dst_sel:WORD_0 dst_unused:UNUSED_PRESERVE src0_sel:WORD_0
    v_lshrrev_b32_sdwa v0, 2, v99 dst_sel:WORD_0 dst_unused:UNUSED_PRESERVE src0_sel:DWORD src1_sel:WORD_0
    v_lshrrev_b32_sdwa v1, 2, v99 dst_sel:WORD_0 dst_unused:UNUSED_PRESERVE src0_sel:DWORD src1_sel:WORD_1
    v_mfma_f32_16x16x32_bf16 v[144:147], v[208:211], v[88:91], v[144:147]
    ds_read_u16 v107, v0 offset:20416
    ds_read_u16 v99, v1 offset:20416
    v_rcp_f16_sdwa v111, v111 dst_sel:WORD_0 dst_unused:UNUSED_PRESERVE src0_sel:WORD_0
    v_mfma_f32_16x16x32_bf16 v[152:155], v[208:211], v[92:95], v[152:155]
    ds_read_b128 v[208:211], v50 offset:38912
    v_rcp_f16_sdwa v109, v109 dst_sel:WORD_1 dst_unused:UNUSED_PRESERVE src0_sel:WORD_1
    v_mfma_f32_16x16x32_bf16 v[148:151], v[212:215], v[88:91], v[148:151]
    v_rcp_f16_sdwa v110, v110 dst_sel:WORD_1 dst_unused:UNUSED_PRESERVE src0_sel:WORD_1
    v_mfma_f32_16x16x32_bf16 v[156:159], v[212:215], v[92:95], v[156:159]
    ds_read_b128 v[212:215], v50 offset:39936
    v_rcp_f16_sdwa v111, v111 dst_sel:WORD_1 dst_unused:UNUSED_PRESERVE src0_sel:WORD_1
    v_lshrrev_b32_sdwa v0, 2, v100 dst_sel:WORD_0 dst_unused:UNUSED_PRESERVE src0_sel:DWORD src1_sel:WORD_0
    v_lshrrev_b32_sdwa v1, 2, v100 dst_sel:WORD_0 dst_unused:UNUSED_PRESERVE src0_sel:DWORD src1_sel:WORD_1
    v_mfma_f32_16x16x32_bf16 v[160:163], v[216:219], v[88:91], v[160:163]
    ds_read_u16 v108, v0 offset:20416
    ds_read_u16 v100, v1 offset:20416
    v_fma_mix_f32 v224, v109, v101, 0 op_sel_hi:[1,1,0]
    v_mfma_f32_16x16x32_bf16 v[168:171], v[216:219], v[92:95], v[168:171]
    ds_read_b128 v[216:219], v50 offset:40960
    v_fma_mix_f32 v109, v109, v101, 0 op_sel:[1,1,0] op_sel_hi:[1,1,0]
    v_fma_mix_f32 v225, v110, v102, 0 op_sel_hi:[1,1,0]
    v_mfma_f32_16x16x32_bf16 v[164:167], v[220:223], v[88:91], v[164:167]
    v_fma_mix_f32 v110, v110, v102, 0 op_sel:[1,1,0] op_sel_hi:[1,1,0]
    v_fma_mix_f32 v226, v111, v103, 0 op_sel_hi:[1,1,0]
    v_mfma_f32_16x16x32_bf16 v[172:175], v[220:223], v[92:95], v[172:175]
    ds_read_b128 v[220:223], v50 offset:41984
    v_fma_mix_f32 v111, v111, v103, 0 op_sel:[1,1,0] op_sel_hi:[1,1,0]
    v_cvt_pk_bf16_f32 v101, v224, v109
    v_cvt_pk_bf16_f32 v102, v225, v110
    v_cvt_pk_bf16_f32 v103, v226, v111
    s_waitcnt lgkmcnt(2)
    v_lshl_or_b32 v96, v96, 16, v104
    v_lshl_or_b32 v97, v97, 16, v105
    v_lshl_or_b32 v98, v98, 16, v106
    v_lshl_or_b32 v99, v99, 16, v107
    v_lshl_or_b32 v100, v100, 16, v108
    s_waitcnt vmcnt(0) lgkmcnt(0)
    s_barrier
    v_mfma_f32_16x16x32_bf16 v[128:131], v[200:203], v[96:99], v[128:131]
    s_sub_u32 m0, s34, 12288
    s_movk_i32 s79, 0
    buffer_load_dwordx4 v51, s[44:47], s79 offen offset:0 lds
    s_add_u32 m0, s34, 12224
    s_setprio 0
    buffer_load_dwordx4 v54, s[36:39], 0 offen offset:64 lds
    v_cvt_pk_f16_f32 v88, v112, v113
    v_cvt_pk_f16_f32 v89, v114, v115
    v_cvt_pk_f16_f32 v90, v116, v117
    v_cvt_pk_f16_f32 v91, v118, v119
    v_mfma_f32_16x16x32_bf16 v[136:139], v[200:203], v[100:103], v[136:139]
    ds_read_b128 v[200:203], v50 offset:30720
    v_cvt_pk_f16_f32 v92, v120, v121
    v_cvt_pk_f16_f32 v93, v122, v123
    v_cvt_pk_f16_f32 v94, v124, v125
    v_cvt_pk_f16_f32 v95, v126, v127
    v_mfma_f32_16x16x32_bf16 v[112:115], v[176:179], v[64:67], 0
    s_setprio 1
    v_and_b32 v88, s42, v88
    v_and_b32 v89, s42, v89
    v_and_b32 v90, s42, v90
    v_mfma_f32_16x16x32_bf16 v[120:123], v[176:179], v[76:79], 0
    s_add_u32 m0, s34, 17984
    ds_read_b64_tr_b16 v[176:177], v49 offset:0
    ds_read_b64_tr_b16 v[178:179], v49 offset:256
    buffer_load_dwordx4 v54, s[36:39], 0 offen offset:448 lds
    v_and_b32 v91, s42, v91
    v_and_b32 v92, s42, v92
    v_lshrrev_b32_sdwa v0, 2, v88 dst_sel:WORD_0 dst_unused:UNUSED_PRESERVE src0_sel:DWORD src1_sel:WORD_0
    v_lshrrev_b32_sdwa v1, 2, v88 dst_sel:WORD_0 dst_unused:UNUSED_PRESERVE src0_sel:DWORD src1_sel:WORD_1
    v_mfma_f32_16x16x32_bf16 v[116:119], v[180:183], v[64:67], 0
    ds_read_u16 v104, v0 offset:20416
    ds_read_u16 v88, v1 offset:20416
    buffer_store_dwordx4 v[244:247], v55, s[8:11], s22 offen offset:1600 sc0 sc1 nt
    s_add_u32 s16, s16, 1572864
    s_add_u32 s21, s21, 1
    v_pk_fma_f16 v109, v93, v93, s25
    v_pk_fma_f16 v110, v94, v94, s25
    v_mfma_f32_16x16x32_bf16 v[124:127], v[180:183], v[76:79], 0
    ds_read_b64_tr_b16 v[180:181], v62 offset:0
    ds_read_b64_tr_b16 v[182:183], v62 offset:256
    v_pk_fma_f16 v111, v95, v95, s25
    v_pk_mul_f16 v109, v109, v93
    v_mfma_f32_16x16x32_bf16 v[112:115], v[184:187], v[68:71], v[112:115]
    v_pk_mul_f16 v110, v110, v94
    v_pk_mul_f16 v111, v111, v95
    v_mfma_f32_16x16x32_bf16 v[120:123], v[184:187], v[80:83], v[120:123]
    ds_read_b64_tr_b16 v[184:185], v49 offset:2048
    ds_read_b64_tr_b16 v[186:187], v49 offset:2304
    v_exp_f16_sdwa v109, -v109 dst_sel:WORD_0 dst_unused:UNUSED_PRESERVE src0_sel:WORD_0
    v_lshrrev_b32_sdwa v0, 2, v89 dst_sel:WORD_0 dst_unused:UNUSED_PRESERVE src0_sel:DWORD src1_sel:WORD_0
    v_lshrrev_b32_sdwa v1, 2, v89 dst_sel:WORD_0 dst_unused:UNUSED_PRESERVE src0_sel:DWORD src1_sel:WORD_1
    v_mfma_f32_16x16x32_bf16 v[116:119], v[188:191], v[68:71], v[116:119]
    ds_read_u16 v105, v0 offset:20416
    ds_read_u16 v89, v1 offset:20416
    s_setprio 2
    v_exp_f16_sdwa v110, -v110 dst_sel:WORD_0 dst_unused:UNUSED_PRESERVE src0_sel:WORD_0
    v_mfma_f32_16x16x32_bf16 v[124:127], v[188:191], v[80:83], v[124:127]
    ds_read_b64_tr_b16 v[188:189], v62 offset:2048
    ds_read_b64_tr_b16 v[190:191], v62 offset:2304
    v_exp_f16_sdwa v111, -v111 dst_sel:WORD_0 dst_unused:UNUSED_PRESERVE src0_sel:WORD_0
    v_mfma_f32_16x16x32_bf16 v[112:115], v[192:195], v[72:75], v[112:115]
    buffer_store_dwordx4 v[248:251], v55, s[8:11], s22 offen offset:128 sc0 sc1 nt
    v_exp_f16_sdwa v109, -v109 dst_sel:WORD_1 dst_unused:UNUSED_PRESERVE src0_sel:WORD_1
    v_mfma_f32_16x16x32_bf16 v[120:123], v[192:195], v[84:87], v[120:123]
    ds_read_b64_tr_b16 v[192:193], v49 offset:4096
    ds_read_b64_tr_b16 v[194:195], v49 offset:4352
    v_exp_f16_sdwa v110, -v110 dst_sel:WORD_1 dst_unused:UNUSED_PRESERVE src0_sel:WORD_1
    v_lshrrev_b32_sdwa v0, 2, v90 dst_sel:WORD_0 dst_unused:UNUSED_PRESERVE src0_sel:DWORD src1_sel:WORD_0
    v_lshrrev_b32_sdwa v1, 2, v90 dst_sel:WORD_0 dst_unused:UNUSED_PRESERVE src0_sel:DWORD src1_sel:WORD_1
    v_mfma_f32_16x16x32_bf16 v[116:119], v[196:199], v[72:75], v[116:119]
    ds_read_u16 v106, v0 offset:20416
    ds_read_u16 v90, v1 offset:20416
    v_exp_f16_sdwa v111, -v111 dst_sel:WORD_1 dst_unused:UNUSED_PRESERVE src0_sel:WORD_1
    v_mfma_f32_16x16x32_bf16 v[124:127], v[196:199], v[84:87], v[124:127]
    ds_read_b64_tr_b16 v[196:197], v62 offset:4096
    ds_read_b64_tr_b16 v[198:199], v62 offset:4352
    v_pk_fma_f16 v109, v109, s27, s27
    v_pk_fma_f16 v110, v110, s27, s27
    v_mfma_f32_16x16x32_bf16 v[132:135], v[204:207], v[96:99], v[132:135]
    v_pk_fma_f16 v111, v111, s27, s27
    v_rcp_f16_sdwa v109, v109 dst_sel:WORD_0 dst_unused:UNUSED_PRESERVE src0_sel:WORD_0
    v_mfma_f32_16x16x32_bf16 v[140:143], v[204:207], v[100:103], v[140:143]
    ds_read_b128 v[204:207], v50 offset:31744
    s_setprio 3
    v_rcp_f16_sdwa v110, v110 dst_sel:WORD_0 dst_unused:UNUSED_PRESERVE src0_sel:WORD_0
    v_lshrrev_b32_sdwa v0, 2, v91 dst_sel:WORD_0 dst_unused:UNUSED_PRESERVE src0_sel:DWORD src1_sel:WORD_0
    v_lshrrev_b32_sdwa v1, 2, v91 dst_sel:WORD_0 dst_unused:UNUSED_PRESERVE src0_sel:DWORD src1_sel:WORD_1
    v_mfma_f32_16x16x32_bf16 v[144:147], v[208:211], v[96:99], v[144:147]
    ds_read_u16 v107, v0 offset:20416
    ds_read_u16 v91, v1 offset:20416
    v_rcp_f16_sdwa v111, v111 dst_sel:WORD_0 dst_unused:UNUSED_PRESERVE src0_sel:WORD_0
    v_mfma_f32_16x16x32_bf16 v[152:155], v[208:211], v[100:103], v[152:155]
    ds_read_b128 v[208:211], v50 offset:32768
    v_rcp_f16_sdwa v109, v109 dst_sel:WORD_1 dst_unused:UNUSED_PRESERVE src0_sel:WORD_1
    v_mfma_f32_16x16x32_bf16 v[148:151], v[212:215], v[96:99], v[148:151]
    v_rcp_f16_sdwa v110, v110 dst_sel:WORD_1 dst_unused:UNUSED_PRESERVE src0_sel:WORD_1
    v_mfma_f32_16x16x32_bf16 v[156:159], v[212:215], v[100:103], v[156:159]
    ds_read_b128 v[212:215], v50 offset:33792
    v_rcp_f16_sdwa v111, v111 dst_sel:WORD_1 dst_unused:UNUSED_PRESERVE src0_sel:WORD_1
    v_lshrrev_b32_sdwa v0, 2, v92 dst_sel:WORD_0 dst_unused:UNUSED_PRESERVE src0_sel:DWORD src1_sel:WORD_0
    v_lshrrev_b32_sdwa v1, 2, v92 dst_sel:WORD_0 dst_unused:UNUSED_PRESERVE src0_sel:DWORD src1_sel:WORD_1
    v_mfma_f32_16x16x32_bf16 v[160:163], v[216:219], v[96:99], v[160:163]
    ds_read_u16 v108, v0 offset:20416
    ds_read_u16 v92, v1 offset:20416
    v_fma_mix_f32 v224, v109, v93, 0 op_sel_hi:[1,1,0]
    v_mfma_f32_16x16x32_bf16 v[168:171], v[216:219], v[100:103], v[168:171]
    ds_read_b128 v[216:219], v50 offset:34816
    v_fma_mix_f32 v109, v109, v93, 0 op_sel:[1,1,0] op_sel_hi:[1,1,0]
    v_fma_mix_f32 v225, v110, v94, 0 op_sel_hi:[1,1,0]
    v_mfma_f32_16x16x32_bf16 v[164:167], v[220:223], v[96:99], v[164:167]
    v_fma_mix_f32 v110, v110, v94, 0 op_sel:[1,1,0] op_sel_hi:[1,1,0]
    v_fma_mix_f32 v226, v111, v95, 0 op_sel_hi:[1,1,0]
    v_mfma_f32_16x16x32_bf16 v[172:175], v[220:223], v[100:103], v[172:175]
    ds_read_b128 v[220:223], v50 offset:35840
    v_fma_mix_f32 v111, v111, v95, 0 op_sel:[1,1,0] op_sel_hi:[1,1,0]
    v_cvt_pk_bf16_f32 v93, v224, v109
    v_cvt_pk_bf16_f32 v94, v225, v110
    v_cvt_pk_bf16_f32 v95, v226, v111
    s_waitcnt lgkmcnt(2)
    v_lshl_or_b32 v88, v88, 16, v104
    v_lshl_or_b32 v89, v89, 16, v105
    v_lshl_or_b32 v90, v90, 16, v106
    v_lshl_or_b32 v91, v91, 16, v107
    v_lshl_or_b32 v92, v92, 16, v108
    s_waitcnt lgkmcnt(0)
    s_setprio 3
    v_mfma_f32_16x16x32_bf16 v[128:131], v[200:203], v[88:91], v[128:131]
    ds_read_b64 v[64:65], v47 offset:0
    v_add_u32 v3, v41, v45
    v_cvt_pk_f16_f32 v96, v112, v113
    v_cvt_pk_f16_f32 v97, v114, v115
    v_cvt_pk_f16_f32 v98, v116, v117
    v_mfma_f32_16x16x32_bf16 v[136:139], v[200:203], v[92:95], v[136:139]
    ds_read_b128 v[200:203], v50 offset:43008
    ds_read_b64 v[66:67], v47 offset:8
    v_cvt_pk_f16_f32 v99, v118, v119
    v_and_b32 v96, s42, v96
    v_and_b32 v97, s42, v97
    v_mfma_f32_16x16x32_bf16 v[132:135], v[204:207], v[88:91], v[132:135]
    ds_read_b64 v[68:69], v47 offset:64
    buffer_store_dwordx4 v[252:255], v55, s[8:11], s22 offen offset:1664 sc0 sc1 nt
    v_pk_fma_f16 v106, v98, v98, s25
    v_pk_fma_f16 v107, v99, v99, s25
    v_pk_mul_f16 v106, v106, v98
    v_mfma_f32_16x16x32_bf16 v[140:143], v[204:207], v[92:95], v[140:143]
    ds_read_b128 v[204:207], v50 offset:44032
    ds_read_b64 v[70:71], v47 offset:72
    v_pk_mul_f16 v107, v107, v99
    v_exp_f16_sdwa v106, -v106 dst_sel:WORD_0 dst_unused:UNUSED_PRESERVE src0_sel:WORD_0
    v_lshrrev_b32_sdwa v0, 2, v96 dst_sel:WORD_0 dst_unused:UNUSED_PRESERVE src0_sel:DWORD src1_sel:WORD_0
    v_lshrrev_b32_sdwa v1, 2, v96 dst_sel:WORD_0 dst_unused:UNUSED_PRESERVE src0_sel:DWORD src1_sel:WORD_1
    v_mfma_f32_16x16x32_bf16 v[144:147], v[208:211], v[88:91], v[144:147]
    ds_read_u16 v104, v0 offset:20416
    ds_read_u16 v96, v1 offset:20416
    ds_read_b64 v[72:73], v47 offset:128
    v_exp_f16_sdwa v107, -v107 dst_sel:WORD_0 dst_unused:UNUSED_PRESERVE src0_sel:WORD_0
    v_exp_f16_sdwa v106, -v106 dst_sel:WORD_1 dst_unused:UNUSED_PRESERVE src0_sel:WORD_1
    v_mfma_f32_16x16x32_bf16 v[152:155], v[208:211], v[92:95], v[152:155]
    ds_read_b128 v[208:211], v50 offset:45056
    ds_read_b64 v[74:75], v47 offset:136
    v_exp_f16_sdwa v107, -v107 dst_sel:WORD_1 dst_unused:UNUSED_PRESERVE src0_sel:WORD_1
    v_pk_fma_f16 v106, v106, s27, s27
    v_mfma_f32_16x16x32_bf16 v[148:151], v[212:215], v[88:91], v[148:151]
    ds_read_b64 v[76:77], v48 offset:0
    v_pk_fma_f16 v107, v107, s27, s27
    v_rcp_f16_sdwa v106, v106 dst_sel:WORD_0 dst_unused:UNUSED_PRESERVE src0_sel:WORD_0
    v_lshrrev_b32_sdwa v0, 2, v97 dst_sel:WORD_0 dst_unused:UNUSED_PRESERVE src0_sel:DWORD src1_sel:WORD_0
    v_lshrrev_b32_sdwa v1, 2, v97 dst_sel:WORD_0 dst_unused:UNUSED_PRESERVE src0_sel:DWORD src1_sel:WORD_1
    v_mfma_f32_16x16x32_bf16 v[156:159], v[212:215], v[92:95], v[156:159]
    ds_read_u16 v105, v0 offset:20416
    ds_read_u16 v97, v1 offset:20416
    ds_read_b128 v[212:215], v50 offset:46080
    ds_read_b64 v[78:79], v48 offset:8
    v_rcp_f16_sdwa v107, v107 dst_sel:WORD_0 dst_unused:UNUSED_PRESERVE src0_sel:WORD_0
    v_rcp_f16_sdwa v106, v106 dst_sel:WORD_1 dst_unused:UNUSED_PRESERVE src0_sel:WORD_1
    v_mfma_f32_16x16x32_bf16 v[160:163], v[216:219], v[88:91], v[160:163]
    ds_read_b64 v[80:81], v48 offset:64
    v_rcp_f16_sdwa v107, v107 dst_sel:WORD_1 dst_unused:UNUSED_PRESERVE src0_sel:WORD_1
    v_mfma_f32_16x16x32_bf16 v[168:171], v[216:219], v[92:95], v[168:171]
    ds_read_b128 v[216:219], v50 offset:47104
    ds_read_b64 v[82:83], v48 offset:72
    v_fma_mix_f32 v224, v106, v98, 0 op_sel_hi:[1,1,0]
    v_fma_mix_f32 v106, v106, v98, 0 op_sel:[1,1,0] op_sel_hi:[1,1,0]
    v_fma_mix_f32 v225, v107, v99, 0 op_sel_hi:[1,1,0]
    v_mfma_f32_16x16x32_bf16 v[164:167], v[220:223], v[88:91], v[164:167]
    ds_read_b64 v[84:85], v48 offset:128
    v_fma_mix_f32 v107, v107, v99, 0 op_sel:[1,1,0] op_sel_hi:[1,1,0]
    v_cvt_pk_bf16_f32 v98, v224, v106
    v_cvt_pk_bf16_f32 v99, v225, v107
    s_waitcnt lgkmcnt(6)
    v_lshl_or_b32 v96, v96, 16, v104
    v_mfma_f32_16x16x32_bf16 v[172:175], v[220:223], v[92:95], v[172:175]
    ds_read_b128 v[220:223], v50 offset:48128
    ds_read_b64 v[86:87], v48 offset:136
    s_cmp_eq_u32 s21, 1
    s_cselect_b32 s79, 0, 1572864
    s_add_u32 s22, s22, s79
    v_lshl_or_b32 v97, v97, 16, v105
    s_setprio 1
    ds_read_b64 v[228:229], v3 offset:11520
    ds_read_b64 v[230:231], v3 offset:11712
    v_cvt_pk_f16_f32 v100, v120, v121
    v_cvt_pk_f16_f32 v101, v122, v123
    v_cvt_pk_f16_f32 v102, v124, v125
    v_cvt_pk_f16_f32 v103, v126, v127
    v_and_b32 v100, s42, v100
    v_and_b32 v101, s42, v101
    s_waitcnt lgkmcnt(12)
    v_mfma_f32_16x16x32_bf16 v[128:131], v[200:203], v[96:99], v[128:131]
    v_pk_fma_f16 v110, v102, v102, s25
    v_pk_fma_f16 v111, v103, v103, s25
    v_pk_mul_f16 v110, v110, v102
    v_pk_mul_f16 v111, v111, v103
    v_exp_f16_sdwa v110, -v110 dst_sel:WORD_0 dst_unused:UNUSED_PRESERVE src0_sel:WORD_0
    v_lshrrev_b32_sdwa v0, 2, v100 dst_sel:WORD_0 dst_unused:UNUSED_PRESERVE src0_sel:DWORD src1_sel:WORD_0
    v_lshrrev_b32_sdwa v1, 2, v100 dst_sel:WORD_0 dst_unused:UNUSED_PRESERVE src0_sel:DWORD src1_sel:WORD_1
    v_mfma_f32_16x16x32_bf16 v[132:135], v[204:207], v[96:99], v[132:135]
    ds_read_u16 v108, v0 offset:20416
    ds_read_u16 v100, v1 offset:20416
    v_exp_f16_sdwa v111, -v111 dst_sel:WORD_0 dst_unused:UNUSED_PRESERVE src0_sel:WORD_0
    v_exp_f16_sdwa v110, -v110 dst_sel:WORD_1 dst_unused:UNUSED_PRESERVE src0_sel:WORD_1
    v_exp_f16_sdwa v111, -v111 dst_sel:WORD_1 dst_unused:UNUSED_PRESERVE src0_sel:WORD_1
    s_waitcnt lgkmcnt(11)
    v_mfma_f32_16x16x32_bf16 v[144:147], v[208:211], v[96:99], v[144:147]
    v_pk_fma_f16 v110, v110, s27, s27
    v_pk_fma_f16 v111, v111, s27, s27
    v_rcp_f16_sdwa v110, v110 dst_sel:WORD_0 dst_unused:UNUSED_PRESERVE src0_sel:WORD_0
    v_lshrrev_b32_sdwa v0, 2, v101 dst_sel:WORD_0 dst_unused:UNUSED_PRESERVE src0_sel:DWORD src1_sel:WORD_0
    v_lshrrev_b32_sdwa v1, 2, v101 dst_sel:WORD_0 dst_unused:UNUSED_PRESERVE src0_sel:DWORD src1_sel:WORD_1
    v_mfma_f32_16x16x32_bf16 v[148:151], v[212:215], v[96:99], v[148:151]
    ds_read_u16 v109, v0 offset:20416
    ds_read_u16 v101, v1 offset:20416
    v_rcp_f16_sdwa v111, v111 dst_sel:WORD_0 dst_unused:UNUSED_PRESERVE src0_sel:WORD_0
    v_rcp_f16_sdwa v110, v110 dst_sel:WORD_1 dst_unused:UNUSED_PRESERVE src0_sel:WORD_1
    v_rcp_f16_sdwa v111, v111 dst_sel:WORD_1 dst_unused:UNUSED_PRESERVE src0_sel:WORD_1
    s_waitcnt lgkmcnt(10)
    v_mfma_f32_16x16x32_bf16 v[160:163], v[216:219], v[96:99], v[160:163]
    v_fma_mix_f32 v224, v110, v102, 0 op_sel_hi:[1,1,0]
    v_fma_mix_f32 v110, v110, v102, 0 op_sel:[1,1,0] op_sel_hi:[1,1,0]
    v_fma_mix_f32 v225, v111, v103, 0 op_sel_hi:[1,1,0]
    v_fma_mix_f32 v111, v111, v103, 0 op_sel:[1,1,0] op_sel_hi:[1,1,0]
    v_cvt_pk_bf16_f32 v102, v224, v110
    s_waitcnt lgkmcnt(7)
    v_mfma_f32_16x16x32_bf16 v[164:167], v[220:223], v[96:99], v[164:167]
    v_cvt_pk_bf16_f32 v103, v225, v111
    s_waitcnt lgkmcnt(0)
    v_lshl_or_b32 v100, v100, 16, v108
    v_lshl_or_b32 v101, v101, 16, v109
    ds_read_b64 v[224:225], v3 offset:7680
    ds_read_b64 v[226:227], v3 offset:7872
    s_setprio 3
    s_waitcnt lgkmcnt(4)
    s_barrier
    v_mfma_f32_16x16x32_bf16 v[136:139], v[200:203], v[100:103], v[136:139]
    ds_read_b64 v[200:201], v41 offset:0
    ds_read_b64 v[202:203], v41 offset:192
    v_cmp_class_f32 vcc, v128, s43
    s_nop 0
    s_or_b64 s[56:57], s[56:57], vcc
    v_cvt_pk_bf16_f32 v232, v128, v129
    v_mfma_f32_16x16x32_bf16 v[140:143], v[204:207], v[100:103], v[140:143]
    ds_read_b64 v[204:205], v41 offset:3840
    ds_read_b64 v[206:207], v41 offset:4032
    v_cvt_pk_bf16_f32 v233, v130, v131
    v_cvt_pk_bf16_f32 v234, v132, v133
    v_cvt_pk_bf16_f32 v235, v134, v135
    v_mfma_f32_16x16x32_bf16 v[152:155], v[208:211], v[100:103], v[152:155]
    ds_read_b64 v[208:209], v41 offset:7680
    ds_read_b64 v[210:211], v41 offset:7872
    v_cvt_pk_bf16_f32 v240, v144, v145
    v_cvt_pk_bf16_f32 v241, v146, v147
    v_cvt_pk_bf16_f32 v242, v148, v149
    v_mfma_f32_16x16x32_bf16 v[156:159], v[212:215], v[100:103], v[156:159]
    ds_read_b64 v[212:213], v41 offset:11520
    ds_read_b64 v[214:215], v41 offset:11712
    v_cvt_pk_bf16_f32 v243, v150, v151
    v_cvt_pk_bf16_f32 v248, v160, v161
    v_cvt_pk_bf16_f32 v249, v162, v163
    v_mfma_f32_16x16x32_bf16 v[168:171], v[216:219], v[100:103], v[168:171]
    ds_read_b64 v[216:217], v3 offset:0
    ds_read_b64 v[218:219], v3 offset:192
    v_cvt_pk_bf16_f32 v250, v164, v165
    v_cvt_pk_bf16_f32 v251, v166, v167
    v_mfma_f32_16x16x32_bf16 v[172:175], v[220:223], v[100:103], v[172:175]
    ds_read_b64 v[220:221], v3 offset:3840
    ds_read_b64 v[222:223], v3 offset:4032
    s_mov_b32 s10, 50331648
    v_mfma_f32_16x16x32_bf16 v[128:131], v[58:61], v[64:67], 0
    v_cmp_class_f32 vcc, v136, s43
    s_nop 0
    s_or_b64 s[56:57], s[56:57], vcc
    v_cvt_pk_bf16_f32 v236, v136, v137
    v_mfma_f32_16x16x32_bf16 v[132:135], v[56:59], v[64:67], 0
    v_cvt_pk_bf16_f32 v237, v138, v139
    v_cvt_pk_bf16_f32 v238, v140, v141
    v_cvt_pk_bf16_f32 v239, v142, v143
    v_mfma_f32_16x16x32_bf16 v[144:147], v[58:61], v[68:71], 0
    v_cvt_pk_bf16_f32 v244, v152, v153
    v_cvt_pk_bf16_f32 v245, v154, v155
    v_cvt_pk_bf16_f32 v246, v156, v157
    v_mfma_f32_16x16x32_bf16 v[148:151], v[56:59], v[68:71], 0
    v_cvt_pk_bf16_f32 v247, v158, v159
    v_cvt_pk_bf16_f32 v252, v168, v169
    v_cvt_pk_bf16_f32 v253, v170, v171
    v_mfma_f32_16x16x32_bf16 v[160:163], v[58:61], v[72:75], 0
    v_cvt_pk_bf16_f32 v254, v172, v173
    v_cvt_pk_bf16_f32 v255, v174, v175
    v_mfma_f32_16x16x32_bf16 v[164:167], v[56:59], v[72:75], 0
    v_mfma_f32_16x16x32_bf16 v[136:139], v[58:61], v[76:79], 0
    v_mfma_f32_16x16x32_bf16 v[140:143], v[56:59], v[76:79], 0
    v_mfma_f32_16x16x32_bf16 v[152:155], v[58:61], v[80:83], 0
    v_mfma_f32_16x16x32_bf16 v[156:159], v[56:59], v[80:83], 0
    v_mfma_f32_16x16x32_bf16 v[168:171], v[58:61], v[84:87], 0
    v_mfma_f32_16x16x32_bf16 v[172:175], v[56:59], v[84:87], 0
    s_waitcnt lgkmcnt(0)
    s_setprio 2
    v_mfma_f32_16x16x32_bf16 v[112:115], v[4:7], v[216:219], 0
    v_add_u32 v3, v42, v45
    v_add_u32 v72, v41, v44
    v_add_u32 v73, v72, v45
    ds_read_b64 v[80:81], v42 offset:0
    ds_read_b64 v[82:83], v42 offset:192
    v_smfmac_f32_16x16x64_bf16 v[112:115], v[8:11], v[200:207], v40
    ds_read_b64 v[84:85], v42 offset:3840
    ds_read_b64 v[86:87], v42 offset:4032
    v_smfmac_f32_16x16x64_bf16 v[112:115], v[12:15], v[208:215], v40
    ds_read_b64 v[88:89], v42 offset:7680
    ds_read_b64 v[90:91], v42 offset:7872
    v_mfma_f32_16x16x32_bf16 v[116:119], v[4:7], v[220:223], 0
    ds_read_b64 v[92:93], v42 offset:11520
    ds_read_b64 v[94:95], v42 offset:11712
    v_smfmac_f32_16x16x64_bf16 v[116:119], v[8:11], v[204:211], v40
    ds_read_b64 v[96:97], v3 offset:0
    ds_read_b64 v[98:99], v3 offset:192
    v_smfmac_f32_16x16x64_bf16 v[116:119], v[12:15], v[212:219], v40
    ds_read_b64 v[100:101], v3 offset:3840
    ds_read_b64 v[102:103], v3 offset:4032
    v_cvt_pk_bf16_f32 v64, v112, v113
    v_cvt_pk_bf16_f32 v65, v114, v115
    ds_write_b64 v72, v[64:65] offset:7680
    v_mfma_f32_16x16x32_bf16 v[120:123], v[4:7], v[224:227], 0
    ds_read_b64 v[104:105], v3 offset:7680
    v_smfmac_f32_16x16x64_bf16 v[120:123], v[8:11], v[208:215], v40
    ds_read_b64 v[106:107], v3 offset:7872
    v_smfmac_f32_16x16x64_bf16 v[120:123], v[12:15], v[216:223], v40
    ds_read_b64 v[108:109], v3 offset:11520
    v_cvt_pk_bf16_f32 v66, v116, v117
    v_cvt_pk_bf16_f32 v67, v118, v119
    ds_write_b64 v72, v[66:67] offset:11520
    v_mfma_f32_16x16x32_bf16 v[124:127], v[4:7], v[228:231], 0
    ds_read_b64 v[110:111], v3 offset:11712
    v_smfmac_f32_16x16x64_bf16 v[124:127], v[8:11], v[212:219], v40
    v_smfmac_f32_16x16x64_bf16 v[124:127], v[12:15], v[220:227], v40
    v_cvt_pk_bf16_f32 v68, v120, v121
    v_cvt_pk_bf16_f32 v69, v122, v123
    ds_write_b64 v73, v[68:69] offset:0
    s_waitcnt lgkmcnt(1)
    s_setprio 1
    v_mfma_f32_16x16x32_bf16 v[112:115], v[16:19], v[96:99], 0
    v_add_u32 v3, v43, v45
    v_add_u32 v74, v42, v44
    v_add_u32 v75, v74, v45
    ds_read_b64 v[200:201], v43 offset:0
    ds_read_b64 v[202:203], v43 offset:192
    v_smfmac_f32_16x16x64_bf16 v[112:115], v[20:23], v[80:87], v40
    ds_read_b64 v[204:205], v43 offset:3840
    ds_read_b64 v[206:207], v43 offset:4032
    v_smfmac_f32_16x16x64_bf16 v[112:115], v[24:27], v[88:95], v40
    ds_read_b64 v[208:209], v43 offset:7680
    ds_read_b64 v[210:211], v43 offset:7872
    v_cvt_pk_bf16_f32 v70, v124, v125
    v_cvt_pk_bf16_f32 v71, v126, v127
    ds_write_b64 v73, v[70:71] offset:3840
    v_mfma_f32_16x16x32_bf16 v[116:119], v[16:19], v[100:103], 0
    ds_read_b64 v[212:213], v43 offset:11520
    ds_read_b64 v[214:215], v43 offset:11712
    v_smfmac_f32_16x16x64_bf16 v[116:119], v[20:23], v[84:91], v40
    ds_read_b64 v[216:217], v3 offset:0
    ds_read_b64 v[218:219], v3 offset:192
    v_smfmac_f32_16x16x64_bf16 v[116:119], v[24:27], v[92:99], v40
    ds_read_b64 v[220:221], v3 offset:3840
    ds_read_b64 v[222:223], v3 offset:4032
    v_cvt_pk_bf16_f32 v64, v112, v113
    v_cvt_pk_bf16_f32 v65, v114, v115
    ds_write_b64 v74, v[64:65] offset:7680
    v_mfma_f32_16x16x32_bf16 v[120:123], v[16:19], v[104:107], 0
    ds_read_b64 v[224:225], v3 offset:7680
    v_smfmac_f32_16x16x64_bf16 v[120:123], v[20:23], v[88:95], v40
    ds_read_b64 v[226:227], v3 offset:7872
    v_smfmac_f32_16x16x64_bf16 v[120:123], v[24:27], v[96:103], v40
    ds_read_b64 v[228:229], v3 offset:11520
    v_cvt_pk_bf16_f32 v66, v116, v117
    v_cvt_pk_bf16_f32 v67, v118, v119
    ds_write_b64 v74, v[66:67] offset:11520
    v_mfma_f32_16x16x32_bf16 v[124:127], v[16:19], v[108:111], 0
    ds_read_b64 v[230:231], v3 offset:11712
    v_smfmac_f32_16x16x64_bf16 v[124:127], v[20:23], v[92:99], v40
    v_smfmac_f32_16x16x64_bf16 v[124:127], v[24:27], v[100:107], v40
    v_cvt_pk_bf16_f32 v68, v120, v121
    v_cvt_pk_bf16_f32 v69, v122, v123
    ds_write_b64 v75, v[68:69] offset:0
    s_waitcnt lgkmcnt(1)
    s_setprio 0
    v_mfma_f32_16x16x32_bf16 v[112:115], v[28:31], v[216:219], 0
    v_add_u32 v72, v43, v44
    v_add_u32 v73, v72, v45
    v_smfmac_f32_16x16x64_bf16 v[112:115], v[32:35], v[200:207], v40
    v_smfmac_f32_16x16x64_bf16 v[112:115], v[36:39], v[208:215], v40
    v_cvt_pk_bf16_f32 v70, v124, v125
    v_cvt_pk_bf16_f32 v71, v126, v127
    ds_write_b64 v75, v[70:71] offset:3840
    v_mfma_f32_16x16x32_bf16 v[116:119], v[28:31], v[220:223], 0
    v_smfmac_f32_16x16x64_bf16 v[116:119], v[32:35], v[204:211], v40
    v_smfmac_f32_16x16x64_bf16 v[116:119], v[36:39], v[212:219], v40
    s_nop 1
    v_cvt_pk_bf16_f32 v64, v112, v113
    v_cvt_pk_bf16_f32 v65, v114, v115
    ds_write_b64 v72, v[64:65] offset:7680
    v_mfma_f32_16x16x32_bf16 v[120:123], v[28:31], v[224:227], 0
    v_smfmac_f32_16x16x64_bf16 v[120:123], v[32:35], v[208:215], v40
    v_smfmac_f32_16x16x64_bf16 v[120:123], v[36:39], v[216:223], v40
    v_cvt_pk_bf16_f32 v66, v116, v117
    v_cvt_pk_bf16_f32 v67, v118, v119
    ds_write_b64 v72, v[66:67] offset:11520
    v_mfma_f32_16x16x32_bf16 v[124:127], v[28:31], v[228:231], 0
    v_smfmac_f32_16x16x64_bf16 v[124:127], v[32:35], v[212:219], v40
    v_smfmac_f32_16x16x64_bf16 v[124:127], v[36:39], v[220:227], v40
    s_nop 1
    v_cvt_pk_bf16_f32 v68, v120, v121
    v_cvt_pk_bf16_f32 v69, v122, v123
    ds_write_b64 v73, v[68:69] offset:0
    s_nop 2
    v_cvt_pk_bf16_f32 v70, v124, v125
    v_cvt_pk_bf16_f32 v71, v126, v127
    ds_write_b64 v73, v[70:71] offset:3840
    s_waitcnt lgkmcnt(0)
    s_barrier
    ds_read_b64 v[64:65], v47 offset:0
    ds_read_b64 v[66:67], v47 offset:8
    ds_read_b64 v[68:69], v47 offset:64
    ds_read_b64 v[70:71], v47 offset:72
    ds_read_b64 v[72:73], v47 offset:128
    ds_read_b64 v[74:75], v47 offset:136
    ds_read_b64 v[76:77], v48 offset:0
    ds_read_b64 v[78:79], v48 offset:8
    ds_read_b64 v[80:81], v48 offset:64
    ds_read_b64 v[82:83], v48 offset:72
    ds_read_b64 v[84:85], v48 offset:128
    ds_read_b64 v[86:87], v48 offset:136
    s_cmp_lt_u32 s21, 3
    s_cbranch_scc1 L_stats
L_last:
    s_setprio 3
    s_waitcnt lgkmcnt(10)
    v_dot2_f32_bf16 v0, v64, s26, 0
    v_dot2_f32_bf16 v2, v64, v64, 0
    v_dot2_f32_bf16 v0, v65, s26, v0
    v_dot2_f32_bf16 v2, v65, v65, v2
    v_dot2_f32_bf16 v0, v66, s26, v0
    v_dot2_f32_bf16 v2, v66, v66, v2
    v_dot2_f32_bf16 v0, v67, s26, v0
    v_dot2_f32_bf16 v2, v67, v67, v2
    s_waitcnt lgkmcnt(8)
    v_dot2_f32_bf16 v0, v68, s26, v0
    v_dot2_f32_bf16 v2, v68, v68, v2
    v_dot2_f32_bf16 v0, v69, s26, v0
    v_dot2_f32_bf16 v2, v69, v69, v2
    v_dot2_f32_bf16 v0, v70, s26, v0
    v_dot2_f32_bf16 v2, v70, v70, v2
    v_dot2_f32_bf16 v0, v71, s26, v0
    v_dot2_f32_bf16 v2, v71, v71, v2
    s_waitcnt lgkmcnt(6)
    v_dot2_f32_bf16 v0, v72, s26, v0
    v_dot2_f32_bf16 v2, v72, v72, v2
    v_dot2_f32_bf16 v0, v73, s26, v0
    v_dot2_f32_bf16 v2, v73, v73, v2
    v_dot2_f32_bf16 v0, v74, s26, v0
    v_dot2_f32_bf16 v2, v74, v74, v2
    v_dot2_f32_bf16 v0, v75, s26, v0
    v_dot2_f32_bf16 v2, v75, v75, v2
    s_waitcnt lgkmcnt(4)
    v_dot2_f32_bf16 v1, v76, s26, 0
    v_dot2_f32_bf16 v3, v76, v76, 0
    v_dot2_f32_bf16 v1, v77, s26, v1
    v_dot2_f32_bf16 v3, v77, v77, v3
    v_dot2_f32_bf16 v1, v78, s26, v1
    v_dot2_f32_bf16 v3, v78, v78, v3
    v_dot2_f32_bf16 v1, v79, s26, v1
    v_dot2_f32_bf16 v3, v79, v79, v3
    s_waitcnt lgkmcnt(2)
    v_dot2_f32_bf16 v1, v80, s26, v1
    v_dot2_f32_bf16 v3, v80, v80, v3
    v_dot2_f32_bf16 v1, v81, s26, v1
    v_dot2_f32_bf16 v3, v81, v81, v3
    v_dot2_f32_bf16 v1, v82, s26, v1
    v_dot2_f32_bf16 v3, v82, v82, v3
    v_dot2_f32_bf16 v1, v83, s26, v1
    v_dot2_f32_bf16 v3, v83, v83, v3
    s_waitcnt lgkmcnt(0)
    v_dot2_f32_bf16 v1, v84, s26, v1
    v_dot2_f32_bf16 v3, v84, v84, v3
    v_dot2_f32_bf16 v1, v85, s26, v1
    v_dot2_f32_bf16 v3, v85, v85, v3
    v_dot2_f32_bf16 v1, v86, s26, v1
    v_dot2_f32_bf16 v3, v86, v86, v3
    v_dot2_f32_bf16 v1, v87, s26, v1
    v_dot2_f32_bf16 v3, v87, v87, v3
    s_nop 1
    v_permlane32_swap_b32 v0, v1
    v_permlane32_swap_b32 v2, v3
    v_add_f32 v0, v0, v1
    v_add_f32 v2, v2, v3
    s_nop 1
    v_permlane16_swap_b32 v0, v2
    v_add_f32 v0, v0, v2
    v_mov_b32 v1, v0
    v_mov_b32 v2, s29
    s_nop 0
    v_permlane16_swap_b32 v0, v1
    v_mul_f32 v0, s28, v0
    v_fma_f32 v1, v1, s28, v2
    v_fma_f32 v1, -v0, v0, v1
    v_max_f32 v1, v1, v2
    v_rsq_f32 v1, v1
    s_nop 0
    v_mul_f32 v1, s30, v1
    v_cvt_pk_bf16_f32 v2, 0, v1
    v_mul_f32 v0, -v0, v2
    v_mov_b32 v3, v2
    v_mov_b32 v1, v0
    s_nop 0
    v_permlane32_swap_b32 v2, v3
    v_permlane32_swap_b32 v0, v1
    v_lshrrev_b32 v224, 16, v2
    v_lshrrev_b32 v225, 16, v3
    s_setprio 2
    v_dot2_f32_bf16 v88, v64, v224, v0
    v_dot2_f32_bf16 v89, v64, v2, v0
    v_dot2_f32_bf16 v90, v65, v224, v0
    v_dot2_f32_bf16 v91, v65, v2, v0
    v_dot2_f32_bf16 v92, v66, v224, v0
    v_dot2_f32_bf16 v93, v66, v2, v0
    v_dot2_f32_bf16 v94, v67, v224, v0
    v_dot2_f32_bf16 v95, v67, v2, v0
    v_dot2_f32_bf16 v96, v68, v224, v0
    v_dot2_f32_bf16 v97, v68, v2, v0
    v_dot2_f32_bf16 v98, v69, v224, v0
    v_dot2_f32_bf16 v99, v69, v2, v0
    v_dot2_f32_bf16 v100, v70, v224, v0
    v_dot2_f32_bf16 v101, v70, v2, v0
    v_dot2_f32_bf16 v102, v71, v224, v0
    v_dot2_f32_bf16 v103, v71, v2, v0
    v_cvt_pk_bf16_f32 v64, v88, v89
    v_cvt_pk_bf16_f32 v65, v90, v91
    v_cvt_pk_bf16_f32 v66, v92, v93
    v_cvt_pk_bf16_f32 v67, v94, v95
    s_setprio 1
    v_dot2_f32_bf16 v104, v72, v224, v0
    v_dot2_f32_bf16 v105, v72, v2, v0
    v_dot2_f32_bf16 v106, v73, v224, v0
    v_dot2_f32_bf16 v107, v73, v2, v0
    v_dot2_f32_bf16 v108, v74, v224, v0
    v_dot2_f32_bf16 v109, v74, v2, v0
    v_dot2_f32_bf16 v110, v75, v224, v0
    v_dot2_f32_bf16 v111, v75, v2, v0
    v_cvt_pk_bf16_f32 v68, v96, v97
    v_cvt_pk_bf16_f32 v69, v98, v99
    v_cvt_pk_bf16_f32 v70, v100, v101
    v_cvt_pk_bf16_f32 v71, v102, v103
    v_dot2_f32_bf16 v88, v76, v225, v1
    v_dot2_f32_bf16 v89, v76, v3, v1
    v_dot2_f32_bf16 v90, v77, v225, v1
    v_dot2_f32_bf16 v91, v77, v3, v1
    v_dot2_f32_bf16 v92, v78, v225, v1
    v_dot2_f32_bf16 v93, v78, v3, v1
    v_dot2_f32_bf16 v94, v79, v225, v1
    v_dot2_f32_bf16 v95, v79, v3, v1
    v_cvt_pk_bf16_f32 v72, v104, v105
    v_cvt_pk_bf16_f32 v73, v106, v107
    v_cvt_pk_bf16_f32 v74, v108, v109
    v_cvt_pk_bf16_f32 v75, v110, v111
    s_setprio 0
    v_dot2_f32_bf16 v96, v80, v225, v1
    v_dot2_f32_bf16 v97, v80, v3, v1
    v_dot2_f32_bf16 v98, v81, v225, v1
    v_dot2_f32_bf16 v99, v81, v3, v1
    v_dot2_f32_bf16 v100, v82, v225, v1
    v_dot2_f32_bf16 v101, v82, v3, v1
    v_dot2_f32_bf16 v102, v83, v225, v1
    v_dot2_f32_bf16 v103, v83, v3, v1
    v_cvt_pk_bf16_f32 v76, v88, v89
    v_cvt_pk_bf16_f32 v77, v90, v91
    v_cvt_pk_bf16_f32 v78, v92, v93
    v_cvt_pk_bf16_f32 v79, v94, v95
    v_dot2_f32_bf16 v104, v84, v225, v1
    v_dot2_f32_bf16 v105, v84, v3, v1
    v_dot2_f32_bf16 v106, v85, v225, v1
    v_dot2_f32_bf16 v107, v85, v3, v1
    v_dot2_f32_bf16 v108, v86, v225, v1
    v_dot2_f32_bf16 v109, v86, v3, v1
    v_dot2_f32_bf16 v110, v87, v225, v1
    v_dot2_f32_bf16 v111, v87, v3, v1
    v_cvt_pk_bf16_f32 v80, v96, v97
    v_cvt_pk_bf16_f32 v81, v98, v99
    v_cvt_pk_bf16_f32 v82, v100, v101
    v_cvt_pk_bf16_f32 v83, v102, v103
    v_mfma_f32_16x16x32_bf16 v[112:115], v[176:179], v[64:67], 0
    v_mov_b32 v0, 0x20000
    v_mfma_f32_16x16x32_bf16 v[116:119], v[180:183], v[64:67], 0
    v_mov_b32 v1, 0x20000
    v_mfma_f32_16x16x32_bf16 v[112:115], v[184:187], v[68:71], v[112:115]
    v_cvt_pk_bf16_f32 v84, v104, v105
    v_cvt_pk_bf16_f32 v85, v106, v107
    v_cvt_pk_bf16_f32 v86, v108, v109
    v_cvt_pk_bf16_f32 v87, v110, v111
    v_mfma_f32_16x16x32_bf16 v[116:119], v[188:191], v[68:71], v[116:119]
    v_mfma_f32_16x16x32_bf16 v[112:115], v[192:195], v[72:75], v[112:115]
    v_mfma_f32_16x16x32_bf16 v[116:119], v[196:199], v[72:75], v[116:119]
    v_mfma_f32_16x16x32_bf16 v[120:123], v[176:179], v[76:79], 0
    ds_read_b64_tr_b16 v[176:177], v49 offset:6144
    ds_read_b64_tr_b16 v[178:179], v49 offset:6400
    v_mfma_f32_16x16x32_bf16 v[124:127], v[180:183], v[76:79], 0
    ds_read_b64_tr_b16 v[180:181], v62 offset:6144
    ds_read_b64_tr_b16 v[182:183], v62 offset:6400
    v_mfma_f32_16x16x32_bf16 v[120:123], v[184:187], v[80:83], v[120:123]
    ds_read_b64_tr_b16 v[184:185], v49 offset:8192
    ds_read_b64_tr_b16 v[186:187], v49 offset:8448
    v_mfma_f32_16x16x32_bf16 v[124:127], v[188:191], v[80:83], v[124:127]
    ds_read_b64_tr_b16 v[188:189], v62 offset:8192
    ds_read_b64_tr_b16 v[190:191], v62 offset:8448
    v_mfma_f32_16x16x32_bf16 v[120:123], v[192:195], v[84:87], v[120:123]
    ds_read_b64_tr_b16 v[192:193], v49 offset:10240
    ds_read_b64_tr_b16 v[194:195], v49 offset:10496
    v_mfma_f32_16x16x32_bf16 v[124:127], v[196:199], v[84:87], v[124:127]
    ds_read_b64_tr_b16 v[196:197], v62 offset:10240
    ds_read_b64_tr_b16 v[198:199], v62 offset:10496
    s_waitcnt vmcnt(3) lgkmcnt(0)
    s_barrier
    s_sub_u32 m0, s34, 6144
    s_movk_i32 s79, 6144
    buffer_load_dwordx4 v51, s[44:47], s79 offen offset:0 lds
    s_add_u32 m0, s34, -128
    s_setprio 0
    buffer_load_dwordx4 v54, s[36:39], 0 offen offset:128 lds
    v_cvt_pk_f16_f32 v88, v112, v113
    v_cvt_pk_f16_f32 v89, v114, v115
    v_cvt_pk_f16_f32 v90, v116, v117
    v_cvt_pk_f16_f32 v91, v118, v119
    v_cvt_pk_f16_f32 v92, v120, v121
    v_cvt_pk_f16_f32 v93, v122, v123
    v_cvt_pk_f16_f32 v94, v124, v125
    v_cvt_pk_f16_f32 v95, v126, v127
    v_mfma_f32_16x16x32_bf16 v[112:115], v[176:179], v[64:67], 0
    s_setprio 1
    v_and_b32 v88, s42, v88
    v_and_b32 v89, s42, v89
    v_and_b32 v90, s42, v90
    v_and_b32 v91, s42, v91
    v_mfma_f32_16x16x32_bf16 v[120:123], v[176:179], v[76:79], 0
    s_add_u32 m0, s34, 5632
    ds_read_b64_tr_b16 v[176:177], v49 offset:12288
    ds_read_b64_tr_b16 v[178:179], v49 offset:12544
    ds_read_b128 v[200:203], v50 offset:0
    buffer_load_dwordx4 v54, s[36:39], 0 offen offset:512 lds
    v_and_b32 v92, s42, v92
    v_pk_fma_f16 v109, v93, v93, s25
    v_pk_fma_f16 v110, v94, v94, s25
    v_pk_fma_f16 v111, v95, v95, s25
    v_lshrrev_b32_sdwa v0, 2, v88 dst_sel:WORD_0 dst_unused:UNUSED_PRESERVE src0_sel:DWORD src1_sel:WORD_0
    v_lshrrev_b32_sdwa v1, 2, v88 dst_sel:WORD_0 dst_unused:UNUSED_PRESERVE src0_sel:DWORD src1_sel:WORD_1
    v_mfma_f32_16x16x32_bf16 v[116:119], v[180:183], v[64:67], 0
    ds_read_u16 v104, v0 offset:20416
    ds_read_u16 v88, v1 offset:20416
    buffer_store_dwordx4 v[232:235], v55, s[8:11], s22 offen offset:0 sc0 sc1 nt
    v_pk_mul_f16 v109, v109, v93
    v_pk_mul_f16 v110, v110, v94
    v_pk_mul_f16 v111, v111, v95
    v_exp_f16_sdwa v109, -v109 dst_sel:WORD_0 dst_unused:UNUSED_PRESERVE src0_sel:WORD_0
    v_mfma_f32_16x16x32_bf16 v[124:127], v[180:183], v[76:79], 0
    ds_read_b64_tr_b16 v[180:181], v62 offset:12288
    ds_read_b64_tr_b16 v[182:183], v62 offset:12544
    ds_read_b128 v[204:207], v50 offset:1024
    s_setprio 2
    v_exp_f16_sdwa v110, -v110 dst_sel:WORD_0 dst_unused:UNUSED_PRESERVE src0_sel:WORD_0
    v_exp_f16_sdwa v111, -v111 dst_sel:WORD_0 dst_unused:UNUSED_PRESERVE src0_sel:WORD_0
    v_lshrrev_b32_sdwa v0, 2, v89 dst_sel:WORD_0 dst_unused:UNUSED_PRESERVE src0_sel:DWORD src1_sel:WORD_0
    v_lshrrev_b32_sdwa v1, 2, v89 dst_sel:WORD_0 dst_unused:UNUSED_PRESERVE src0_sel:DWORD src1_sel:WORD_1
    v_mfma_f32_16x16x32_bf16 v[112:115], v[184:187], v[68:71], v[112:115]
    ds_read_u16 v105, v0 offset:20416
    ds_read_u16 v89, v1 offset:20416
    v_exp_f16_sdwa v109, -v109 dst_sel:WORD_1 dst_unused:UNUSED_PRESERVE src0_sel:WORD_1
    v_exp_f16_sdwa v110, -v110 dst_sel:WORD_1 dst_unused:UNUSED_PRESERVE src0_sel:WORD_1
    v_mfma_f32_16x16x32_bf16 v[120:123], v[184:187], v[80:83], v[120:123]
    ds_read_b64_tr_b16 v[184:185], v49 offset:14336
    ds_read_b64_tr_b16 v[186:187], v49 offset:14592
    ds_read_b128 v[208:211], v50 offset:2048
    v_exp_f16_sdwa v111, -v111 dst_sel:WORD_1 dst_unused:UNUSED_PRESERVE src0_sel:WORD_1
    v_pk_fma_f16 v109, v109, s27, s27
    v_lshrrev_b32_sdwa v0, 2, v90 dst_sel:WORD_0 dst_unused:UNUSED_PRESERVE src0_sel:DWORD src1_sel:WORD_0
    v_lshrrev_b32_sdwa v1, 2, v90 dst_sel:WORD_0 dst_unused:UNUSED_PRESERVE src0_sel:DWORD src1_sel:WORD_1
    v_mfma_f32_16x16x32_bf16 v[116:119], v[188:191], v[68:71], v[116:119]
    ds_read_u16 v106, v0 offset:20416
    ds_read_u16 v90, v1 offset:20416
    v_pk_fma_f16 v110, v110, s27, s27
    v_pk_fma_f16 v111, v111, s27, s27
    v_rcp_f16_sdwa v109, v109 dst_sel:WORD_0 dst_unused:UNUSED_PRESERVE src0_sel:WORD_0
    v_mfma_f32_16x16x32_bf16 v[124:127], v[188:191], v[80:83], v[124:127]
    ds_read_b64_tr_b16 v[188:189], v62 offset:14336
    ds_read_b64_tr_b16 v[190:191], v62 offset:14592
    ds_read_b128 v[212:215], v50 offset:3072
    s_setprio 3
    v_rcp_f16_sdwa v110, v110 dst_sel:WORD_0 dst_unused:UNUSED_PRESERVE src0_sel:WORD_0
    v_rcp_f16_sdwa v111, v111 dst_sel:WORD_0 dst_unused:UNUSED_PRESERVE src0_sel:WORD_0
    v_lshrrev_b32_sdwa v0, 2, v91 dst_sel:WORD_0 dst_unused:UNUSED_PRESERVE src0_sel:DWORD src1_sel:WORD_0
    v_lshrrev_b32_sdwa v1, 2, v91 dst_sel:WORD_0 dst_unused:UNUSED_PRESERVE src0_sel:DWORD src1_sel:WORD_1
    v_mfma_f32_16x16x32_bf16 v[112:115], v[192:195], v[72:75], v[112:115]
    ds_read_u16 v107, v0 offset:20416
    ds_read_u16 v91, v1 offset:20416
    v_rcp_f16_sdwa v109, v109 dst_sel:WORD_1 dst_unused:UNUSED_PRESERVE src0_sel:WORD_1
    v_rcp_f16_sdwa v110, v110 dst_sel:WORD_1 dst_unused:UNUSED_PRESERVE src0_sel:WORD_1
    v_mfma_f32_16x16x32_bf16 v[120:123], v[192:195], v[84:87], v[120:123]
    ds_read_b64_tr_b16 v[192:193], v49 offset:16384
    ds_read_b64_tr_b16 v[194:195], v49 offset:16640
    ds_read_b128 v[216:219], v50 offset:4096
    v_rcp_f16_sdwa v111, v111 dst_sel:WORD_1 dst_unused:UNUSED_PRESERVE src0_sel:WORD_1
    v_fma_mix_f32 v224, v109, v93, 0 op_sel_hi:[1,1,0]
    v_fma_mix_f32 v109, v109, v93, 0 op_sel:[1,1,0] op_sel_hi:[1,1,0]
    v_lshrrev_b32_sdwa v0, 2, v92 dst_sel:WORD_0 dst_unused:UNUSED_PRESERVE src0_sel:DWORD src1_sel:WORD_0
    v_lshrrev_b32_sdwa v1, 2, v92 dst_sel:WORD_0 dst_unused:UNUSED_PRESERVE src0_sel:DWORD src1_sel:WORD_1
    v_mfma_f32_16x16x32_bf16 v[116:119], v[196:199], v[72:75], v[116:119]
    ds_read_u16 v108, v0 offset:20416
    ds_read_u16 v92, v1 offset:20416
    v_fma_mix_f32 v225, v110, v94, 0 op_sel_hi:[1,1,0]
    v_fma_mix_f32 v110, v110, v94, 0 op_sel:[1,1,0] op_sel_hi:[1,1,0]
    v_fma_mix_f32 v226, v111, v95, 0 op_sel_hi:[1,1,0]
    v_mfma_f32_16x16x32_bf16 v[124:127], v[196:199], v[84:87], v[124:127]
    ds_read_b64_tr_b16 v[196:197], v62 offset:16384
    ds_read_b64_tr_b16 v[198:199], v62 offset:16640
    ds_read_b128 v[220:223], v50 offset:5120
    v_fma_mix_f32 v111, v111, v95, 0 op_sel:[1,1,0] op_sel_hi:[1,1,0]
    v_cvt_pk_bf16_f32 v93, v224, v109
    v_cvt_pk_bf16_f32 v94, v225, v110
    v_cvt_pk_bf16_f32 v95, v226, v111
    s_waitcnt lgkmcnt(3)
    v_lshl_or_b32 v88, v88, 16, v104
    v_lshl_or_b32 v89, v89, 16, v105
    v_lshl_or_b32 v90, v90, 16, v106
    v_lshl_or_b32 v91, v91, 16, v107
    v_lshl_or_b32 v92, v92, 16, v108
    s_waitcnt lgkmcnt(0)
    v_mfma_f32_16x16x32_bf16 v[128:131], v[200:203], v[88:91], v[128:131]
    s_setprio 3
    v_cvt_pk_f16_f32 v96, v112, v113
    v_cvt_pk_f16_f32 v97, v114, v115
    v_cvt_pk_f16_f32 v98, v116, v117
    v_cvt_pk_f16_f32 v99, v118, v119
    v_mfma_f32_16x16x32_bf16 v[136:139], v[200:203], v[92:95], v[136:139]
    ds_read_b128 v[200:203], v50 offset:36864
    v_cvt_pk_f16_f32 v100, v120, v121
    v_cvt_pk_f16_f32 v101, v122, v123
    v_cvt_pk_f16_f32 v102, v124, v125
    v_cvt_pk_f16_f32 v103, v126, v127
    v_mfma_f32_16x16x32_bf16 v[112:115], v[176:179], v[64:67], 0
    s_setprio 2
    v_and_b32 v96, s42, v96
    v_and_b32 v97, s42, v97
    v_and_b32 v98, s42, v98
    v_mfma_f32_16x16x32_bf16 v[120:123], v[176:179], v[76:79], 0
    ds_read_b64_tr_b16 v[176:177], v49 offset:18432
    ds_read_b64_tr_b16 v[178:179], v49 offset:18688
    v_and_b32 v99, s42, v99
    v_and_b32 v100, s42, v100
    v_lshrrev_b32_sdwa v0, 2, v96 dst_sel:WORD_0 dst_unused:UNUSED_PRESERVE src0_sel:DWORD src1_sel:WORD_0
    v_lshrrev_b32_sdwa v1, 2, v96 dst_sel:WORD_0 dst_unused:UNUSED_PRESERVE src0_sel:DWORD src1_sel:WORD_1
    v_mfma_f32_16x16x32_bf16 v[116:119], v[180:183], v[64:67], 0
    ds_read_u16 v104, v0 offset:20416
    ds_read_u16 v96, v1 offset:20416
    buffer_store_dwordx4 v[236:239], v55, s[8:11], s22 offen offset:1536 sc0 sc1 nt
    v_pk_fma_f16 v109, v101, v101, s25
    v_pk_fma_f16 v110, v102, v102, s25
    v_mfma_f32_16x16x32_bf16 v[124:127], v[180:183], v[76:79], 0
    ds_read_b64_tr_b16 v[180:181], v62 offset:18432
    ds_read_b64_tr_b16 v[182:183], v62 offset:18688
    v_pk_fma_f16 v111, v103, v103, s25
    v_pk_mul_f16 v109, v109, v101
    v_mfma_f32_16x16x32_bf16 v[112:115], v[184:187], v[68:71], v[112:115]
    v_pk_mul_f16 v110, v110, v102
    v_pk_mul_f16 v111, v111, v103
    v_mfma_f32_16x16x32_bf16 v[120:123], v[184:187], v[80:83], v[120:123]
    ds_read_b64_tr_b16 v[184:185], v49 offset:20480
    ds_read_b64_tr_b16 v[186:187], v49 offset:20736
    v_exp_f16_sdwa v109, -v109 dst_sel:WORD_0 dst_unused:UNUSED_PRESERVE src0_sel:WORD_0
    v_lshrrev_b32_sdwa v0, 2, v97 dst_sel:WORD_0 dst_unused:UNUSED_PRESERVE src0_sel:DWORD src1_sel:WORD_0
    v_lshrrev_b32_sdwa v1, 2, v97 dst_sel:WORD_0 dst_unused:UNUSED_PRESERVE src0_sel:DWORD src1_sel:WORD_1
    v_mfma_f32_16x16x32_bf16 v[116:119], v[188:191], v[68:71], v[116:119]
    ds_read_u16 v105, v0 offset:20416
    ds_read_u16 v97, v1 offset:20416
    s_setprio 1
    v_exp_f16_sdwa v110, -v110 dst_sel:WORD_0 dst_unused:UNUSED_PRESERVE src0_sel:WORD_0
    v_mfma_f32_16x16x32_bf16 v[124:127], v[188:191], v[80:83], v[124:127]
    ds_read_b64_tr_b16 v[188:189], v62 offset:20480
    ds_read_b64_tr_b16 v[190:191], v62 offset:20736
    v_exp_f16_sdwa v111, -v111 dst_sel:WORD_0 dst_unused:UNUSED_PRESERVE src0_sel:WORD_0
    v_mfma_f32_16x16x32_bf16 v[112:115], v[192:195], v[72:75], v[112:115]
    v_exp_f16_sdwa v109, -v109 dst_sel:WORD_1 dst_unused:UNUSED_PRESERVE src0_sel:WORD_1
    v_mfma_f32_16x16x32_bf16 v[120:123], v[192:195], v[84:87], v[120:123]
    ds_read_b64_tr_b16 v[192:193], v49 offset:22528
    ds_read_b64_tr_b16 v[194:195], v49 offset:22784
    v_exp_f16_sdwa v110, -v110 dst_sel:WORD_1 dst_unused:UNUSED_PRESERVE src0_sel:WORD_1
    v_lshrrev_b32_sdwa v0, 2, v98 dst_sel:WORD_0 dst_unused:UNUSED_PRESERVE src0_sel:DWORD src1_sel:WORD_0
    v_lshrrev_b32_sdwa v1, 2, v98 dst_sel:WORD_0 dst_unused:UNUSED_PRESERVE src0_sel:DWORD src1_sel:WORD_1
    v_mfma_f32_16x16x32_bf16 v[116:119], v[196:199], v[72:75], v[116:119]
    ds_read_u16 v106, v0 offset:20416
    ds_read_u16 v98, v1 offset:20416
    v_exp_f16_sdwa v111, -v111 dst_sel:WORD_1 dst_unused:UNUSED_PRESERVE src0_sel:WORD_1
    v_mfma_f32_16x16x32_bf16 v[124:127], v[196:199], v[84:87], v[124:127]
    ds_read_b64_tr_b16 v[196:197], v62 offset:22528
    ds_read_b64_tr_b16 v[198:199], v62 offset:22784
    v_pk_fma_f16 v109, v109, s27, s27
    v_pk_fma_f16 v110, v110, s27, s27
    v_mfma_f32_16x16x32_bf16 v[132:135], v[204:207], v[88:91], v[132:135]
    v_pk_fma_f16 v111, v111, s27, s27
    v_rcp_f16_sdwa v109, v109 dst_sel:WORD_0 dst_unused:UNUSED_PRESERVE src0_sel:WORD_0
    v_mfma_f32_16x16x32_bf16 v[140:143], v[204:207], v[92:95], v[140:143]
    ds_read_b128 v[204:207], v50 offset:37888
    s_setprio 0
    v_rcp_f16_sdwa v110, v110 dst_sel:WORD_0 dst_unused:UNUSED_PRESERVE src0_sel:WORD_0
    v_lshrrev_b32_sdwa v0, 2, v99 dst_sel:WORD_0 dst_unused:UNUSED_PRESERVE src0_sel:DWORD src1_sel:WORD_0
    v_lshrrev_b32_sdwa v1, 2, v99 dst_sel:WORD_0 dst_unused:UNUSED_PRESERVE src0_sel:DWORD src1_sel:WORD_1
    v_mfma_f32_16x16x32_bf16 v[144:147], v[208:211], v[88:91], v[144:147]
    ds_read_u16 v107, v0 offset:20416
    ds_read_u16 v99, v1 offset:20416
    v_rcp_f16_sdwa v111, v111 dst_sel:WORD_0 dst_unused:UNUSED_PRESERVE src0_sel:WORD_0
    v_mfma_f32_16x16x32_bf16 v[152:155], v[208:211], v[92:95], v[152:155]
    ds_read_b128 v[208:211], v50 offset:38912
    v_rcp_f16_sdwa v109, v109 dst_sel:WORD_1 dst_unused:UNUSED_PRESERVE src0_sel:WORD_1
    v_mfma_f32_16x16x32_bf16 v[148:151], v[212:215], v[88:91], v[148:151]
    v_rcp_f16_sdwa v110, v110 dst_sel:WORD_1 dst_unused:UNUSED_PRESERVE src0_sel:WORD_1
    v_mfma_f32_16x16x32_bf16 v[156:159], v[212:215], v[92:95], v[156:159]
    ds_read_b128 v[212:215], v50 offset:39936
    v_rcp_f16_sdwa v111, v111 dst_sel:WORD_1 dst_unused:UNUSED_PRESERVE src0_sel:WORD_1
    v_lshrrev_b32_sdwa v0, 2, v100 dst_sel:WORD_0 dst_unused:UNUSED_PRESERVE src0_sel:DWORD src1_sel:WORD_0
    v_lshrrev_b32_sdwa v1, 2, v100 dst_sel:WORD_0 dst_unused:UNUSED_PRESERVE src0_sel:DWORD src1_sel:WORD_1
    v_mfma_f32_16x16x32_bf16 v[160:163], v[216:219], v[88:91], v[160:163]
    ds_read_u16 v108, v0 offset:20416
    ds_read_u16 v100, v1 offset:20416
    v_fma_mix_f32 v224, v109, v101, 0 op_sel_hi:[1,1,0]
    v_mfma_f32_16x16x32_bf16 v[168:171], v[216:219], v[92:95], v[168:171]
    ds_read_b128 v[216:219], v50 offset:40960
    v_fma_mix_f32 v109, v109, v101, 0 op_sel:[1,1,0] op_sel_hi:[1,1,0]
    v_fma_mix_f32 v225, v110, v102, 0 op_sel_hi:[1,1,0]
    v_mfma_f32_16x16x32_bf16 v[164:167], v[220:223], v[88:91], v[164:167]
    v_fma_mix_f32 v110, v110, v102, 0 op_sel:[1,1,0] op_sel_hi:[1,1,0]
    v_fma_mix_f32 v226, v111, v103, 0 op_sel_hi:[1,1,0]
    v_mfma_f32_16x16x32_bf16 v[172:175], v[220:223], v[92:95], v[172:175]
    ds_read_b128 v[220:223], v50 offset:41984
    v_fma_mix_f32 v111, v111, v103, 0 op_sel:[1,1,0] op_sel_hi:[1,1,0]
    v_cvt_pk_bf16_f32 v101, v224, v109
    v_cvt_pk_bf16_f32 v102, v225, v110
    v_cvt_pk_bf16_f32 v103, v226, v111
    s_waitcnt lgkmcnt(2)
    v_lshl_or_b32 v96, v96, 16, v104
    v_lshl_or_b32 v97, v97, 16, v105
    v_lshl_or_b32 v98, v98, 16, v106
    v_lshl_or_b32 v99, v99, 16, v107
    v_lshl_or_b32 v100, v100, 16, v108
    s_waitcnt vmcnt(2) lgkmcnt(0)
    s_barrier
    v_mfma_f32_16x16x32_bf16 v[128:131], v[200:203], v[96:99], v[128:131]
    s_sub_u32 m0, s34, 12288
    s_movk_i32 s79, 12288
    buffer_load_dwordx4 v51, s[44:47], s79 offen offset:0 lds
    s_add_u32 m0, s34, 12096
    s_setprio 0
    buffer_load_dwordx4 v54, s[36:39], 0 offen offset:192 lds
    v_cvt_pk_f16_f32 v88, v112, v113
    v_cvt_pk_f16_f32 v89, v114, v115
    v_cvt_pk_f16_f32 v90, v116, v117
    v_cvt_pk_f16_f32 v91, v118, v119
    v_mfma_f32_16x16x32_bf16 v[136:139], v[200:203], v[100:103], v[136:139]
    ds_read_b128 v[200:203], v50 offset:6144
    v_cvt_pk_f16_f32 v92, v120, v121
    v_cvt_pk_f16_f32 v93, v122, v123
    v_cvt_pk_f16_f32 v94, v124, v125
    v_cvt_pk_f16_f32 v95, v126, v127
    v_mfma_f32_16x16x32_bf16 v[112:115], v[176:179], v[64:67], 0
    s_setprio 1
    v_and_b32 v88, s42, v88
    v_and_b32 v89, s42, v89
    v_and_b32 v90, s42, v90
    v_mfma_f32_16x16x32_bf16 v[120:123], v[176:179], v[76:79], 0
    s_add_u32 m0, s34, 17856
    ds_read_b64_tr_b16 v[176:177], v49 offset:0
    ds_read_b64_tr_b16 v[178:179], v49 offset:256
    buffer_load_dwordx4 v54, s[36:39], 0 offen offset:576 lds
    v_and_b32 v91, s42, v91
    v_and_b32 v92, s42, v92
    v_lshrrev_b32_sdwa v0, 2, v88 dst_sel:WORD_0 dst_unused:UNUSED_PRESERVE src0_sel:DWORD src1_sel:WORD_0
    v_lshrrev_b32_sdwa v1, 2, v88 dst_sel:WORD_0 dst_unused:UNUSED_PRESERVE src0_sel:DWORD src1_sel:WORD_1
    v_mfma_f32_16x16x32_bf16 v[116:119], v[180:183], v[64:67], 0
    ds_read_u16 v104, v0 offset:20416
    ds_read_u16 v88, v1 offset:20416
    buffer_store_dwordx4 v[240:243], v55, s[8:11], s22 offen offset:64 sc0 sc1 nt
    v_pk_fma_f16 v109, v93, v93, s25
    v_pk_fma_f16 v110, v94, v94, s25
    v_mfma_f32_16x16x32_bf16 v[124:127], v[180:183], v[76:79], 0
    ds_read_b64_tr_b16 v[180:181], v62 offset:0
    ds_read_b64_tr_b16 v[182:183], v62 offset:256
    v_pk_fma_f16 v111, v95, v95, s25
    v_pk_mul_f16 v109, v109, v93
    v_mfma_f32_16x16x32_bf16 v[112:115], v[184:187], v[68:71], v[112:115]
    v_pk_mul_f16 v110, v110, v94
    v_pk_mul_f16 v111, v111, v95
    v_mfma_f32_16x16x32_bf16 v[120:123], v[184:187], v[80:83], v[120:123]
    ds_read_b64_tr_b16 v[184:185], v49 offset:2048
    ds_read_b64_tr_b16 v[186:187], v49 offset:2304
    v_exp_f16_sdwa v109, -v109 dst_sel:WORD_0 dst_unused:UNUSED_PRESERVE src0_sel:WORD_0
    v_lshrrev_b32_sdwa v0, 2, v89 dst_sel:WORD_0 dst_unused:UNUSED_PRESERVE src0_sel:DWORD src1_sel:WORD_0
    v_lshrrev_b32_sdwa v1, 2, v89 dst_sel:WORD_0 dst_unused:UNUSED_PRESERVE src0_sel:DWORD src1_sel:WORD_1
    v_mfma_f32_16x16x32_bf16 v[116:119], v[188:191], v[68:71], v[116:119]
    ds_read_u16 v105, v0 offset:20416
    ds_read_u16 v89, v1 offset:20416
    s_setprio 2
    v_exp_f16_sdwa v110, -v110 dst_sel:WORD_0 dst_unused:UNUSED_PRESERVE src0_sel:WORD_0
    v_mfma_f32_16x16x32_bf16 v[124:127], v[188:191], v[80:83], v[124:127]
    ds_read_b64_tr_b16 v[188:189], v62 offset:2048
    ds_read_b64_tr_b16 v[190:191], v62 offset:2304
    v_exp_f16_sdwa v111, -v111 dst_sel:WORD_0 dst_unused:UNUSED_PRESERVE src0_sel:WORD_0
    v_mfma_f32_16x16x32_bf16 v[112:115], v[192:195], v[72:75], v[112:115]
    v_exp_f16_sdwa v109, -v109 dst_sel:WORD_1 dst_unused:UNUSED_PRESERVE src0_sel:WORD_1
    v_mfma_f32_16x16x32_bf16 v[120:123], v[192:195], v[84:87], v[120:123]
    ds_read_b64_tr_b16 v[192:193], v49 offset:4096
    ds_read_b64_tr_b16 v[194:195], v49 offset:4352
    v_exp_f16_sdwa v110, -v110 dst_sel:WORD_1 dst_unused:UNUSED_PRESERVE src0_sel:WORD_1
    v_lshrrev_b32_sdwa v0, 2, v90 dst_sel:WORD_0 dst_unused:UNUSED_PRESERVE src0_sel:DWORD src1_sel:WORD_0
    v_lshrrev_b32_sdwa v1, 2, v90 dst_sel:WORD_0 dst_unused:UNUSED_PRESERVE src0_sel:DWORD src1_sel:WORD_1
    v_mfma_f32_16x16x32_bf16 v[116:119], v[196:199], v[72:75], v[116:119]
    ds_read_u16 v106, v0 offset:20416
    ds_read_u16 v90, v1 offset:20416
    v_exp_f16_sdwa v111, -v111 dst_sel:WORD_1 dst_unused:UNUSED_PRESERVE src0_sel:WORD_1
    v_mfma_f32_16x16x32_bf16 v[124:127], v[196:199], v[84:87], v[124:127]
    ds_read_b64_tr_b16 v[196:197], v62 offset:4096
    ds_read_b64_tr_b16 v[198:199], v62 offset:4352
    v_pk_fma_f16 v109, v109, s27, s27
    v_pk_fma_f16 v110, v110, s27, s27
    v_mfma_f32_16x16x32_bf16 v[132:135], v[204:207], v[96:99], v[132:135]
    v_pk_fma_f16 v111, v111, s27, s27
    v_rcp_f16_sdwa v109, v109 dst_sel:WORD_0 dst_unused:UNUSED_PRESERVE src0_sel:WORD_0
    v_mfma_f32_16x16x32_bf16 v[140:143], v[204:207], v[100:103], v[140:143]
    ds_read_b128 v[204:207], v50 offset:7168
    s_setprio 3
    v_rcp_f16_sdwa v110, v110 dst_sel:WORD_0 dst_unused:UNUSED_PRESERVE src0_sel:WORD_0
    v_lshrrev_b32_sdwa v0, 2, v91 dst_sel:WORD_0 dst_unused:UNUSED_PRESERVE src0_sel:DWORD src1_sel:WORD_0
    v_lshrrev_b32_sdwa v1, 2, v91 dst_sel:WORD_0 dst_unused:UNUSED_PRESERVE src0_sel:DWORD src1_sel:WORD_1
    v_mfma_f32_16x16x32_bf16 v[144:147], v[208:211], v[96:99], v[144:147]
    ds_read_u16 v107, v0 offset:20416
    ds_read_u16 v91, v1 offset:20416
    v_rcp_f16_sdwa v111, v111 dst_sel:WORD_0 dst_unused:UNUSED_PRESERVE src0_sel:WORD_0
    v_mfma_f32_16x16x32_bf16 v[152:155], v[208:211], v[100:103], v[152:155]
    ds_read_b128 v[208:211], v50 offset:8192
    v_rcp_f16_sdwa v109, v109 dst_sel:WORD_1 dst_unused:UNUSED_PRESERVE src0_sel:WORD_1
    v_mfma_f32_16x16x32_bf16 v[148:151], v[212:215], v[96:99], v[148:151]
    v_rcp_f16_sdwa v110, v110 dst_sel:WORD_1 dst_unused:UNUSED_PRESERVE src0_sel:WORD_1
    v_mfma_f32_16x16x32_bf16 v[156:159], v[212:215], v[100:103], v[156:159]
    ds_read_b128 v[212:215], v50 offset:9216
    v_rcp_f16_sdwa v111, v111 dst_sel:WORD_1 dst_unused:UNUSED_PRESERVE src0_sel:WORD_1
    v_lshrrev_b32_sdwa v0, 2, v92 dst_sel:WORD_0 dst_unused:UNUSED_PRESERVE src0_sel:DWORD src1_sel:WORD_0
    v_lshrrev_b32_sdwa v1, 2, v92 dst_sel:WORD_0 dst_unused:UNUSED_PRESERVE src0_sel:DWORD src1_sel:WORD_1
    v_mfma_f32_16x16x32_bf16 v[160:163], v[216:219], v[96:99], v[160:163]
    ds_read_u16 v108, v0 offset:20416
    ds_read_u16 v92, v1 offset:20416
    v_fma_mix_f32 v224, v109, v93, 0 op_sel_hi:[1,1,0]
    v_mfma_f32_16x16x32_bf16 v[168:171], v[216:219], v[100:103], v[168:171]
    ds_read_b128 v[216:219], v50 offset:10240
    v_fma_mix_f32 v109, v109, v93, 0 op_sel:[1,1,0] op_sel_hi:[1,1,0]
    v_fma_mix_f32 v225, v110, v94, 0 op_sel_hi:[1,1,0]
    v_mfma_f32_16x16x32_bf16 v[164:167], v[220:223], v[96:99], v[164:167]
    v_fma_mix_f32 v110, v110, v94, 0 op_sel:[1,1,0] op_sel_hi:[1,1,0]
    v_fma_mix_f32 v226, v111, v95, 0 op_sel_hi:[1,1,0]
    v_mfma_f32_16x16x32_bf16 v[172:175], v[220:223], v[100:103], v[172:175]
    ds_read_b128 v[220:223], v50 offset:11264
    v_fma_mix_f32 v111, v111, v95, 0 op_sel:[1,1,0] op_sel_hi:[1,1,0]
    v_cvt_pk_bf16_f32 v93, v224, v109
    v_cvt_pk_bf16_f32 v94, v225, v110
    v_cvt_pk_bf16_f32 v95, v226, v111
    s_waitcnt lgkmcnt(2)
    v_lshl_or_b32 v88, v88, 16, v104
    v_lshl_or_b32 v89, v89, 16, v105
    v_lshl_or_b32 v90, v90, 16, v106
    v_lshl_or_b32 v91, v91, 16, v107
    v_lshl_or_b32 v92, v92, 16, v108
    s_waitcnt lgkmcnt(0)
    v_mfma_f32_16x16x32_bf16 v[128:131], v[200:203], v[88:91], v[128:131]
    s_setprio 3
    v_cvt_pk_f16_f32 v96, v112, v113
    v_cvt_pk_f16_f32 v97, v114, v115
    v_cvt_pk_f16_f32 v98, v116, v117
    v_cvt_pk_f16_f32 v99, v118, v119
    v_mfma_f32_16x16x32_bf16 v[136:139], v[200:203], v[92:95], v[136:139]
    ds_read_b128 v[200:203], v50 offset:43008
    v_cvt_pk_f16_f32 v100, v120, v121
    v_cvt_pk_f16_f32 v101, v122, v123
    v_cvt_pk_f16_f32 v102, v124, v125
    v_cvt_pk_f16_f32 v103, v126, v127
    v_mfma_f32_16x16x32_bf16 v[112:115], v[176:179], v[64:67], 0
    s_setprio 2
    v_and_b32 v96, s42, v96
    v_and_b32 v97, s42, v97
    v_and_b32 v98, s42, v98
    v_mfma_f32_16x16x32_bf16 v[120:123], v[176:179], v[76:79], 0
    ds_read_b64_tr_b16 v[176:177], v49 offset:6144
    ds_read_b64_tr_b16 v[178:179], v49 offset:6400
    v_and_b32 v99, s42, v99
    v_and_b32 v100, s42, v100
    v_lshrrev_b32_sdwa v0, 2, v96 dst_sel:WORD_0 dst_unused:UNUSED_PRESERVE src0_sel:DWORD src1_sel:WORD_0
    v_lshrrev_b32_sdwa v1, 2, v96 dst_sel:WORD_0 dst_unused:UNUSED_PRESERVE src0_sel:DWORD src1_sel:WORD_1
    v_mfma_f32_16x16x32_bf16 v[116:119], v[180:183], v[64:67], 0
    ds_read_u16 v104, v0 offset:20416
    ds_read_u16 v96, v1 offset:20416
    buffer_store_dwordx4 v[244:247], v55, s[8:11], s22 offen offset:1600 sc0 sc1 nt
    v_pk_fma_f16 v109, v101, v101, s25
    v_pk_fma_f16 v110, v102, v102, s25
    v_mfma_f32_16x16x32_bf16 v[124:127], v[180:183], v[76:79], 0
    ds_read_b64_tr_b16 v[180:181], v62 offset:6144
    ds_read_b64_tr_b16 v[182:183], v62 offset:6400
    v_pk_fma_f16 v111, v103, v103, s25
    v_pk_mul_f16 v109, v109, v101
    v_mfma_f32_16x16x32_bf16 v[112:115], v[184:187], v[68:71], v[112:115]
    v_pk_mul_f16 v110, v110, v102
    v_pk_mul_f16 v111, v111, v103
    v_mfma_f32_16x16x32_bf16 v[120:123], v[184:187], v[80:83], v[120:123]
    ds_read_b64_tr_b16 v[184:185], v49 offset:8192
    ds_read_b64_tr_b16 v[186:187], v49 offset:8448
    v_exp_f16_sdwa v109, -v109 dst_sel:WORD_0 dst_unused:UNUSED_PRESERVE src0_sel:WORD_0
    v_lshrrev_b32_sdwa v0, 2, v97 dst_sel:WORD_0 dst_unused:UNUSED_PRESERVE src0_sel:DWORD src1_sel:WORD_0
    v_lshrrev_b32_sdwa v1, 2, v97 dst_sel:WORD_0 dst_unused:UNUSED_PRESERVE src0_sel:DWORD src1_sel:WORD_1
    v_mfma_f32_16x16x32_bf16 v[116:119], v[188:191], v[68:71], v[116:119]
    ds_read_u16 v105, v0 offset:20416
    ds_read_u16 v97, v1 offset:20416
    s_setprio 1
    v_exp_f16_sdwa v110, -v110 dst_sel:WORD_0 dst_unused:UNUSED_PRESERVE src0_sel:WORD_0
    v_mfma_f32_16x16x32_bf16 v[124:127], v[188:191], v[80:83], v[124:127]
    ds_read_b64_tr_b16 v[188:189], v62 offset:8192
    ds_read_b64_tr_b16 v[190:191], v62 offset:8448
    v_exp_f16_sdwa v111, -v111 dst_sel:WORD_0 dst_unused:UNUSED_PRESERVE src0_sel:WORD_0
    v_mfma_f32_16x16x32_bf16 v[112:115], v[192:195], v[72:75], v[112:115]
    v_exp_f16_sdwa v109, -v109 dst_sel:WORD_1 dst_unused:UNUSED_PRESERVE src0_sel:WORD_1
    v_mfma_f32_16x16x32_bf16 v[120:123], v[192:195], v[84:87], v[120:123]
    ds_read_b64_tr_b16 v[192:193], v49 offset:10240
    ds_read_b64_tr_b16 v[194:195], v49 offset:10496
    v_exp_f16_sdwa v110, -v110 dst_sel:WORD_1 dst_unused:UNUSED_PRESERVE src0_sel:WORD_1
    v_lshrrev_b32_sdwa v0, 2, v98 dst_sel:WORD_0 dst_unused:UNUSED_PRESERVE src0_sel:DWORD src1_sel:WORD_0
    v_lshrrev_b32_sdwa v1, 2, v98 dst_sel:WORD_0 dst_unused:UNUSED_PRESERVE src0_sel:DWORD src1_sel:WORD_1
    v_mfma_f32_16x16x32_bf16 v[116:119], v[196:199], v[72:75], v[116:119]
    ds_read_u16 v106, v0 offset:20416
    ds_read_u16 v98, v1 offset:20416
    v_exp_f16_sdwa v111, -v111 dst_sel:WORD_1 dst_unused:UNUSED_PRESERVE src0_sel:WORD_1
    v_mfma_f32_16x16x32_bf16 v[124:127], v[196:199], v[84:87], v[124:127]
    ds_read_b64_tr_b16 v[196:197], v62 offset:10240
    ds_read_b64_tr_b16 v[198:199], v62 offset:10496
    v_pk_fma_f16 v109, v109, s27, s27
    v_pk_fma_f16 v110, v110, s27, s27
    v_mfma_f32_16x16x32_bf16 v[132:135], v[204:207], v[88:91], v[132:135]
    v_pk_fma_f16 v111, v111, s27, s27
    v_rcp_f16_sdwa v109, v109 dst_sel:WORD_0 dst_unused:UNUSED_PRESERVE src0_sel:WORD_0
    v_mfma_f32_16x16x32_bf16 v[140:143], v[204:207], v[92:95], v[140:143]
    ds_read_b128 v[204:207], v50 offset:44032
    s_setprio 0
    v_rcp_f16_sdwa v110, v110 dst_sel:WORD_0 dst_unused:UNUSED_PRESERVE src0_sel:WORD_0
    v_lshrrev_b32_sdwa v0, 2, v99 dst_sel:WORD_0 dst_unused:UNUSED_PRESERVE src0_sel:DWORD src1_sel:WORD_0
    v_lshrrev_b32_sdwa v1, 2, v99 dst_sel:WORD_0 dst_unused:UNUSED_PRESERVE src0_sel:DWORD src1_sel:WORD_1
    v_mfma_f32_16x16x32_bf16 v[144:147], v[208:211], v[88:91], v[144:147]
    ds_read_u16 v107, v0 offset:20416
    ds_read_u16 v99, v1 offset:20416
    v_rcp_f16_sdwa v111, v111 dst_sel:WORD_0 dst_unused:UNUSED_PRESERVE src0_sel:WORD_0
    v_mfma_f32_16x16x32_bf16 v[152:155], v[208:211], v[92:95], v[152:155]
    ds_read_b128 v[208:211], v50 offset:45056
    v_rcp_f16_sdwa v109, v109 dst_sel:WORD_1 dst_unused:UNUSED_PRESERVE src0_sel:WORD_1
    v_mfma_f32_16x16x32_bf16 v[148:151], v[212:215], v[88:91], v[148:151]
    v_rcp_f16_sdwa v110, v110 dst_sel:WORD_1 dst_unused:UNUSED_PRESERVE src0_sel:WORD_1
    v_mfma_f32_16x16x32_bf16 v[156:159], v[212:215], v[92:95], v[156:159]
    ds_read_b128 v[212:215], v50 offset:46080
    v_rcp_f16_sdwa v111, v111 dst_sel:WORD_1 dst_unused:UNUSED_PRESERVE src0_sel:WORD_1
    v_lshrrev_b32_sdwa v0, 2, v100 dst_sel:WORD_0 dst_unused:UNUSED_PRESERVE src0_sel:DWORD src1_sel:WORD_0
    v_lshrrev_b32_sdwa v1, 2, v100 dst_sel:WORD_0 dst_unused:UNUSED_PRESERVE src0_sel:DWORD src1_sel:WORD_1
    v_mfma_f32_16x16x32_bf16 v[160:163], v[216:219], v[88:91], v[160:163]
    ds_read_u16 v108, v0 offset:20416
    ds_read_u16 v100, v1 offset:20416
    v_fma_mix_f32 v224, v109, v101, 0 op_sel_hi:[1,1,0]
    v_mfma_f32_16x16x32_bf16 v[168:171], v[216:219], v[92:95], v[168:171]
    ds_read_b128 v[216:219], v50 offset:47104
    v_fma_mix_f32 v109, v109, v101, 0 op_sel:[1,1,0] op_sel_hi:[1,1,0]
    v_fma_mix_f32 v225, v110, v102, 0 op_sel_hi:[1,1,0]
    v_mfma_f32_16x16x32_bf16 v[164:167], v[220:223], v[88:91], v[164:167]
    v_fma_mix_f32 v110, v110, v102, 0 op_sel:[1,1,0] op_sel_hi:[1,1,0]
    v_fma_mix_f32 v226, v111, v103, 0 op_sel_hi:[1,1,0]
    v_mfma_f32_16x16x32_bf16 v[172:175], v[220:223], v[92:95], v[172:175]
    ds_read_b128 v[220:223], v50 offset:48128
    v_fma_mix_f32 v111, v111, v103, 0 op_sel:[1,1,0] op_sel_hi:[1,1,0]
    v_cvt_pk_bf16_f32 v101, v224, v109
    v_cvt_pk_bf16_f32 v102, v225, v110
    v_cvt_pk_bf16_f32 v103, v226, v111
    s_waitcnt lgkmcnt(2)
    v_lshl_or_b32 v96, v96, 16, v104
    v_lshl_or_b32 v97, v97, 16, v105
    v_lshl_or_b32 v98, v98, 16, v106
    v_lshl_or_b32 v99, v99, 16, v107
    v_lshl_or_b32 v100, v100, 16, v108
    s_waitcnt vmcnt(2) lgkmcnt(0)
    s_barrier
    v_mfma_f32_16x16x32_bf16 v[128:131], v[200:203], v[96:99], v[128:131]
    s_sub_u32 m0, s34, 6144
    s_movk_i32 s79, 18432
    buffer_load_dwordx4 v51, s[44:47], s79 offen offset:0 lds
    s_add_u32 m0, s34, -256
    s_setprio 0
    buffer_load_dwordx4 v54, s[36:39], 0 offen offset:256 lds
    v_cvt_pk_f16_f32 v88, v112, v113
    v_cvt_pk_f16_f32 v89, v114, v115
    v_cvt_pk_f16_f32 v90, v116, v117
    v_cvt_pk_f16_f32 v91, v118, v119
    v_mfma_f32_16x16x32_bf16 v[136:139], v[200:203], v[100:103], v[136:139]
    ds_read_b128 v[200:203], v50 offset:12288
    v_cvt_pk_f16_f32 v92, v120, v121
    v_cvt_pk_f16_f32 v93, v122, v123
    v_cvt_pk_f16_f32 v94, v124, v125
    v_cvt_pk_f16_f32 v95, v126, v127
    v_mfma_f32_16x16x32_bf16 v[112:115], v[176:179], v[64:67], 0
    s_setprio 1
    v_and_b32 v88, s42, v88
    v_and_b32 v89, s42, v89
    v_and_b32 v90, s42, v90
    v_mfma_f32_16x16x32_bf16 v[120:123], v[176:179], v[76:79], 0
    s_add_u32 m0, s34, 5504
    ds_read_b64_tr_b16 v[176:177], v49 offset:12288
    ds_read_b64_tr_b16 v[178:179], v49 offset:12544
    buffer_load_dwordx4 v54, s[36:39], 0 offen offset:640 lds
    v_and_b32 v91, s42, v91
    v_and_b32 v92, s42, v92
    v_lshrrev_b32_sdwa v0, 2, v88 dst_sel:WORD_0 dst_unused:UNUSED_PRESERVE src0_sel:DWORD src1_sel:WORD_0
    v_lshrrev_b32_sdwa v1, 2, v88 dst_sel:WORD_0 dst_unused:UNUSED_PRESERVE src0_sel:DWORD src1_sel:WORD_1
    v_mfma_f32_16x16x32_bf16 v[116:119], v[180:183], v[64:67], 0
    ds_read_u16 v104, v0 offset:20416
    ds_read_u16 v88, v1 offset:20416
    buffer_store_dwordx4 v[248:251], v55, s[8:11], s22 offen offset:128 sc0 sc1 nt
    v_pk_fma_f16 v109, v93, v93, s25
    v_pk_fma_f16 v110, v94, v94, s25
    v_mfma_f32_16x16x32_bf16 v[124:127], v[180:183], v[76:79], 0
    ds_read_b64_tr_b16 v[180:181], v62 offset:12288
    ds_read_b64_tr_b16 v[182:183], v62 offset:12544
    v_pk_fma_f16 v111, v95, v95, s25
    v_pk_mul_f16 v109, v109, v93
    v_mfma_f32_16x16x32_bf16 v[112:115], v[184:187], v[68:71], v[112:115]
    v_pk_mul_f16 v110, v110, v94
    v_pk_mul_f16 v111, v111, v95
    v_mfma_f32_16x16x32_bf16 v[120:123], v[184:187], v[80:83], v[120:123]
    ds_read_b64_tr_b16 v[184:185], v49 offset:14336
    ds_read_b64_tr_b16 v[186:187], v49 offset:14592
    v_exp_f16_sdwa v109, -v109 dst_sel:WORD_0 dst_unused:UNUSED_PRESERVE src0_sel:WORD_0
    v_lshrrev_b32_sdwa v0, 2, v89 dst_sel:WORD_0 dst_unused:UNUSED_PRESERVE src0_sel:DWORD src1_sel:WORD_0
    v_lshrrev_b32_sdwa v1, 2, v89 dst_sel:WORD_0 dst_unused:UNUSED_PRESERVE src0_sel:DWORD src1_sel:WORD_1
    v_mfma_f32_16x16x32_bf16 v[116:119], v[188:191], v[68:71], v[116:119]
    ds_read_u16 v105, v0 offset:20416
    ds_read_u16 v89, v1 offset:20416
    s_setprio 2
    v_exp_f16_sdwa v110, -v110 dst_sel:WORD_0 dst_unused:UNUSED_PRESERVE src0_sel:WORD_0
    v_mfma_f32_16x16x32_bf16 v[124:127], v[188:191], v[80:83], v[124:127]
    ds_read_b64_tr_b16 v[188:189], v62 offset:14336
    ds_read_b64_tr_b16 v[190:191], v62 offset:14592
    v_exp_f16_sdwa v111, -v111 dst_sel:WORD_0 dst_unused:UNUSED_PRESERVE src0_sel:WORD_0
    v_mfma_f32_16x16x32_bf16 v[112:115], v[192:195], v[72:75], v[112:115]
    v_exp_f16_sdwa v109, -v109 dst_sel:WORD_1 dst_unused:UNUSED_PRESERVE src0_sel:WORD_1
    v_mfma_f32_16x16x32_bf16 v[120:123], v[192:195], v[84:87], v[120:123]
    ds_read_b64_tr_b16 v[192:193], v49 offset:16384
    ds_read_b64_tr_b16 v[194:195], v49 offset:16640
    v_exp_f16_sdwa v110, -v110 dst_sel:WORD_1 dst_unused:UNUSED_PRESERVE src0_sel:WORD_1
    v_lshrrev_b32_sdwa v0, 2, v90 dst_sel:WORD_0 dst_unused:UNUSED_PRESERVE src0_sel:DWORD src1_sel:WORD_0
    v_lshrrev_b32_sdwa v1, 2, v90 dst_sel:WORD_0 dst_unused:UNUSED_PRESERVE src0_sel:DWORD src1_sel:WORD_1
    v_mfma_f32_16x16x32_bf16 v[116:119], v[196:199], v[72:75], v[116:119]
    ds_read_u16 v106, v0 offset:20416
    ds_read_u16 v90, v1 offset:20416
    v_exp_f16_sdwa v111, -v111 dst_sel:WORD_1 dst_unused:UNUSED_PRESERVE src0_sel:WORD_1
    v_mfma_f32_16x16x32_bf16 v[124:127], v[196:199], v[84:87], v[124:127]
    ds_read_b64_tr_b16 v[196:197], v62 offset:16384
    ds_read_b64_tr_b16 v[198:199], v62 offset:16640
    v_pk_fma_f16 v109, v109, s27, s27
    v_pk_fma_f16 v110, v110, s27, s27
    v_mfma_f32_16x16x32_bf16 v[132:135], v[204:207], v[96:99], v[132:135]
    v_pk_fma_f16 v111, v111, s27, s27
    v_rcp_f16_sdwa v109, v109 dst_sel:WORD_0 dst_unused:UNUSED_PRESERVE src0_sel:WORD_0
    v_mfma_f32_16x16x32_bf16 v[140:143], v[204:207], v[100:103], v[140:143]
    ds_read_b128 v[204:207], v50 offset:13312
    s_setprio 3
    v_rcp_f16_sdwa v110, v110 dst_sel:WORD_0 dst_unused:UNUSED_PRESERVE src0_sel:WORD_0
    v_lshrrev_b32_sdwa v0, 2, v91 dst_sel:WORD_0 dst_unused:UNUSED_PRESERVE src0_sel:DWORD src1_sel:WORD_0
    v_lshrrev_b32_sdwa v1, 2, v91 dst_sel:WORD_0 dst_unused:UNUSED_PRESERVE src0_sel:DWORD src1_sel:WORD_1
    v_mfma_f32_16x16x32_bf16 v[144:147], v[208:211], v[96:99], v[144:147]
    ds_read_u16 v107, v0 offset:20416
    ds_read_u16 v91, v1 offset:20416
    v_rcp_f16_sdwa v111, v111 dst_sel:WORD_0 dst_unused:UNUSED_PRESERVE src0_sel:WORD_0
    v_mfma_f32_16x16x32_bf16 v[152:155], v[208:211], v[100:103], v[152:155]
    ds_read_b128 v[208:211], v50 offset:14336
    v_rcp_f16_sdwa v109, v109 dst_sel:WORD_1 dst_unused:UNUSED_PRESERVE src0_sel:WORD_1
    v_mfma_f32_16x16x32_bf16 v[148:151], v[212:215], v[96:99], v[148:151]
    v_rcp_f16_sdwa v110, v110 dst_sel:WORD_1 dst_unused:UNUSED_PRESERVE src0_sel:WORD_1
    v_mfma_f32_16x16x32_bf16 v[156:159], v[212:215], v[100:103], v[156:159]
    ds_read_b128 v[212:215], v50 offset:15360
    v_rcp_f16_sdwa v111, v111 dst_sel:WORD_1 dst_unused:UNUSED_PRESERVE src0_sel:WORD_1
    v_lshrrev_b32_sdwa v0, 2, v92 dst_sel:WORD_0 dst_unused:UNUSED_PRESERVE src0_sel:DWORD src1_sel:WORD_0
    v_lshrrev_b32_sdwa v1, 2, v92 dst_sel:WORD_0 dst_unused:UNUSED_PRESERVE src0_sel:DWORD src1_sel:WORD_1
    v_mfma_f32_16x16x32_bf16 v[160:163], v[216:219], v[96:99], v[160:163]
    ds_read_u16 v108, v0 offset:20416
    ds_read_u16 v92, v1 offset:20416
    v_fma_mix_f32 v224, v109, v93, 0 op_sel_hi:[1,1,0]
    v_mfma_f32_16x16x32_bf16 v[168:171], v[216:219], v[100:103], v[168:171]
    ds_read_b128 v[216:219], v50 offset:16384
    v_fma_mix_f32 v109, v109, v93, 0 op_sel:[1,1,0] op_sel_hi:[1,1,0]
    v_fma_mix_f32 v225, v110, v94, 0 op_sel_hi:[1,1,0]
    v_mfma_f32_16x16x32_bf16 v[164:167], v[220:223], v[96:99], v[164:167]
    v_fma_mix_f32 v110, v110, v94, 0 op_sel:[1,1,0] op_sel_hi:[1,1,0]
    v_fma_mix_f32 v226, v111, v95, 0 op_sel_hi:[1,1,0]
    v_mfma_f32_16x16x32_bf16 v[172:175], v[220:223], v[100:103], v[172:175]
    ds_read_b128 v[220:223], v50 offset:17408
    v_fma_mix_f32 v111, v111, v95, 0 op_sel:[1,1,0] op_sel_hi:[1,1,0]
    v_cvt_pk_bf16_f32 v93, v224, v109
    v_cvt_pk_bf16_f32 v94, v225, v110
    v_cvt_pk_bf16_f32 v95, v226, v111
    s_waitcnt lgkmcnt(2)
    v_lshl_or_b32 v88, v88, 16, v104
    v_lshl_or_b32 v89, v89, 16, v105
    v_lshl_or_b32 v90, v90, 16, v106
    v_lshl_or_b32 v91, v91, 16, v107
    v_lshl_or_b32 v92, v92, 16, v108
    s_waitcnt lgkmcnt(0)
    v_mfma_f32_16x16x32_bf16 v[128:131], v[200:203], v[88:91], v[128:131]
    s_setprio 3
    v_cvt_pk_f16_f32 v96, v112, v113
    v_cvt_pk_f16_f32 v97, v114, v115
    v_cvt_pk_f16_f32 v98, v116, v117
    v_cvt_pk_f16_f32 v99, v118, v119
    v_mfma_f32_16x16x32_bf16 v[136:139], v[200:203], v[92:95], v[136:139]
    ds_read_b128 v[200:203], v50 offset:36864
    v_cvt_pk_f16_f32 v100, v120, v121
    v_cvt_pk_f16_f32 v101, v122, v123
    v_cvt_pk_f16_f32 v102, v124, v125
    v_cvt_pk_f16_f32 v103, v126, v127
    v_mfma_f32_16x16x32_bf16 v[112:115], v[176:179], v[64:67], 0
    s_setprio 2
    v_and_b32 v96, s42, v96
    v_and_b32 v97, s42, v97
    v_and_b32 v98, s42, v98
    v_mfma_f32_16x16x32_bf16 v[120:123], v[176:179], v[76:79], 0
    ds_read_b64_tr_b16 v[176:177], v49 offset:18432
    ds_read_b64_tr_b16 v[178:179], v49 offset:18688
    v_and_b32 v99, s42, v99
    v_and_b32 v100, s42, v100
    v_lshrrev_b32_sdwa v0, 2, v96 dst_sel:WORD_0 dst_unused:UNUSED_PRESERVE src0_sel:DWORD src1_sel:WORD_0
    v_lshrrev_b32_sdwa v1, 2, v96 dst_sel:WORD_0 dst_unused:UNUSED_PRESERVE src0_sel:DWORD src1_sel:WORD_1
    v_mfma_f32_16x16x32_bf16 v[116:119], v[180:183], v[64:67], 0
    ds_read_u16 v104, v0 offset:20416
    ds_read_u16 v96, v1 offset:20416
    buffer_store_dwordx4 v[252:255], v55, s[8:11], s22 offen offset:1664 sc0 sc1 nt
    v_pk_fma_f16 v109, v101, v101, s25
    v_pk_fma_f16 v110, v102, v102, s25
    v_mfma_f32_16x16x32_bf16 v[124:127], v[180:183], v[76:79], 0
    ds_read_b64_tr_b16 v[180:181], v62 offset:18432
    ds_read_b64_tr_b16 v[182:183], v62 offset:18688
    v_pk_fma_f16 v111, v103, v103, s25
    v_pk_mul_f16 v109, v109, v101
    v_mfma_f32_16x16x32_bf16 v[112:115], v[184:187], v[68:71], v[112:115]
    v_pk_mul_f16 v110, v110, v102
    v_pk_mul_f16 v111, v111, v103
    v_mfma_f32_16x16x32_bf16 v[120:123], v[184:187], v[80:83], v[120:123]
    ds_read_b64_tr_b16 v[184:185], v49 offset:20480
    ds_read_b64_tr_b16 v[186:187], v49 offset:20736
    v_exp_f16_sdwa v109, -v109 dst_sel:WORD_0 dst_unused:UNUSED_PRESERVE src0_sel:WORD_0
    v_lshrrev_b32_sdwa v0, 2, v97 dst_sel:WORD_0 dst_unused:UNUSED_PRESERVE src0_sel:DWORD src1_sel:WORD_0
    v_lshrrev_b32_sdwa v1, 2, v97 dst_sel:WORD_0 dst_unused:UNUSED_PRESERVE src0_sel:DWORD src1_sel:WORD_1
    v_mfma_f32_16x16x32_bf16 v[116:119], v[188:191], v[68:71], v[116:119]
    ds_read_u16 v105, v0 offset:20416
    ds_read_u16 v97, v1 offset:20416
    s_setprio 1
    v_exp_f16_sdwa v110, -v110 dst_sel:WORD_0 dst_unused:UNUSED_PRESERVE src0_sel:WORD_0
    v_mfma_f32_16x16x32_bf16 v[124:127], v[188:191], v[80:83], v[124:127]
    ds_read_b64_tr_b16 v[188:189], v62 offset:20480
    ds_read_b64_tr_b16 v[190:191], v62 offset:20736
    v_exp_f16_sdwa v111, -v111 dst_sel:WORD_0 dst_unused:UNUSED_PRESERVE src0_sel:WORD_0
    v_mfma_f32_16x16x32_bf16 v[112:115], v[192:195], v[72:75], v[112:115]
    v_exp_f16_sdwa v109, -v109 dst_sel:WORD_1 dst_unused:UNUSED_PRESERVE src0_sel:WORD_1
    v_mfma_f32_16x16x32_bf16 v[120:123], v[192:195], v[84:87], v[120:123]
    ds_read_b64_tr_b16 v[192:193], v49 offset:22528
    ds_read_b64_tr_b16 v[194:195], v49 offset:22784
    v_exp_f16_sdwa v110, -v110 dst_sel:WORD_1 dst_unused:UNUSED_PRESERVE src0_sel:WORD_1
    v_lshrrev_b32_sdwa v0, 2, v98 dst_sel:WORD_0 dst_unused:UNUSED_PRESERVE src0_sel:DWORD src1_sel:WORD_0
    v_lshrrev_b32_sdwa v1, 2, v98 dst_sel:WORD_0 dst_unused:UNUSED_PRESERVE src0_sel:DWORD src1_sel:WORD_1
    v_mfma_f32_16x16x32_bf16 v[116:119], v[196:199], v[72:75], v[116:119]
    ds_read_u16 v106, v0 offset:20416
    ds_read_u16 v98, v1 offset:20416
    v_exp_f16_sdwa v111, -v111 dst_sel:WORD_1 dst_unused:UNUSED_PRESERVE src0_sel:WORD_1
    v_mfma_f32_16x16x32_bf16 v[124:127], v[196:199], v[84:87], v[124:127]
    ds_read_b64_tr_b16 v[196:197], v62 offset:22528
    ds_read_b64_tr_b16 v[198:199], v62 offset:22784
    v_pk_fma_f16 v109, v109, s27, s27
    v_pk_fma_f16 v110, v110, s27, s27
    v_mfma_f32_16x16x32_bf16 v[132:135], v[204:207], v[88:91], v[132:135]
    v_pk_fma_f16 v111, v111, s27, s27
    v_rcp_f16_sdwa v109, v109 dst_sel:WORD_0 dst_unused:UNUSED_PRESERVE src0_sel:WORD_0
    v_mfma_f32_16x16x32_bf16 v[140:143], v[204:207], v[92:95], v[140:143]
    ds_read_b128 v[204:207], v50 offset:37888
    s_setprio 0
    v_rcp_f16_sdwa v110, v110 dst_sel:WORD_0 dst_unused:UNUSED_PRESERVE src0_sel:WORD_0
    v_lshrrev_b32_sdwa v0, 2, v99 dst_sel:WORD_0 dst_unused:UNUSED_PRESERVE src0_sel:DWORD src1_sel:WORD_0
    v_lshrrev_b32_sdwa v1, 2, v99 dst_sel:WORD_0 dst_unused:UNUSED_PRESERVE src0_sel:DWORD src1_sel:WORD_1
    v_mfma_f32_16x16x32_bf16 v[144:147], v[208:211], v[88:91], v[144:147]
    ds_read_u16 v107, v0 offset:20416
    ds_read_u16 v99, v1 offset:20416
    v_rcp_f16_sdwa v111, v111 dst_sel:WORD_0 dst_unused:UNUSED_PRESERVE src0_sel:WORD_0
    v_mfma_f32_16x16x32_bf16 v[152:155], v[208:211], v[92:95], v[152:155]
    ds_read_b128 v[208:211], v50 offset:38912
    v_rcp_f16_sdwa v109, v109 dst_sel:WORD_1 dst_unused:UNUSED_PRESERVE src0_sel:WORD_1
    v_mfma_f32_16x16x32_bf16 v[148:151], v[212:215], v[88:91], v[148:151]
    v_rcp_f16_sdwa v110, v110 dst_sel:WORD_1 dst_unused:UNUSED_PRESERVE src0_sel:WORD_1
    v_mfma_f32_16x16x32_bf16 v[156:159], v[212:215], v[92:95], v[156:159]
    ds_read_b128 v[212:215], v50 offset:39936
    v_rcp_f16_sdwa v111, v111 dst_sel:WORD_1 dst_unused:UNUSED_PRESERVE src0_sel:WORD_1
    v_lshrrev_b32_sdwa v0, 2, v100 dst_sel:WORD_0 dst_unused:UNUSED_PRESERVE src0_sel:DWORD src1_sel:WORD_0
    v_lshrrev_b32_sdwa v1, 2, v100 dst_sel:WORD_0 dst_unused:UNUSED_PRESERVE src0_sel:DWORD src1_sel:WORD_1
    v_mfma_f32_16x16x32_bf16 v[160:163], v[216:219], v[88:91], v[160:163]
    ds_read_u16 v108, v0 offset:20416
    ds_read_u16 v100, v1 offset:20416
    v_fma_mix_f32 v224, v109, v101, 0 op_sel_hi:[1,1,0]
    v_mfma_f32_16x16x32_bf16 v[168:171], v[216:219], v[92:95], v[168:171]
    ds_read_b128 v[216:219], v50 offset:40960
    v_fma_mix_f32 v109, v109, v101, 0 op_sel:[1,1,0] op_sel_hi:[1,1,0]
    v_fma_mix_f32 v225, v110, v102, 0 op_sel_hi:[1,1,0]
    v_mfma_f32_16x16x32_bf16 v[164:167], v[220:223], v[88:91], v[164:167]
    v_fma_mix_f32 v110, v110, v102, 0 op_sel:[1,1,0] op_sel_hi:[1,1,0]
    v_fma_mix_f32 v226, v111, v103, 0 op_sel_hi:[1,1,0]
    v_mfma_f32_16x16x32_bf16 v[172:175], v[220:223], v[92:95], v[172:175]
    ds_read_b128 v[220:223], v50 offset:41984
    v_fma_mix_f32 v111, v111, v103, 0 op_sel:[1,1,0] op_sel_hi:[1,1,0]
    v_cvt_pk_bf16_f32 v101, v224, v109
    v_cvt_pk_bf16_f32 v102, v225, v110
    v_cvt_pk_bf16_f32 v103, v226, v111
    s_waitcnt lgkmcnt(2)
    v_lshl_or_b32 v96, v96, 16, v104
    v_lshl_or_b32 v97, v97, 16, v105
    v_lshl_or_b32 v98, v98, 16, v106
    v_lshl_or_b32 v99, v99, 16, v107
    v_lshl_or_b32 v100, v100, 16, v108
    s_waitcnt vmcnt(2) lgkmcnt(0)
    s_barrier
    v_mfma_f32_16x16x32_bf16 v[128:131], v[200:203], v[96:99], v[128:131]
    s_sub_u32 m0, s34, 12288
    s_movk_i32 s79, 24576
    buffer_load_dwordx4 v51, s[44:47], s79 offen offset:0 lds
    s_add_u32 m0, s34, 11968
    s_setprio 0
    buffer_load_dwordx4 v54, s[36:39], 0 offen offset:320 lds
    v_cvt_pk_f16_f32 v88, v112, v113
    v_cvt_pk_f16_f32 v89, v114, v115
    v_cvt_pk_f16_f32 v90, v116, v117
    v_cvt_pk_f16_f32 v91, v118, v119
    v_mfma_f32_16x16x32_bf16 v[136:139], v[200:203], v[100:103], v[136:139]
    ds_read_b128 v[200:203], v50 offset:18432
    v_cvt_pk_f16_f32 v92, v120, v121
    v_cvt_pk_f16_f32 v93, v122, v123
    v_cvt_pk_f16_f32 v94, v124, v125
    v_cvt_pk_f16_f32 v95, v126, v127
    v_mfma_f32_16x16x32_bf16 v[112:115], v[176:179], v[64:67], 0
    s_setprio 1
    v_and_b32 v88, s42, v88
    v_and_b32 v89, s42, v89
    v_and_b32 v90, s42, v90
    v_mfma_f32_16x16x32_bf16 v[120:123], v[176:179], v[76:79], 0
    s_add_u32 m0, s34, 17728
    ds_read_b64_tr_b16 v[176:177], v49 offset:0
    ds_read_b64_tr_b16 v[178:179], v49 offset:256
    buffer_load_dwordx4 v54, s[36:39], 0 offen offset:704 lds
    v_and_b32 v91, s42, v91
    v_and_b32 v92, s42, v92
    v_lshrrev_b32_sdwa v0, 2, v88 dst_sel:WORD_0 dst_unused:UNUSED_PRESERVE src0_sel:DWORD src1_sel:WORD_0
    v_lshrrev_b32_sdwa v1, 2, v88 dst_sel:WORD_0 dst_unused:UNUSED_PRESERVE src0_sel:DWORD src1_sel:WORD_1
    v_mfma_f32_16x16x32_bf16 v[116:119], v[180:183], v[64:67], 0
    ds_read_u16 v104, v0 offset:20416
    ds_read_u16 v88, v1 offset:20416
    v_pk_fma_f16 v109, v93, v93, s25
    v_pk_fma_f16 v110, v94, v94, s25
    v_mfma_f32_16x16x32_bf16 v[124:127], v[180:183], v[76:79], 0
    ds_read_b64_tr_b16 v[180:181], v62 offset:0
    ds_read_b64_tr_b16 v[182:183], v62 offset:256
    v_pk_fma_f16 v111, v95, v95, s25
    v_pk_mul_f16 v109, v109, v93
    v_mfma_f32_16x16x32_bf16 v[112:115], v[184:187], v[68:71], v[112:115]
    v_pk_mul_f16 v110, v110, v94
    v_pk_mul_f16 v111, v111, v95
    v_mfma_f32_16x16x32_bf16 v[120:123], v[184:187], v[80:83], v[120:123]
    ds_read_b64_tr_b16 v[184:185], v49 offset:2048
    ds_read_b64_tr_b16 v[186:187], v49 offset:2304
    v_exp_f16_sdwa v109, -v109 dst_sel:WORD_0 dst_unused:UNUSED_PRESERVE src0_sel:WORD_0
    v_lshrrev_b32_sdwa v0, 2, v89 dst_sel:WORD_0 dst_unused:UNUSED_PRESERVE src0_sel:DWORD src1_sel:WORD_0
    v_lshrrev_b32_sdwa v1, 2, v89 dst_sel:WORD_0 dst_unused:UNUSED_PRESERVE src0_sel:DWORD src1_sel:WORD_1
    v_mfma_f32_16x16x32_bf16 v[116:119], v[188:191], v[68:71], v[116:119]
    ds_read_u16 v105, v0 offset:20416
    ds_read_u16 v89, v1 offset:20416
    s_setprio 2
    v_exp_f16_sdwa v110, -v110 dst_sel:WORD_0 dst_unused:UNUSED_PRESERVE src0_sel:WORD_0
    v_mfma_f32_16x16x32_bf16 v[124:127], v[188:191], v[80:83], v[124:127]
    ds_read_b64_tr_b16 v[188:189], v62 offset:2048
    ds_read_b64_tr_b16 v[190:191], v62 offset:2304
    v_exp_f16_sdwa v111, -v111 dst_sel:WORD_0 dst_unused:UNUSED_PRESERVE src0_sel:WORD_0
    v_mfma_f32_16x16x32_bf16 v[112:115], v[192:195], v[72:75], v[112:115]
    v_exp_f16_sdwa v109, -v109 dst_sel:WORD_1 dst_unused:UNUSED_PRESERVE src0_sel:WORD_1
    v_mfma_f32_16x16x32_bf16 v[120:123], v[192:195], v[84:87], v[120:123]
    ds_read_b64_tr_b16 v[192:193], v49 offset:4096
    ds_read_b64_tr_b16 v[194:195], v49 offset:4352
    v_exp_f16_sdwa v110, -v110 dst_sel:WORD_1 dst_unused:UNUSED_PRESERVE src0_sel:WORD_1
    v_lshrrev_b32_sdwa v0, 2, v90 dst_sel:WORD_0 dst_unused:UNUSED_PRESERVE src0_sel:DWORD src1_sel:WORD_0
    v_lshrrev_b32_sdwa v1, 2, v90 dst_sel:WORD_0 dst_unused:UNUSED_PRESERVE src0_sel:DWORD src1_sel:WORD_1
    v_mfma_f32_16x16x32_bf16 v[116:119], v[196:199], v[72:75], v[116:119]
    ds_read_u16 v106, v0 offset:20416
    ds_read_u16 v90, v1 offset:20416
    v_exp_f16_sdwa v111, -v111 dst_sel:WORD_1 dst_unused:UNUSED_PRESERVE src0_sel:WORD_1
    v_mfma_f32_16x16x32_bf16 v[124:127], v[196:199], v[84:87], v[124:127]
    ds_read_b64_tr_b16 v[196:197], v62 offset:4096
    ds_read_b64_tr_b16 v[198:199], v62 offset:4352
    v_pk_fma_f16 v109, v109, s27, s27
    v_pk_fma_f16 v110, v110, s27, s27
    v_mfma_f32_16x16x32_bf16 v[132:135], v[204:207], v[96:99], v[132:135]
    v_pk_fma_f16 v111, v111, s27, s27
    v_rcp_f16_sdwa v109, v109 dst_sel:WORD_0 dst_unused:UNUSED_PRESERVE src0_sel:WORD_0
    v_mfma_f32_16x16x32_bf16 v[140:143], v[204:207], v[100:103], v[140:143]
    ds_read_b128 v[204:207], v50 offset:19456
    s_setprio 3
    v_rcp_f16_sdwa v110, v110 dst_sel:WORD_0 dst_unused:UNUSED_PRESERVE src0_sel:WORD_0
    v_lshrrev_b32_sdwa v0, 2, v91 dst_sel:WORD_0 dst_unused:UNUSED_PRESERVE src0_sel:DWORD src1_sel:WORD_0
    v_lshrrev_b32_sdwa v1, 2, v91 dst_sel:WORD_0 dst_unused:UNUSED_PRESERVE src0_sel:DWORD src1_sel:WORD_1
    v_mfma_f32_16x16x32_bf16 v[144:147], v[208:211], v[96:99], v[144:147]
    ds_read_u16 v107, v0 offset:20416
    ds_read_u16 v91, v1 offset:20416
    v_rcp_f16_sdwa v111, v111 dst_sel:WORD_0 dst_unused:UNUSED_PRESERVE src0_sel:WORD_0
    v_mfma_f32_16x16x32_bf16 v[152:155], v[208:211], v[100:103], v[152:155]
    ds_read_b128 v[208:211], v50 offset:20480
    v_rcp_f16_sdwa v109, v109 dst_sel:WORD_1 dst_unused:UNUSED_PRESERVE src0_sel:WORD_1
    v_mfma_f32_16x16x32_bf16 v[148:151], v[212:215], v[96:99], v[148:151]
    v_rcp_f16_sdwa v110, v110 dst_sel:WORD_1 dst_unused:UNUSED_PRESERVE src0_sel:WORD_1
    v_mfma_f32_16x16x32_bf16 v[156:159], v[212:215], v[100:103], v[156:159]
    ds_read_b128 v[212:215], v50 offset:21504
    v_rcp_f16_sdwa v111, v111 dst_sel:WORD_1 dst_unused:UNUSED_PRESERVE src0_sel:WORD_1
    v_lshrrev_b32_sdwa v0, 2, v92 dst_sel:WORD_0 dst_unused:UNUSED_PRESERVE src0_sel:DWORD src1_sel:WORD_0
    v_lshrrev_b32_sdwa v1, 2, v92 dst_sel:WORD_0 dst_unused:UNUSED_PRESERVE src0_sel:DWORD src1_sel:WORD_1
    v_mfma_f32_16x16x32_bf16 v[160:163], v[216:219], v[96:99], v[160:163]
    ds_read_u16 v108, v0 offset:20416
    ds_read_u16 v92, v1 offset:20416
    v_fma_mix_f32 v224, v109, v93, 0 op_sel_hi:[1,1,0]
    v_mfma_f32_16x16x32_bf16 v[168:171], v[216:219], v[100:103], v[168:171]
    ds_read_b128 v[216:219], v50 offset:22528
    v_fma_mix_f32 v109, v109, v93, 0 op_sel:[1,1,0] op_sel_hi:[1,1,0]
    v_fma_mix_f32 v225, v110, v94, 0 op_sel_hi:[1,1,0]
    v_mfma_f32_16x16x32_bf16 v[164:167], v[220:223], v[96:99], v[164:167]
    v_fma_mix_f32 v110, v110, v94, 0 op_sel:[1,1,0] op_sel_hi:[1,1,0]
    v_fma_mix_f32 v226, v111, v95, 0 op_sel_hi:[1,1,0]
    v_mfma_f32_16x16x32_bf16 v[172:175], v[220:223], v[100:103], v[172:175]
    ds_read_b128 v[220:223], v50 offset:23552
    v_fma_mix_f32 v111, v111, v95, 0 op_sel:[1,1,0] op_sel_hi:[1,1,0]
    v_cvt_pk_bf16_f32 v93, v224, v109
    v_cvt_pk_bf16_f32 v94, v225, v110
    v_cvt_pk_bf16_f32 v95, v226, v111
    s_waitcnt lgkmcnt(2)
    v_lshl_or_b32 v88, v88, 16, v104
    v_lshl_or_b32 v89, v89, 16, v105
    v_lshl_or_b32 v90, v90, 16, v106
    v_lshl_or_b32 v91, v91, 16, v107
    v_lshl_or_b32 v92, v92, 16, v108
    s_waitcnt lgkmcnt(0)
    v_mfma_f32_16x16x32_bf16 v[128:131], v[200:203], v[88:91], v[128:131]
    s_setprio 3
    v_cvt_pk_f16_f32 v96, v112, v113
    v_cvt_pk_f16_f32 v97, v114, v115
    v_cvt_pk_f16_f32 v98, v116, v117
    v_cvt_pk_f16_f32 v99, v118, v119
    v_mfma_f32_16x16x32_bf16 v[136:139], v[200:203], v[92:95], v[136:139]
    ds_read_b128 v[200:203], v50 offset:43008
    v_cvt_pk_f16_f32 v100, v120, v121
    v_cvt_pk_f16_f32 v101, v122, v123
    v_cvt_pk_f16_f32 v102, v124, v125
    v_cvt_pk_f16_f32 v103, v126, v127
    v_mfma_f32_16x16x32_bf16 v[112:115], v[176:179], v[64:67], 0
    s_setprio 2
    v_and_b32 v96, s42, v96
    v_and_b32 v97, s42, v97
    v_and_b32 v98, s42, v98
    v_mfma_f32_16x16x32_bf16 v[120:123], v[176:179], v[76:79], 0
    ds_read_b64_tr_b16 v[176:177], v49 offset:6144
    ds_read_b64_tr_b16 v[178:179], v49 offset:6400
    v_and_b32 v99, s42, v99
    v_and_b32 v100, s42, v100
    v_lshrrev_b32_sdwa v0, 2, v96 dst_sel:WORD_0 dst_unused:UNUSED_PRESERVE src0_sel:DWORD src1_sel:WORD_0
    v_lshrrev_b32_sdwa v1, 2, v96 dst_sel:WORD_0 dst_unused:UNUSED_PRESERVE src0_sel:DWORD src1_sel:WORD_1
    v_mfma_f32_16x16x32_bf16 v[116:119], v[180:183], v[64:67], 0
    ds_read_u16 v104, v0 offset:20416
    ds_read_u16 v96, v1 offset:20416
    v_pk_fma_f16 v109, v101, v101, s25
    v_pk_fma_f16 v110, v102, v102, s25
    v_mfma_f32_16x16x32_bf16 v[124:127], v[180:183], v[76:79], 0
    ds_read_b64_tr_b16 v[180:181], v62 offset:6144
    ds_read_b64_tr_b16 v[182:183], v62 offset:6400
    v_pk_fma_f16 v111, v103, v103, s25
    v_pk_mul_f16 v109, v109, v101
    v_mfma_f32_16x16x32_bf16 v[112:115], v[184:187], v[68:71], v[112:115]
    v_pk_mul_f16 v110, v110, v102
    v_pk_mul_f16 v111, v111, v103
    v_mfma_f32_16x16x32_bf16 v[120:123], v[184:187], v[80:83], v[120:123]
    ds_read_b64_tr_b16 v[184:185], v49 offset:8192
    ds_read_b64_tr_b16 v[186:187], v49 offset:8448
    v_exp_f16_sdwa v109, -v109 dst_sel:WORD_0 dst_unused:UNUSED_PRESERVE src0_sel:WORD_0
    v_lshrrev_b32_sdwa v0, 2, v97 dst_sel:WORD_0 dst_unused:UNUSED_PRESERVE src0_sel:DWORD src1_sel:WORD_0
    v_lshrrev_b32_sdwa v1, 2, v97 dst_sel:WORD_0 dst_unused:UNUSED_PRESERVE src0_sel:DWORD src1_sel:WORD_1
    v_mfma_f32_16x16x32_bf16 v[116:119], v[188:191], v[68:71], v[116:119]
    ds_read_u16 v105, v0 offset:20416
    ds_read_u16 v97, v1 offset:20416
    s_setprio 1
    v_exp_f16_sdwa v110, -v110 dst_sel:WORD_0 dst_unused:UNUSED_PRESERVE src0_sel:WORD_0
    v_mfma_f32_16x16x32_bf16 v[124:127], v[188:191], v[80:83], v[124:127]
    ds_read_b64_tr_b16 v[188:189], v62 offset:8192
    ds_read_b64_tr_b16 v[190:191], v62 offset:8448
    v_exp_f16_sdwa v111, -v111 dst_sel:WORD_0 dst_unused:UNUSED_PRESERVE src0_sel:WORD_0
    v_mfma_f32_16x16x32_bf16 v[112:115], v[192:195], v[72:75], v[112:115]
    v_exp_f16_sdwa v109, -v109 dst_sel:WORD_1 dst_unused:UNUSED_PRESERVE src0_sel:WORD_1
    v_mfma_f32_16x16x32_bf16 v[120:123], v[192:195], v[84:87], v[120:123]
    ds_read_b64_tr_b16 v[192:193], v49 offset:10240
    ds_read_b64_tr_b16 v[194:195], v49 offset:10496
    v_exp_f16_sdwa v110, -v110 dst_sel:WORD_1 dst_unused:UNUSED_PRESERVE src0_sel:WORD_1
    v_lshrrev_b32_sdwa v0, 2, v98 dst_sel:WORD_0 dst_unused:UNUSED_PRESERVE src0_sel:DWORD src1_sel:WORD_0
    v_lshrrev_b32_sdwa v1, 2, v98 dst_sel:WORD_0 dst_unused:UNUSED_PRESERVE src0_sel:DWORD src1_sel:WORD_1
    v_mfma_f32_16x16x32_bf16 v[116:119], v[196:199], v[72:75], v[116:119]
    ds_read_u16 v106, v0 offset:20416
    ds_read_u16 v98, v1 offset:20416
    v_exp_f16_sdwa v111, -v111 dst_sel:WORD_1 dst_unused:UNUSED_PRESERVE src0_sel:WORD_1
    v_mfma_f32_16x16x32_bf16 v[124:127], v[196:199], v[84:87], v[124:127]
    ds_read_b64_tr_b16 v[196:197], v62 offset:10240
    ds_read_b64_tr_b16 v[198:199], v62 offset:10496
    v_pk_fma_f16 v109, v109, s27, s27
    v_pk_fma_f16 v110, v110, s27, s27
    v_mfma_f32_16x16x32_bf16 v[132:135], v[204:207], v[88:91], v[132:135]
    v_pk_fma_f16 v111, v111, s27, s27
    v_rcp_f16_sdwa v109, v109 dst_sel:WORD_0 dst_unused:UNUSED_PRESERVE src0_sel:WORD_0
    v_mfma_f32_16x16x32_bf16 v[140:143], v[204:207], v[92:95], v[140:143]
    ds_read_b128 v[204:207], v50 offset:44032
    s_setprio 0
    v_rcp_f16_sdwa v110, v110 dst_sel:WORD_0 dst_unused:UNUSED_PRESERVE src0_sel:WORD_0
    v_lshrrev_b32_sdwa v0, 2, v99 dst_sel:WORD_0 dst_unused:UNUSED_PRESERVE src0_sel:DWORD src1_sel:WORD_0
    v_lshrrev_b32_sdwa v1, 2, v99 dst_sel:WORD_0 dst_unused:UNUSED_PRESERVE src0_sel:DWORD src1_sel:WORD_1
    v_mfma_f32_16x16x32_bf16 v[144:147], v[208:211], v[88:91], v[144:147]
    ds_read_u16 v107, v0 offset:20416
    ds_read_u16 v99, v1 offset:20416
    v_rcp_f16_sdwa v111, v111 dst_sel:WORD_0 dst_unused:UNUSED_PRESERVE src0_sel:WORD_0
    v_mfma_f32_16x16x32_bf16 v[152:155], v[208:211], v[92:95], v[152:155]
    ds_read_b128 v[208:211], v50 offset:45056
    v_rcp_f16_sdwa v109, v109 dst_sel:WORD_1 dst_unused:UNUSED_PRESERVE src0_sel:WORD_1
    v_mfma_f32_16x16x32_bf16 v[148:151], v[212:215], v[88:91], v[148:151]
    v_rcp_f16_sdwa v110, v110 dst_sel:WORD_1 dst_unused:UNUSED_PRESERVE src0_sel:WORD_1
    v_mfma_f32_16x16x32_bf16 v[156:159], v[212:215], v[92:95], v[156:159]
    ds_read_b128 v[212:215], v50 offset:46080
    v_rcp_f16_sdwa v111, v111 dst_sel:WORD_1 dst_unused:UNUSED_PRESERVE src0_sel:WORD_1
    v_lshrrev_b32_sdwa v0, 2, v100 dst_sel:WORD_0 dst_unused:UNUSED_PRESERVE src0_sel:DWORD src1_sel:WORD_0
    v_lshrrev_b32_sdwa v1, 2, v100 dst_sel:WORD_0 dst_unused:UNUSED_PRESERVE src0_sel:DWORD src1_sel:WORD_1
    v_mfma_f32_16x16x32_bf16 v[160:163], v[216:219], v[88:91], v[160:163]
    ds_read_u16 v108, v0 offset:20416
    ds_read_u16 v100, v1 offset:20416
    v_fma_mix_f32 v224, v109, v101, 0 op_sel_hi:[1,1,0]
    v_mfma_f32_16x16x32_bf16 v[168:171], v[216:219], v[92:95], v[168:171]
    ds_read_b128 v[216:219], v50 offset:47104
    v_fma_mix_f32 v109, v109, v101, 0 op_sel:[1,1,0] op_sel_hi:[1,1,0]
    v_fma_mix_f32 v225, v110, v102, 0 op_sel_hi:[1,1,0]
    v_mfma_f32_16x16x32_bf16 v[164:167], v[220:223], v[88:91], v[164:167]
    v_fma_mix_f32 v110, v110, v102, 0 op_sel:[1,1,0] op_sel_hi:[1,1,0]
    v_fma_mix_f32 v226, v111, v103, 0 op_sel_hi:[1,1,0]
    v_mfma_f32_16x16x32_bf16 v[172:175], v[220:223], v[92:95], v[172:175]
    ds_read_b128 v[220:223], v50 offset:48128
    v_fma_mix_f32 v111, v111, v103, 0 op_sel:[1,1,0] op_sel_hi:[1,1,0]
    v_cvt_pk_bf16_f32 v101, v224, v109
    v_cvt_pk_bf16_f32 v102, v225, v110
    v_cvt_pk_bf16_f32 v103, v226, v111
    s_waitcnt lgkmcnt(2)
    v_lshl_or_b32 v96, v96, 16, v104
    v_lshl_or_b32 v97, v97, 16, v105
    v_lshl_or_b32 v98, v98, 16, v106
    v_lshl_or_b32 v99, v99, 16, v107
    v_lshl_or_b32 v100, v100, 16, v108
    s_waitcnt vmcnt(0) lgkmcnt(0)
    s_barrier
    v_mfma_f32_16x16x32_bf16 v[128:131], v[200:203], v[96:99], v[128:131]
    s_setprio 0
    s_sub_u32 m0, s34, 6144
    s_movk_i32 s79, 30720
    buffer_load_dwordx4 v51, s[44:47], s79 offen offset:0 lds
    v_cvt_pk_f16_f32 v88, v112, v113
    v_cvt_pk_f16_f32 v89, v114, v115
    v_cvt_pk_f16_f32 v90, v116, v117
    v_cvt_pk_f16_f32 v91, v118, v119
    v_mfma_f32_16x16x32_bf16 v[136:139], v[200:203], v[100:103], v[136:139]
    ds_read_b128 v[200:203], v50 offset:24576
    v_cvt_pk_f16_f32 v92, v120, v121
    v_cvt_pk_f16_f32 v93, v122, v123
    v_cvt_pk_f16_f32 v94, v124, v125
    v_cvt_pk_f16_f32 v95, v126, v127
    v_mfma_f32_16x16x32_bf16 v[112:115], v[176:179], v[64:67], 0
    s_setprio 1
    v_and_b32 v88, s42, v88
    v_and_b32 v89, s42, v89
    v_and_b32 v90, s42, v90
    v_mfma_f32_16x16x32_bf16 v[120:123], v[176:179], v[76:79], 0
    ds_read_b64_tr_b16 v[176:177], v49 offset:12288
    ds_read_b64_tr_b16 v[178:179], v49 offset:12544
    v_and_b32 v91, s42, v91
    v_and_b32 v92, s42, v92
    v_lshrrev_b32_sdwa v0, 2, v88 dst_sel:WORD_0 dst_unused:UNUSED_PRESERVE src0_sel:DWORD src1_sel:WORD_0
    v_lshrrev_b32_sdwa v1, 2, v88 dst_sel:WORD_0 dst_unused:UNUSED_PRESERVE src0_sel:DWORD src1_sel:WORD_1
    v_mfma_f32_16x16x32_bf16 v[116:119], v[180:183], v[64:67], 0
    ds_read_u16 v104, v0 offset:20416
    ds_read_u16 v88, v1 offset:20416
    v_pk_fma_f16 v109, v93, v93, s25
    v_pk_fma_f16 v110, v94, v94, s25
    v_mfma_f32_16x16x32_bf16 v[124:127], v[180:183], v[76:79], 0
    ds_read_b64_tr_b16 v[180:181], v62 offset:12288
    ds_read_b64_tr_b16 v[182:183], v62 offset:12544
    v_pk_fma_f16 v111, v95, v95, s25
    v_pk_mul_f16 v109, v109, v93
    v_mfma_f32_16x16x32_bf16 v[112:115], v[184:187], v[68:71], v[112:115]
    v_pk_mul_f16 v110, v110, v94
    v_pk_mul_f16 v111, v111, v95
    v_mfma_f32_16x16x32_bf16 v[120:123], v[184:187], v[80:83], v[120:123]
    ds_read_b64_tr_b16 v[184:185], v49 offset:14336
    ds_read_b64_tr_b16 v[186:187], v49 offset:14592
    v_exp_f16_sdwa v109, -v109 dst_sel:WORD_0 dst_unused:UNUSED_PRESERVE src0_sel:WORD_0
    v_lshrrev_b32_sdwa v0, 2, v89 dst_sel:WORD_0 dst_unused:UNUSED_PRESERVE src0_sel:DWORD src1_sel:WORD_0
    v_lshrrev_b32_sdwa v1, 2, v89 dst_sel:WORD_0 dst_unused:UNUSED_PRESERVE src0_sel:DWORD src1_sel:WORD_1
    v_mfma_f32_16x16x32_bf16 v[116:119], v[188:191], v[68:71], v[116:119]
    ds_read_u16 v105, v0 offset:20416
    ds_read_u16 v89, v1 offset:20416
    s_setprio 2
    v_exp_f16_sdwa v110, -v110 dst_sel:WORD_0 dst_unused:UNUSED_PRESERVE src0_sel:WORD_0
    v_mfma_f32_16x16x32_bf16 v[124:127], v[188:191], v[80:83], v[124:127]
    ds_read_b64_tr_b16 v[188:189], v62 offset:14336
    ds_read_b64_tr_b16 v[190:191], v62 offset:14592
    v_exp_f16_sdwa v111, -v111 dst_sel:WORD_0 dst_unused:UNUSED_PRESERVE src0_sel:WORD_0
    v_mfma_f32_16x16x32_bf16 v[112:115], v[192:195], v[72:75], v[112:115]
    v_exp_f16_sdwa v109, -v109 dst_sel:WORD_1 dst_unused:UNUSED_PRESERVE src0_sel:WORD_1
    v_mfma_f32_16x16x32_bf16 v[120:123], v[192:195], v[84:87], v[120:123]
    ds_read_b64_tr_b16 v[192:193], v49 offset:16384
    ds_read_b64_tr_b16 v[194:195], v49 offset:16640
    v_exp_f16_sdwa v110, -v110 dst_sel:WORD_1 dst_unused:UNUSED_PRESERVE src0_sel:WORD_1
    v_lshrrev_b32_sdwa v0, 2, v90 dst_sel:WORD_0 dst_unused:UNUSED_PRESERVE src0_sel:DWORD src1_sel:WORD_0
    v_lshrrev_b32_sdwa v1, 2, v90 dst_sel:WORD_0 dst_unused:UNUSED_PRESERVE src0_sel:DWORD src1_sel:WORD_1
    v_mfma_f32_16x16x32_bf16 v[116:119], v[196:199], v[72:75], v[116:119]
    ds_read_u16 v106, v0 offset:20416
    ds_read_u16 v90, v1 offset:20416
    v_exp_f16_sdwa v111, -v111 dst_sel:WORD_1 dst_unused:UNUSED_PRESERVE src0_sel:WORD_1
    v_mfma_f32_16x16x32_bf16 v[124:127], v[196:199], v[84:87], v[124:127]
    ds_read_b64_tr_b16 v[196:197], v62 offset:16384
    ds_read_b64_tr_b16 v[198:199], v62 offset:16640
    v_pk_fma_f16 v109, v109, s27, s27
    v_pk_fma_f16 v110, v110, s27, s27
    v_mfma_f32_16x16x32_bf16 v[132:135], v[204:207], v[96:99], v[132:135]
    v_pk_fma_f16 v111, v111, s27, s27
    v_rcp_f16_sdwa v109, v109 dst_sel:WORD_0 dst_unused:UNUSED_PRESERVE src0_sel:WORD_0
    v_mfma_f32_16x16x32_bf16 v[140:143], v[204:207], v[100:103], v[140:143]
    ds_read_b128 v[204:207], v50 offset:25600
    s_setprio 3
    v_rcp_f16_sdwa v110, v110 dst_sel:WORD_0 dst_unused:UNUSED_PRESERVE src0_sel:WORD_0
    v_lshrrev_b32_sdwa v0, 2, v91 dst_sel:WORD_0 dst_unused:UNUSED_PRESERVE src0_sel:DWORD src1_sel:WORD_0
    v_lshrrev_b32_sdwa v1, 2, v91 dst_sel:WORD_0 dst_unused:UNUSED_PRESERVE src0_sel:DWORD src1_sel:WORD_1
    v_mfma_f32_16x16x32_bf16 v[144:147], v[208:211], v[96:99], v[144:147]
    ds_read_u16 v107, v0 offset:20416
    ds_read_u16 v91, v1 offset:20416
    v_rcp_f16_sdwa v111, v111 dst_sel:WORD_0 dst_unused:UNUSED_PRESERVE src0_sel:WORD_0
    v_mfma_f32_16x16x32_bf16 v[152:155], v[208:211], v[100:103], v[152:155]
    ds_read_b128 v[208:211], v50 offset:26624
    v_rcp_f16_sdwa v109, v109 dst_sel:WORD_1 dst_unused:UNUSED_PRESERVE src0_sel:WORD_1
    v_mfma_f32_16x16x32_bf16 v[148:151], v[212:215], v[96:99], v[148:151]
    v_rcp_f16_sdwa v110, v110 dst_sel:WORD_1 dst_unused:UNUSED_PRESERVE src0_sel:WORD_1
    v_mfma_f32_16x16x32_bf16 v[156:159], v[212:215], v[100:103], v[156:159]
    ds_read_b128 v[212:215], v50 offset:27648
    v_rcp_f16_sdwa v111, v111 dst_sel:WORD_1 dst_unused:UNUSED_PRESERVE src0_sel:WORD_1
    v_lshrrev_b32_sdwa v0, 2, v92 dst_sel:WORD_0 dst_unused:UNUSED_PRESERVE src0_sel:DWORD src1_sel:WORD_0
    v_lshrrev_b32_sdwa v1, 2, v92 dst_sel:WORD_0 dst_unused:UNUSED_PRESERVE src0_sel:DWORD src1_sel:WORD_1
    v_mfma_f32_16x16x32_bf16 v[160:163], v[216:219], v[96:99], v[160:163]
    ds_read_u16 v108, v0 offset:20416
    ds_read_u16 v92, v1 offset:20416
    v_fma_mix_f32 v224, v109, v93, 0 op_sel_hi:[1,1,0]
    v_mfma_f32_16x16x32_bf16 v[168:171], v[216:219], v[100:103], v[168:171]
    ds_read_b128 v[216:219], v50 offset:28672
    v_fma_mix_f32 v109, v109, v93, 0 op_sel:[1,1,0] op_sel_hi:[1,1,0]
    v_fma_mix_f32 v225, v110, v94, 0 op_sel_hi:[1,1,0]
    v_mfma_f32_16x16x32_bf16 v[164:167], v[220:223], v[96:99], v[164:167]
    v_fma_mix_f32 v110, v110, v94, 0 op_sel:[1,1,0] op_sel_hi:[1,1,0]
    v_fma_mix_f32 v226, v111, v95, 0 op_sel_hi:[1,1,0]
    v_mfma_f32_16x16x32_bf16 v[172:175], v[220:223], v[100:103], v[172:175]
    ds_read_b128 v[220:223], v50 offset:29696
    v_fma_mix_f32 v111, v111, v95, 0 op_sel:[1,1,0] op_sel_hi:[1,1,0]
    v_cvt_pk_bf16_f32 v93, v224, v109
    v_cvt_pk_bf16_f32 v94, v225, v110
    v_cvt_pk_bf16_f32 v95, v226, v111
    s_waitcnt lgkmcnt(2)
    v_lshl_or_b32 v88, v88, 16, v104
    v_lshl_or_b32 v89, v89, 16, v105
    v_lshl_or_b32 v90, v90, 16, v106
    v_lshl_or_b32 v91, v91, 16, v107
    v_lshl_or_b32 v92, v92, 16, v108
    s_waitcnt lgkmcnt(0)
    v_mfma_f32_16x16x32_bf16 v[128:131], v[200:203], v[88:91], v[128:131]
    s_setprio 3
    v_cvt_pk_f16_f32 v96, v112, v113
    v_cvt_pk_f16_f32 v97, v114, v115
    v_cvt_pk_f16_f32 v98, v116, v117
    v_cvt_pk_f16_f32 v99, v118, v119
    v_mfma_f32_16x16x32_bf16 v[136:139], v[200:203], v[92:95], v[136:139]
    ds_read_b128 v[200:203], v50 offset:36864
    v_cvt_pk_f16_f32 v100, v120, v121
    v_cvt_pk_f16_f32 v101, v122, v123
    v_cvt_pk_f16_f32 v102, v124, v125
    v_cvt_pk_f16_f32 v103, v126, v127
    v_mfma_f32_16x16x32_bf16 v[112:115], v[176:179], v[64:67], 0
    s_setprio 2
    v_and_b32 v96, s42, v96
    v_and_b32 v97, s42, v97
    v_and_b32 v98, s42, v98
    v_mfma_f32_16x16x32_bf16 v[120:123], v[176:179], v[76:79], 0
    ds_read_b64_tr_b16 v[176:177], v49 offset:18432
    ds_read_b64_tr_b16 v[178:179], v49 offset:18688
    v_and_b32 v99, s42, v99
    v_and_b32 v100, s42, v100
    v_lshrrev_b32_sdwa v0, 2, v96 dst_sel:WORD_0 dst_unused:UNUSED_PRESERVE src0_sel:DWORD src1_sel:WORD_0
    v_lshrrev_b32_sdwa v1, 2, v96 dst_sel:WORD_0 dst_unused:UNUSED_PRESERVE src0_sel:DWORD src1_sel:WORD_1
    v_mfma_f32_16x16x32_bf16 v[116:119], v[180:183], v[64:67], 0
    ds_read_u16 v104, v0 offset:20416
    ds_read_u16 v96, v1 offset:20416
    v_pk_fma_f16 v109, v101, v101, s25
    v_pk_fma_f16 v110, v102, v102, s25
    v_mfma_f32_16x16x32_bf16 v[124:127], v[180:183], v[76:79], 0
    ds_read_b64_tr_b16 v[180:181], v62 offset:18432
    ds_read_b64_tr_b16 v[182:183], v62 offset:18688
    v_pk_fma_f16 v111, v103, v103, s25
    v_pk_mul_f16 v109, v109, v101
    v_mfma_f32_16x16x32_bf16 v[112:115], v[184:187], v[68:71], v[112:115]
    v_pk_mul_f16 v110, v110, v102
    v_pk_mul_f16 v111, v111, v103
    v_mfma_f32_16x16x32_bf16 v[120:123], v[184:187], v[80:83], v[120:123]
    ds_read_b64_tr_b16 v[184:185], v49 offset:20480
    ds_read_b64_tr_b16 v[186:187], v49 offset:20736
    v_exp_f16_sdwa v109, -v109 dst_sel:WORD_0 dst_unused:UNUSED_PRESERVE src0_sel:WORD_0
    v_lshrrev_b32_sdwa v0, 2, v97 dst_sel:WORD_0 dst_unused:UNUSED_PRESERVE src0_sel:DWORD src1_sel:WORD_0
    v_lshrrev_b32_sdwa v1, 2, v97 dst_sel:WORD_0 dst_unused:UNUSED_PRESERVE src0_sel:DWORD src1_sel:WORD_1
    v_mfma_f32_16x16x32_bf16 v[116:119], v[188:191], v[68:71], v[116:119]
    ds_read_u16 v105, v0 offset:20416
    ds_read_u16 v97, v1 offset:20416
    s_setprio 1
    v_exp_f16_sdwa v110, -v110 dst_sel:WORD_0 dst_unused:UNUSED_PRESERVE src0_sel:WORD_0
    v_mfma_f32_16x16x32_bf16 v[124:127], v[188:191], v[80:83], v[124:127]
    ds_read_b64_tr_b16 v[188:189], v62 offset:20480
    ds_read_b64_tr_b16 v[190:191], v62 offset:20736
    v_exp_f16_sdwa v111, -v111 dst_sel:WORD_0 dst_unused:UNUSED_PRESERVE src0_sel:WORD_0
    v_mfma_f32_16x16x32_bf16 v[112:115], v[192:195], v[72:75], v[112:115]
    v_exp_f16_sdwa v109, -v109 dst_sel:WORD_1 dst_unused:UNUSED_PRESERVE src0_sel:WORD_1
    v_mfma_f32_16x16x32_bf16 v[120:123], v[192:195], v[84:87], v[120:123]
    ds_read_b64_tr_b16 v[192:193], v49 offset:22528
    ds_read_b64_tr_b16 v[194:195], v49 offset:22784
    v_exp_f16_sdwa v110, -v110 dst_sel:WORD_1 dst_unused:UNUSED_PRESERVE src0_sel:WORD_1
    v_lshrrev_b32_sdwa v0, 2, v98 dst_sel:WORD_0 dst_unused:UNUSED_PRESERVE src0_sel:DWORD src1_sel:WORD_0
    v_lshrrev_b32_sdwa v1, 2, v98 dst_sel:WORD_0 dst_unused:UNUSED_PRESERVE src0_sel:DWORD src1_sel:WORD_1
    v_mfma_f32_16x16x32_bf16 v[116:119], v[196:199], v[72:75], v[116:119]
    ds_read_u16 v106, v0 offset:20416
    ds_read_u16 v98, v1 offset:20416
    v_exp_f16_sdwa v111, -v111 dst_sel:WORD_1 dst_unused:UNUSED_PRESERVE src0_sel:WORD_1
    v_mfma_f32_16x16x32_bf16 v[124:127], v[196:199], v[84:87], v[124:127]
    ds_read_b64_tr_b16 v[196:197], v62 offset:22528
    ds_read_b64_tr_b16 v[198:199], v62 offset:22784
    v_pk_fma_f16 v109, v109, s27, s27
    v_pk_fma_f16 v110, v110, s27, s27
    v_mfma_f32_16x16x32_bf16 v[132:135], v[204:207], v[88:91], v[132:135]
    v_pk_fma_f16 v111, v111, s27, s27
    v_rcp_f16_sdwa v109, v109 dst_sel:WORD_0 dst_unused:UNUSED_PRESERVE src0_sel:WORD_0
    v_mfma_f32_16x16x32_bf16 v[140:143], v[204:207], v[92:95], v[140:143]
    ds_read_b128 v[204:207], v50 offset:37888
    s_setprio 0
    v_rcp_f16_sdwa v110, v110 dst_sel:WORD_0 dst_unused:UNUSED_PRESERVE src0_sel:WORD_0
    v_lshrrev_b32_sdwa v0, 2, v99 dst_sel:WORD_0 dst_unused:UNUSED_PRESERVE src0_sel:DWORD src1_sel:WORD_0
    v_lshrrev_b32_sdwa v1, 2, v99 dst_sel:WORD_0 dst_unused:UNUSED_PRESERVE src0_sel:DWORD src1_sel:WORD_1
    v_mfma_f32_16x16x32_bf16 v[144:147], v[208:211], v[88:91], v[144:147]
    ds_read_u16 v107, v0 offset:20416
    ds_read_u16 v99, v1 offset:20416
    v_rcp_f16_sdwa v111, v111 dst_sel:WORD_0 dst_unused:UNUSED_PRESERVE src0_sel:WORD_0
    v_mfma_f32_16x16x32_bf16 v[152:155], v[208:211], v[92:95], v[152:155]
    ds_read_b128 v[208:211], v50 offset:38912
    v_rcp_f16_sdwa v109, v109 dst_sel:WORD_1 dst_unused:UNUSED_PRESERVE src0_sel:WORD_1
    v_mfma_f32_16x16x32_bf16 v[148:151], v[212:215], v[88:91], v[148:151]
    v_rcp_f16_sdwa v110, v110 dst_sel:WORD_1 dst_unused:UNUSED_PRESERVE src0_sel:WORD_1
    v_mfma_f32_16x16x32_bf16 v[156:159], v[212:215], v[92:95], v[156:159]
    ds_read_b128 v[212:215], v50 offset:39936
    v_rcp_f16_sdwa v111, v111 dst_sel:WORD_1 dst_unused:UNUSED_PRESERVE src0_sel:WORD_1
    v_lshrrev_b32_sdwa v0, 2, v100 dst_sel:WORD_0 dst_unused:UNUSED_PRESERVE src0_sel:DWORD src1_sel:WORD_0
    v_lshrrev_b32_sdwa v1, 2, v100 dst_sel:WORD_0 dst_unused:UNUSED_PRESERVE src0_sel:DWORD src1_sel:WORD_1
    v_mfma_f32_16x16x32_bf16 v[160:163], v[216:219], v[88:91], v[160:163]
    ds_read_u16 v108, v0 offset:20416
    ds_read_u16 v100, v1 offset:20416
    v_fma_mix_f32 v224, v109, v101, 0 op_sel_hi:[1,1,0]
    v_mfma_f32_16x16x32_bf16 v[168:171], v[216:219], v[92:95], v[168:171]
    ds_read_b128 v[216:219], v50 offset:40960
    v_fma_mix_f32 v109, v109, v101, 0 op_sel:[1,1,0] op_sel_hi:[1,1,0]
    v_fma_mix_f32 v225, v110, v102, 0 op_sel_hi:[1,1,0]
    v_mfma_f32_16x16x32_bf16 v[164:167], v[220:223], v[88:91], v[164:167]
    v_fma_mix_f32 v110, v110, v102, 0 op_sel:[1,1,0] op_sel_hi:[1,1,0]
    v_fma_mix_f32 v226, v111, v103, 0 op_sel_hi:[1,1,0]
    v_mfma_f32_16x16x32_bf16 v[172:175], v[220:223], v[92:95], v[172:175]
    ds_read_b128 v[220:223], v50 offset:41984
    v_fma_mix_f32 v111, v111, v103, 0 op_sel:[1,1,0] op_sel_hi:[1,1,0]
    v_cvt_pk_bf16_f32 v101, v224, v109
    v_cvt_pk_bf16_f32 v102, v225, v110
    v_cvt_pk_bf16_f32 v103, v226, v111
    s_waitcnt lgkmcnt(2)
    v_lshl_or_b32 v96, v96, 16, v104
    v_lshl_or_b32 v97, v97, 16, v105
    v_lshl_or_b32 v98, v98, 16, v106
    v_lshl_or_b32 v99, v99, 16, v107
    v_lshl_or_b32 v100, v100, 16, v108
    s_waitcnt vmcnt(0) lgkmcnt(0)
    s_barrier
    v_mfma_f32_16x16x32_bf16 v[128:131], v[200:203], v[96:99], v[128:131]
    s_setprio 0
    v_cvt_pk_f16_f32 v88, v112, v113
    v_cvt_pk_f16_f32 v89, v114, v115
    v_cvt_pk_f16_f32 v90, v116, v117
    v_cvt_pk_f16_f32 v91, v118, v119
    v_mfma_f32_16x16x32_bf16 v[136:139], v[200:203], v[100:103], v[136:139]
    ds_read_b128 v[200:203], v50 offset:30720
    v_cvt_pk_f16_f32 v92, v120, v121
    v_cvt_pk_f16_f32 v93, v122, v123
    v_cvt_pk_f16_f32 v94, v124, v125
    v_cvt_pk_f16_f32 v95, v126, v127
    v_mfma_f32_16x16x32_bf16 v[112:115], v[176:179], v[64:67], 0
    s_setprio 1
    v_and_b32 v88, s42, v88
    v_and_b32 v89, s42, v89
    v_and_b32 v90, s42, v90
    v_mfma_f32_16x16x32_bf16 v[120:123], v[176:179], v[76:79], 0
    v_and_b32 v91, s42, v91
    v_and_b32 v92, s42, v92
    v_lshrrev_b32_sdwa v0, 2, v88 dst_sel:WORD_0 dst_unused:UNUSED_PRESERVE src0_sel:DWORD src1_sel:WORD_0
    v_lshrrev_b32_sdwa v1, 2, v88 dst_sel:WORD_0 dst_unused:UNUSED_PRESERVE src0_sel:DWORD src1_sel:WORD_1
    v_mfma_f32_16x16x32_bf16 v[116:119], v[180:183], v[64:67], 0
    ds_read_u16 v104, v0 offset:20416
    ds_read_u16 v88, v1 offset:20416
    s_add_u32 s16, s16, 1572864
    s_add_u32 s21, s21, 1
    v_pk_fma_f16 v109, v93, v93, s25
    v_pk_fma_f16 v110, v94, v94, s25
    v_mfma_f32_16x16x32_bf16 v[124:127], v[180:183], v[76:79], 0
    v_pk_fma_f16 v111, v95, v95, s25
    v_pk_mul_f16 v109, v109, v93
    v_mfma_f32_16x16x32_bf16 v[112:115], v[184:187], v[68:71], v[112:115]
    v_pk_mul_f16 v110, v110, v94
    v_pk_mul_f16 v111, v111, v95
    v_mfma_f32_16x16x32_bf16 v[120:123], v[184:187], v[80:83], v[120:123]
    v_exp_f16_sdwa v109, -v109 dst_sel:WORD_0 dst_unused:UNUSED_PRESERVE src0_sel:WORD_0
    v_lshrrev_b32_sdwa v0, 2, v89 dst_sel:WORD_0 dst_unused:UNUSED_PRESERVE src0_sel:DWORD src1_sel:WORD_0
    v_lshrrev_b32_sdwa v1, 2, v89 dst_sel:WORD_0 dst_unused:UNUSED_PRESERVE src0_sel:DWORD src1_sel:WORD_1
    v_mfma_f32_16x16x32_bf16 v[116:119], v[188:191], v[68:71], v[116:119]
    ds_read_u16 v105, v0 offset:20416
    ds_read_u16 v89, v1 offset:20416
    s_setprio 2
    v_exp_f16_sdwa v110, -v110 dst_sel:WORD_0 dst_unused:UNUSED_PRESERVE src0_sel:WORD_0
    v_mfma_f32_16x16x32_bf16 v[124:127], v[188:191], v[80:83], v[124:127]
    v_exp_f16_sdwa v111, -v111 dst_sel:WORD_0 dst_unused:UNUSED_PRESERVE src0_sel:WORD_0
    v_mfma_f32_16x16x32_bf16 v[112:115], v[192:195], v[72:75], v[112:115]
    v_exp_f16_sdwa v109, -v109 dst_sel:WORD_1 dst_unused:UNUSED_PRESERVE src0_sel:WORD_1
    v_mfma_f32_16x16x32_bf16 v[120:123], v[192:195], v[84:87], v[120:123]
    v_exp_f16_sdwa v110, -v110 dst_sel:WORD_1 dst_unused:UNUSED_PRESERVE src0_sel:WORD_1
    v_lshrrev_b32_sdwa v0, 2, v90 dst_sel:WORD_0 dst_unused:UNUSED_PRESERVE src0_sel:DWORD src1_sel:WORD_0
    v_lshrrev_b32_sdwa v1, 2, v90 dst_sel:WORD_0 dst_unused:UNUSED_PRESERVE src0_sel:DWORD src1_sel:WORD_1
    v_mfma_f32_16x16x32_bf16 v[116:119], v[196:199], v[72:75], v[116:119]
    ds_read_u16 v106, v0 offset:20416
    ds_read_u16 v90, v1 offset:20416
    v_exp_f16_sdwa v111, -v111 dst_sel:WORD_1 dst_unused:UNUSED_PRESERVE src0_sel:WORD_1
    v_mfma_f32_16x16x32_bf16 v[124:127], v[196:199], v[84:87], v[124:127]
    v_pk_fma_f16 v109, v109, s27, s27
    v_pk_fma_f16 v110, v110, s27, s27
    v_mfma_f32_16x16x32_bf16 v[132:135], v[204:207], v[96:99], v[132:135]
    v_pk_fma_f16 v111, v111, s27, s27
    v_rcp_f16_sdwa v109, v109 dst_sel:WORD_0 dst_unused:UNUSED_PRESERVE src0_sel:WORD_0
    v_mfma_f32_16x16x32_bf16 v[140:143], v[204:207], v[100:103], v[140:143]
    ds_read_b128 v[204:207], v50 offset:31744
    s_setprio 3
    v_rcp_f16_sdwa v110, v110 dst_sel:WORD_0 dst_unused:UNUSED_PRESERVE src0_sel:WORD_0
    v_lshrrev_b32_sdwa v0, 2, v91 dst_sel:WORD_0 dst_unused:UNUSED_PRESERVE src0_sel:DWORD src1_sel:WORD_0
    v_lshrrev_b32_sdwa v1, 2, v91 dst_sel:WORD_0 dst_unused:UNUSED_PRESERVE src0_sel:DWORD src1_sel:WORD_1
    v_mfma_f32_16x16x32_bf16 v[144:147], v[208:211], v[96:99], v[144:147]
    ds_read_u16 v107, v0 offset:20416
    ds_read_u16 v91, v1 offset:20416
    v_rcp_f16_sdwa v111, v111 dst_sel:WORD_0 dst_unused:UNUSED_PRESERVE src0_sel:WORD_0
    v_mfma_f32_16x16x32_bf16 v[152:155], v[208:211], v[100:103], v[152:155]
    ds_read_b128 v[208:211], v50 offset:32768
    v_rcp_f16_sdwa v109, v109 dst_sel:WORD_1 dst_unused:UNUSED_PRESERVE src0_sel:WORD_1
    v_mfma_f32_16x16x32_bf16 v[148:151], v[212:215], v[96:99], v[148:151]
    v_rcp_f16_sdwa v110, v110 dst_sel:WORD_1 dst_unused:UNUSED_PRESERVE src0_sel:WORD_1
    v_mfma_f32_16x16x32_bf16 v[156:159], v[212:215], v[100:103], v[156:159]
    ds_read_b128 v[212:215], v50 offset:33792
    v_rcp_f16_sdwa v111, v111 dst_sel:WORD_1 dst_unused:UNUSED_PRESERVE src0_sel:WORD_1
    v_lshrrev_b32_sdwa v0, 2, v92 dst_sel:WORD_0 dst_unused:UNUSED_PRESERVE src0_sel:DWORD src1_sel:WORD_0
    v_lshrrev_b32_sdwa v1, 2, v92 dst_sel:WORD_0 dst_unused:UNUSED_PRESERVE src0_sel:DWORD src1_sel:WORD_1
    v_mfma_f32_16x16x32_bf16 v[160:163], v[216:219], v[96:99], v[160:163]
    ds_read_u16 v108, v0 offset:20416
    ds_read_u16 v92, v1 offset:20416
    v_fma_mix_f32 v224, v109, v93, 0 op_sel_hi:[1,1,0]
    v_mfma_f32_16x16x32_bf16 v[168:171], v[216:219], v[100:103], v[168:171]
    ds_read_b128 v[216:219], v50 offset:34816
    v_fma_mix_f32 v109, v109, v93, 0 op_sel:[1,1,0] op_sel_hi:[1,1,0]
    v_fma_mix_f32 v225, v110, v94, 0 op_sel_hi:[1,1,0]
    v_mfma_f32_16x16x32_bf16 v[164:167], v[220:223], v[96:99], v[164:167]
    v_fma_mix_f32 v110, v110, v94, 0 op_sel:[1,1,0] op_sel_hi:[1,1,0]
    v_fma_mix_f32 v226, v111, v95, 0 op_sel_hi:[1,1,0]
    v_mfma_f32_16x16x32_bf16 v[172:175], v[220:223], v[100:103], v[172:175]
    ds_read_b128 v[220:223], v50 offset:35840
    v_fma_mix_f32 v111, v111, v95, 0 op_sel:[1,1,0] op_sel_hi:[1,1,0]
    v_cvt_pk_bf16_f32 v93, v224, v109
    v_cvt_pk_bf16_f32 v94, v225, v110
    v_cvt_pk_bf16_f32 v95, v226, v111
    s_waitcnt lgkmcnt(2)
    v_lshl_or_b32 v88, v88, 16, v104
    v_lshl_or_b32 v89, v89, 16, v105
    v_lshl_or_b32 v90, v90, 16, v106
    v_lshl_or_b32 v91, v91, 16, v107
    v_lshl_or_b32 v92, v92, 16, v108
    s_waitcnt lgkmcnt(0)
    s_setprio 3
    v_mfma_f32_16x16x32_bf16 v[128:131], v[200:203], v[88:91], v[128:131]
    v_cvt_pk_f16_f32 v96, v112, v113
    v_cvt_pk_f16_f32 v97, v114, v115
    v_cvt_pk_f16_f32 v98, v116, v117
    v_mfma_f32_16x16x32_bf16 v[136:139], v[200:203], v[92:95], v[136:139]
    ds_read_b128 v[200:203], v50 offset:43008
    v_cvt_pk_f16_f32 v99, v118, v119
    v_and_b32 v96, s42, v96
    v_and_b32 v97, s42, v97
    v_mfma_f32_16x16x32_bf16 v[132:135], v[204:207], v[88:91], v[132:135]
    v_pk_fma_f16 v106, v98, v98, s25
    v_pk_fma_f16 v107, v99, v99, s25
    v_pk_mul_f16 v106, v106, v98
    v_mfma_f32_16x16x32_bf16 v[140:143], v[204:207], v[92:95], v[140:143]
    ds_read_b128 v[204:207], v50 offset:44032
    v_pk_mul_f16 v107, v107, v99
    v_exp_f16_sdwa v106, -v106 dst_sel:WORD_0 dst_unused:UNUSED_PRESERVE src0_sel:WORD_0
    v_lshrrev_b32_sdwa v0, 2, v96 dst_sel:WORD_0 dst_unused:UNUSED_PRESERVE src0_sel:DWORD src1_sel:WORD_0
    v_lshrrev_b32_sdwa v1, 2, v96 dst_sel:WORD_0 dst_unused:UNUSED_PRESERVE src0_sel:DWORD src1_sel:WORD_1
    v_mfma_f32_16x16x32_bf16 v[144:147], v[208:211], v[88:91], v[144:147]
    ds_read_u16 v104, v0 offset:20416
    ds_read_u16 v96, v1 offset:20416
    v_exp_f16_sdwa v107, -v107 dst_sel:WORD_0 dst_unused:UNUSED_PRESERVE src0_sel:WORD_0
    v_exp_f16_sdwa v106, -v106 dst_sel:WORD_1 dst_unused:UNUSED_PRESERVE src0_sel:WORD_1
    v_mfma_f32_16x16x32_bf16 v[152:155], v[208:211], v[92:95], v[152:155]
    ds_read_b128 v[208:211], v50 offset:45056
    v_exp_f16_sdwa v107, -v107 dst_sel:WORD_1 dst_unused:UNUSED_PRESERVE src0_sel:WORD_1
    v_pk_fma_f16 v106, v106, s27, s27
    v_mfma_f32_16x16x32_bf16 v[148:151], v[212:215], v[88:91], v[148:151]
    v_pk_fma_f16 v107, v107, s27, s27
    v_rcp_f16_sdwa v106, v106 dst_sel:WORD_0 dst_unused:UNUSED_PRESERVE src0_sel:WORD_0
    v_lshrrev_b32_sdwa v0, 2, v97 dst_sel:WORD_0 dst_unused:UNUSED_PRESERVE src0_sel:DWORD src1_sel:WORD_0
    v_lshrrev_b32_sdwa v1, 2, v97 dst_sel:WORD_0 dst_unused:UNUSED_PRESERVE src0_sel:DWORD src1_sel:WORD_1
    v_mfma_f32_16x16x32_bf16 v[156:159], v[212:215], v[92:95], v[156:159]
    ds_read_u16 v105, v0 offset:20416
    ds_read_u16 v97, v1 offset:20416
    ds_read_b128 v[212:215], v50 offset:46080
    v_rcp_f16_sdwa v107, v107 dst_sel:WORD_0 dst_unused:UNUSED_PRESERVE src0_sel:WORD_0
    v_rcp_f16_sdwa v106, v106 dst_sel:WORD_1 dst_unused:UNUSED_PRESERVE src0_sel:WORD_1
    v_mfma_f32_16x16x32_bf16 v[160:163], v[216:219], v[88:91], v[160:163]
    v_rcp_f16_sdwa v107, v107 dst_sel:WORD_1 dst_unused:UNUSED_PRESERVE src0_sel:WORD_1
    v_mfma_f32_16x16x32_bf16 v[168:171], v[216:219], v[92:95], v[168:171]
    ds_read_b128 v[216:219], v50 offset:47104
    v_fma_mix_f32 v224, v106, v98, 0 op_sel_hi:[1,1,0]
    v_fma_mix_f32 v106, v106, v98, 0 op_sel:[1,1,0] op_sel_hi:[1,1,0]
    v_fma_mix_f32 v225, v107, v99, 0 op_sel_hi:[1,1,0]
    v_mfma_f32_16x16x32_bf16 v[164:167], v[220:223], v[88:91], v[164:167]
    v_fma_mix_f32 v107, v107, v99, 0 op_sel:[1,1,0] op_sel_hi:[1,1,0]
    v_cvt_pk_bf16_f32 v98, v224, v106
    v_cvt_pk_bf16_f32 v99, v225, v107
    s_waitcnt lgkmcnt(2)
    v_lshl_or_b32 v96, v96, 16, v104
    v_mfma_f32_16x16x32_bf16 v[172:175], v[220:223], v[92:95], v[172:175]
    ds_read_b128 v[220:223], v50 offset:48128
    s_cmp_eq_u32 s21, 1
    s_cselect_b32 s79, 0, 1572864
    s_add_u32 s22, s22, s79
    v_lshl_or_b32 v97, v97, 16, v105
    s_setprio 1
    v_cvt_pk_f16_f32 v100, v120, v121
    v_cvt_pk_f16_f32 v101, v122, v123
    v_cvt_pk_f16_f32 v102, v124, v125
    v_cvt_pk_f16_f32 v103, v126, v127
    v_and_b32 v100, s42, v100
    v_and_b32 v101, s42, v101
    s_waitcnt lgkmcnt(8)
    v_mfma_f32_16x16x32_bf16 v[128:131], v[200:203], v[96:99], v[128:131]
    v_pk_fma_f16 v110, v102, v102, s25
    v_pk_fma_f16 v111, v103, v103, s25
    v_pk_mul_f16 v110, v110, v102
    v_pk_mul_f16 v111, v111, v103
    v_exp_f16_sdwa v110, -v110 dst_sel:WORD_0 dst_unused:UNUSED_PRESERVE src0_sel:WORD_0
    v_lshrrev_b32_sdwa v0, 2, v100 dst_sel:WORD_0 dst_unused:UNUSED_PRESERVE src0_sel:DWORD src1_sel:WORD_0
    v_lshrrev_b32_sdwa v1, 2, v100 dst_sel:WORD_0 dst_unused:UNUSED_PRESERVE src0_sel:DWORD src1_sel:WORD_1
    v_mfma_f32_16x16x32_bf16 v[132:135], v[204:207], v[96:99], v[132:135]
    ds_read_u16 v108, v0 offset:20416
    ds_read_u16 v100, v1 offset:20416
    v_exp_f16_sdwa v111, -v111 dst_sel:WORD_0 dst_unused:UNUSED_PRESERVE src0_sel:WORD_0
    v_exp_f16_sdwa v110, -v110 dst_sel:WORD_1 dst_unused:UNUSED_PRESERVE src0_sel:WORD_1
    v_exp_f16_sdwa v111, -v111 dst_sel:WORD_1 dst_unused:UNUSED_PRESERVE src0_sel:WORD_1
    s_waitcnt lgkmcnt(4)
    v_mfma_f32_16x16x32_bf16 v[144:147], v[208:211], v[96:99], v[144:147]
    v_pk_fma_f16 v110, v110, s27, s27
    v_pk_fma_f16 v111, v111, s27, s27
    v_rcp_f16_sdwa v110, v110 dst_sel:WORD_0 dst_unused:UNUSED_PRESERVE src0_sel:WORD_0
    v_lshrrev_b32_sdwa v0, 2, v101 dst_sel:WORD_0 dst_unused:UNUSED_PRESERVE src0_sel:DWORD src1_sel:WORD_0
    v_lshrrev_b32_sdwa v1, 2, v101 dst_sel:WORD_0 dst_unused:UNUSED_PRESERVE src0_sel:DWORD src1_sel:WORD_1
    v_mfma_f32_16x16x32_bf16 v[148:151], v[212:215], v[96:99], v[148:151]
    ds_read_u16 v109, v0 offset:20416
    ds_read_u16 v101, v1 offset:20416
    v_rcp_f16_sdwa v111, v111 dst_sel:WORD_0 dst_unused:UNUSED_PRESERVE src0_sel:WORD_0
    v_rcp_f16_sdwa v110, v110 dst_sel:WORD_1 dst_unused:UNUSED_PRESERVE src0_sel:WORD_1
    v_rcp_f16_sdwa v111, v111 dst_sel:WORD_1 dst_unused:UNUSED_PRESERVE src0_sel:WORD_1
    s_waitcnt lgkmcnt(5)
    v_mfma_f32_16x16x32_bf16 v[160:163], v[216:219], v[96:99], v[160:163]
    v_fma_mix_f32 v224, v110, v102, 0 op_sel_hi:[1,1,0]
    v_fma_mix_f32 v110, v110, v102, 0 op_sel:[1,1,0] op_sel_hi:[1,1,0]
    v_fma_mix_f32 v225, v111, v103, 0 op_sel_hi:[1,1,0]
    v_fma_mix_f32 v111, v111, v103, 0 op_sel:[1,1,0] op_sel_hi:[1,1,0]
    v_cvt_pk_bf16_f32 v102, v224, v110
    s_waitcnt lgkmcnt(4)
    v_mfma_f32_16x16x32_bf16 v[164:167], v[220:223], v[96:99], v[164:167]
    v_cvt_pk_bf16_f32 v103, v225, v111
    s_waitcnt lgkmcnt(0)
    v_lshl_or_b32 v100, v100, 16, v108
    v_lshl_or_b32 v101, v101, 16, v109
    s_waitcnt lgkmcnt(0)
    s_nop 0
    v_mfma_f32_16x16x32_bf16 v[136:139], v[200:203], v[100:103], v[136:139]
    v_cmp_class_f32 vcc, v128, s43
    s_nop 0
    s_or_b64 s[56:57], s[56:57], vcc
    v_cvt_pk_bf16_f32 v232, v128, v129
    v_mfma_f32_16x16x32_bf16 v[140:143], v[204:207], v[100:103], v[140:143]
    v_cvt_pk_bf16_f32 v233, v130, v131
    v_cvt_pk_bf16_f32 v234, v132, v133
    v_cvt_pk_bf16_f32 v235, v134, v135
    v_mfma_f32_16x16x32_bf16 v[152:155], v[208:211], v[100:103], v[152:155]
    buffer_store_dwordx4 v[232:235], v55, s[8:11], s22 offen offset:0 sc0 sc1 nt
    v_cvt_pk_bf16_f32 v240, v144, v145
    v_cvt_pk_bf16_f32 v241, v146, v147
    v_mfma_f32_16x16x32_bf16 v[156:159], v[212:215], v[100:103], v[156:159]
    v_cvt_pk_bf16_f32 v242, v148, v149
    v_cvt_pk_bf16_f32 v243, v150, v151
    buffer_store_dwordx4 v[240:243], v55, s[8:11], s22 offen offset:64 sc0 sc1 nt
    v_mfma_f32_16x16x32_bf16 v[168:171], v[216:219], v[100:103], v[168:171]
    v_cvt_pk_bf16_f32 v248, v160, v161
    v_cvt_pk_bf16_f32 v249, v162, v163
    v_cvt_pk_bf16_f32 v250, v164, v165
    v_mfma_f32_16x16x32_bf16 v[172:175], v[220:223], v[100:103], v[172:175]
    v_cvt_pk_bf16_f32 v251, v166, v167
    buffer_store_dwordx4 v[248:251], v55, s[8:11], s22 offen offset:128 sc0 sc1 nt
    v_cmp_class_f32 vcc, v136, s43
    s_nop 0
    s_or_b64 s[56:57], s[56:57], vcc
    v_cvt_pk_bf16_f32 v236, v136, v137
    v_cvt_pk_bf16_f32 v237, v138, v139
    v_cvt_pk_bf16_f32 v238, v140, v141
    v_cvt_pk_bf16_f32 v239, v142, v143
    buffer_store_dwordx4 v[236:239], v55, s[8:11], s22 offen offset:1536 sc0 sc1 nt
    v_cvt_pk_bf16_f32 v244, v152, v153
    v_cvt_pk_bf16_f32 v245, v154, v155
    v_cvt_pk_bf16_f32 v246, v156, v157
    v_cvt_pk_bf16_f32 v247, v158, v159
    buffer_store_dwordx4 v[244:247], v55, s[8:11], s22 offen offset:1600 sc0 sc1 nt
    v_cvt_pk_bf16_f32 v252, v168, v169
    v_cvt_pk_bf16_f32 v253, v170, v171
    v_cvt_pk_bf16_f32 v254, v172, v173
    v_cvt_pk_bf16_f32 v255, v174, v175
    buffer_store_dwordx4 v[252:255], v55, s[8:11], s22 offen offset:1664 sc0 sc1 nt
    v_mov_b32 v1, 150784
    v_mov_b32 v2, 1
    s_cmp_eq_u64 s[56:57], 0
    s_cbranch_scc1 L_noflag
    ds_write_b32 v1, v2 offset:0
    s_waitcnt lgkmcnt(0)
L_noflag:
    s_barrier
    ds_read_b32 v2, v1 offset:0
    s_waitcnt lgkmcnt(0)
    v_readfirstlane_b32 s79, v2
    s_nop 0
    s_cmp_eq_u32 s79, 0
    s_cbranch_scc1 L_done
    s_waitcnt vmcnt(0)
    s_barrier
    s_mov_b32 s19, 1
    s_setprio 0
    v_mbcnt_lo_u32_b32 v0, -1, 0
    v_mbcnt_hi_u32_b32 v0, -1, v0
    v_lshl_add_u32 v0, s24, 6, v0
    s_branch L_restart
L_done:
L_exit:
    s_endpgm
L_stats_s:
    s_setprio 3
    s_waitcnt lgkmcnt(10)
    v_dot2_f32_bf16 v0, v64, s26, 0
    v_dot2_f32_bf16 v2, v64, v64, 0
    v_dot2_f32_bf16 v0, v65, s26, v0
    v_dot2_f32_bf16 v2, v65, v65, v2
    v_dot2_f32_bf16 v0, v66, s26, v0
    v_dot2_f32_bf16 v2, v66, v66, v2
    v_dot2_f32_bf16 v0, v67, s26, v0
    v_dot2_f32_bf16 v2, v67, v67, v2
    s_waitcnt lgkmcnt(8)
    v_dot2_f32_bf16 v0, v68, s26, v0
    v_dot2_f32_bf16 v2, v68, v68, v2
    v_dot2_f32_bf16 v0, v69, s26, v0
    v_dot2_f32_bf16 v2, v69, v69, v2
    v_dot2_f32_bf16 v0, v70, s26, v0
    v_dot2_f32_bf16 v2, v70, v70, v2
    v_dot2_f32_bf16 v0, v71, s26, v0
    v_dot2_f32_bf16 v2, v71, v71, v2
    s_waitcnt lgkmcnt(6)
    v_dot2_f32_bf16 v0, v72, s26, v0
    v_dot2_f32_bf16 v2, v72, v72, v2
    v_dot2_f32_bf16 v0, v73, s26, v0
    v_dot2_f32_bf16 v2, v73, v73, v2
    v_dot2_f32_bf16 v0, v74, s26, v0
    v_dot2_f32_bf16 v2, v74, v74, v2
    v_dot2_f32_bf16 v0, v75, s26, v0
    v_dot2_f32_bf16 v2, v75, v75, v2
    s_waitcnt lgkmcnt(4)
    v_dot2_f32_bf16 v1, v76, s26, 0
    v_dot2_f32_bf16 v3, v76, v76, 0
    v_dot2_f32_bf16 v1, v77, s26, v1
    v_dot2_f32_bf16 v3, v77, v77, v3
    v_dot2_f32_bf16 v1, v78, s26, v1
    v_dot2_f32_bf16 v3, v78, v78, v3
    v_dot2_f32_bf16 v1, v79, s26, v1
    v_dot2_f32_bf16 v3, v79, v79, v3
    s_waitcnt lgkmcnt(2)
    v_dot2_f32_bf16 v1, v80, s26, v1
    v_dot2_f32_bf16 v3, v80, v80, v3
    v_dot2_f32_bf16 v1, v81, s26, v1
    v_dot2_f32_bf16 v3, v81, v81, v3
    v_dot2_f32_bf16 v1, v82, s26, v1
    v_dot2_f32_bf16 v3, v82, v82, v3
    v_dot2_f32_bf16 v1, v83, s26, v1
    v_dot2_f32_bf16 v3, v83, v83, v3
    s_waitcnt lgkmcnt(0)
    v_dot2_f32_bf16 v1, v84, s26, v1
    v_dot2_f32_bf16 v3, v84, v84, v3
    v_dot2_f32_bf16 v1, v85, s26, v1
    v_dot2_f32_bf16 v3, v85, v85, v3
    v_dot2_f32_bf16 v1, v86, s26, v1
    v_dot2_f32_bf16 v3, v86, v86, v3
    v_dot2_f32_bf16 v1, v87, s26, v1
    v_dot2_f32_bf16 v3, v87, v87, v3
    s_nop 1
    v_permlane32_swap_b32 v0, v1
    v_permlane32_swap_b32 v2, v3
    v_add_f32 v0, v0, v1
    v_add_f32 v2, v2, v3
    s_nop 1
    v_permlane16_swap_b32 v0, v2
    v_add_f32 v0, v0, v2
    v_mov_b32 v1, v0
    v_mov_b32 v2, s29
    s_nop 0
    v_permlane16_swap_b32 v0, v1
    v_mul_f32 v0, s28, v0
    v_fma_f32 v1, v1, s28, v2
    v_fma_f32 v1, -v0, v0, v1
    v_max_f32 v1, v1, v2
    v_rsq_f32 v1, v1
    s_nop 0
    v_mul_f32 v1, s30, v1
    v_cvt_pk_bf16_f32 v2, 0, v1
    v_mul_f32 v0, -v0, v2
    v_mov_b32 v3, v2
    v_mov_b32 v1, v0
    s_nop 0
    v_permlane32_swap_b32 v2, v3
    v_permlane32_swap_b32 v0, v1
    v_lshrrev_b32 v224, 16, v2
    v_lshrrev_b32 v225, 16, v3
    s_setprio 2
    v_dot2_f32_bf16 v88, v64, v224, v0
    v_dot2_f32_bf16 v89, v64, v2, v0
    v_dot2_f32_bf16 v90, v65, v224, v0
    v_dot2_f32_bf16 v91, v65, v2, v0
    v_dot2_f32_bf16 v92, v66, v224, v0
    v_dot2_f32_bf16 v93, v66, v2, v0
    v_dot2_f32_bf16 v94, v67, v224, v0
    v_dot2_f32_bf16 v95, v67, v2, v0
    v_dot2_f32_bf16 v96, v68, v224, v0
    v_dot2_f32_bf16 v97, v68, v2, v0
    v_dot2_f32_bf16 v98, v69, v224, v0
    v_dot2_f32_bf16 v99, v69, v2, v0
    v_dot2_f32_bf16 v100, v70, v224, v0
    v_dot2_f32_bf16 v101, v70, v2, v0
    v_dot2_f32_bf16 v102, v71, v224, v0
    v_dot2_f32_bf16 v103, v71, v2, v0
    v_cvt_pk_bf16_f32 v64, v88, v89
    v_cvt_pk_bf16_f32 v65, v90, v91
    v_cvt_pk_bf16_f32 v66, v92, v93
    v_cvt_pk_bf16_f32 v67, v94, v95
    s_setprio 1
    v_dot2_f32_bf16 v104, v72, v224, v0
    v_dot2_f32_bf16 v105, v72, v2, v0
    v_dot2_f32_bf16 v106, v73, v224, v0
    v_dot2_f32_bf16 v107, v73, v2, v0
    v_dot2_f32_bf16 v108, v74, v224, v0
    v_dot2_f32_bf16 v109, v74, v2, v0
    v_dot2_f32_bf16 v110, v75, v224, v0
    v_dot2_f32_bf16 v111, v75, v2, v0
    v_cvt_pk_bf16_f32 v68, v96, v97
    v_cvt_pk_bf16_f32 v69, v98, v99
    v_cvt_pk_bf16_f32 v70, v100, v101
    v_cvt_pk_bf16_f32 v71, v102, v103
    v_dot2_f32_bf16 v88, v76, v225, v1
    v_dot2_f32_bf16 v89, v76, v3, v1
    v_dot2_f32_bf16 v90, v77, v225, v1
    v_dot2_f32_bf16 v91, v77, v3, v1
    v_dot2_f32_bf16 v92, v78, v225, v1
    v_dot2_f32_bf16 v93, v78, v3, v1
    v_dot2_f32_bf16 v94, v79, v225, v1
    v_dot2_f32_bf16 v95, v79, v3, v1
    v_cvt_pk_bf16_f32 v72, v104, v105
    v_cvt_pk_bf16_f32 v73, v106, v107
    v_cvt_pk_bf16_f32 v74, v108, v109
    v_cvt_pk_bf16_f32 v75, v110, v111
    s_setprio 0
    v_dot2_f32_bf16 v96, v80, v225, v1
    v_dot2_f32_bf16 v97, v80, v3, v1
    v_dot2_f32_bf16 v98, v81, v225, v1
    v_dot2_f32_bf16 v99, v81, v3, v1
    v_dot2_f32_bf16 v100, v82, v225, v1
    v_dot2_f32_bf16 v101, v82, v3, v1
    v_dot2_f32_bf16 v102, v83, v225, v1
    v_dot2_f32_bf16 v103, v83, v3, v1
    v_cvt_pk_bf16_f32 v76, v88, v89
    v_cvt_pk_bf16_f32 v77, v90, v91
    v_cvt_pk_bf16_f32 v78, v92, v93
    v_cvt_pk_bf16_f32 v79, v94, v95
    v_dot2_f32_bf16 v104, v84, v225, v1
    v_dot2_f32_bf16 v105, v84, v3, v1
    v_dot2_f32_bf16 v106, v85, v225, v1
    v_dot2_f32_bf16 v107, v85, v3, v1
    v_dot2_f32_bf16 v108, v86, v225, v1
    v_dot2_f32_bf16 v109, v86, v3, v1
    v_dot2_f32_bf16 v110, v87, v225, v1
    v_dot2_f32_bf16 v111, v87, v3, v1
    v_cvt_pk_bf16_f32 v80, v96, v97
    v_cvt_pk_bf16_f32 v81, v98, v99
    v_cvt_pk_bf16_f32 v82, v100, v101
    v_cvt_pk_bf16_f32 v83, v102, v103
    v_mfma_f32_16x16x32_bf16 v[112:115], v[176:179], v[64:67], 0
    v_mov_b32 v0, 0x20000
    v_mfma_f32_16x16x32_bf16 v[116:119], v[180:183], v[64:67], 0
    v_mov_b32 v1, 0x20000
    v_mfma_f32_16x16x32_bf16 v[112:115], v[184:187], v[68:71], v[112:115]
    v_cvt_pk_bf16_f32 v84, v104, v105
    v_cvt_pk_bf16_f32 v85, v106, v107
    v_cvt_pk_bf16_f32 v86, v108, v109
    v_cvt_pk_bf16_f32 v87, v110, v111
    v_mfma_f32_16x16x32_bf16 v[116:119], v[188:191], v[68:71], v[116:119]
    v_mfma_f32_16x16x32_bf16 v[112:115], v[192:195], v[72:75], v[112:115]
    v_mfma_f32_16x16x32_bf16 v[116:119], v[196:199], v[72:75], v[116:119]
    v_mfma_f32_16x16x32_bf16 v[120:123], v[176:179], v[76:79], 0
    ds_read_b64_tr_b16 v[176:177], v49 offset:6144
    ds_read_b64_tr_b16 v[178:179], v49 offset:6400
    v_mfma_f32_16x16x32_bf16 v[124:127], v[180:183], v[76:79], 0
    ds_read_b64_tr_b16 v[180:181], v62 offset:6144
    ds_read_b64_tr_b16 v[182:183], v62 offset:6400
    v_mfma_f32_16x16x32_bf16 v[120:123], v[184:187], v[80:83], v[120:123]
    ds_read_b64_tr_b16 v[184:185], v49 offset:8192
    ds_read_b64_tr_b16 v[186:187], v49 offset:8448
    v_mfma_f32_16x16x32_bf16 v[124:127], v[188:191], v[80:83], v[124:127]
    ds_read_b64_tr_b16 v[188:189], v62 offset:8192
    ds_read_b64_tr_b16 v[190:191], v62 offset:8448
    v_mfma_f32_16x16x32_bf16 v[120:123], v[192:195], v[84:87], v[120:123]
    ds_read_b64_tr_b16 v[192:193], v49 offset:10240
    ds_read_b64_tr_b16 v[194:195], v49 offset:10496
    v_mfma_f32_16x16x32_bf16 v[124:127], v[196:199], v[84:87], v[124:127]
    ds_read_b64_tr_b16 v[196:197], v62 offset:10240
    ds_read_b64_tr_b16 v[198:199], v62 offset:10496
    s_waitcnt vmcnt(1) lgkmcnt(0)
    s_barrier
    s_sub_u32 m0, s34, 6144
    s_movk_i32 s79, 6144
    buffer_load_dwordx4 v51, s[44:47], s79 offen offset:0 lds
    s_add_u32 m0, s34, -128
    s_setprio 0
    buffer_load_dwordx4 v54, s[36:39], 0 offen offset:128 lds
    v_fma_f32 v104, v112, v112, s20
    v_fma_f32 v105, v113, v113, s20
    v_fma_f32 v106, v114, v114, s20
    v_fma_f32 v107, v115, v115, s20
    v_fma_f32 v108, v116, v116, s20
    v_fma_f32 v109, v117, v117, s20
    v_fma_f32 v110, v118, v118, s20
    v_fma_f32 v111, v119, v119, s20
    v_fma_f32 v224, v120, v120, s20
    v_fma_f32 v225, v121, v121, s20
    v_fma_f32 v226, v122, v122, s20
    v_fma_f32 v227, v123, v123, s20
    v_fma_f32 v228, v124, v124, s20
    v_fma_f32 v229, v125, v125, s20
    v_fma_f32 v230, v126, v126, s20
    v_fma_f32 v231, v127, v127, s20
    v_mul_f32 v104, v104, v112
    v_mul_f32 v105, v105, v113
    v_mul_f32 v106, v106, v114
    v_mul_f32 v107, v107, v115
    v_mul_f32 v108, v108, v116
    v_mul_f32 v109, v109, v117
    v_mul_f32 v110, v110, v118
    v_mul_f32 v111, v111, v119
    v_mul_f32 v224, v224, v120
    v_mul_f32 v225, v225, v121
    v_mul_f32 v226, v226, v122
    v_mul_f32 v227, v227, v123
    v_mul_f32 v228, v228, v124
    v_mul_f32 v229, v229, v125
    v_mul_f32 v230, v230, v126
    v_mul_f32 v231, v231, v127
    v_exp_f32 v104, -v104
    v_exp_f32 v105, -v105
    v_exp_f32 v106, -v106
    v_exp_f32 v107, -v107
    v_exp_f32 v108, -v108
    v_exp_f32 v109, -v109
    v_exp_f32 v110, -v110
    v_exp_f32 v111, -v111
    v_exp_f32 v224, -v224
    v_exp_f32 v225, -v225
    v_exp_f32 v226, -v226
    v_exp_f32 v227, -v227
    v_exp_f32 v228, -v228
    v_exp_f32 v229, -v229
    v_exp_f32 v230, -v230
    v_exp_f32 v231, -v231
    v_fma_f32 v104, v104, s30, s30
    v_fma_f32 v105, v105, s30, s30
    v_fma_f32 v106, v106, s30, s30
    v_fma_f32 v107, v107, s30, s30
    v_fma_f32 v108, v108, s30, s30
    v_fma_f32 v109, v109, s30, s30
    v_fma_f32 v110, v110, s30, s30
    v_fma_f32 v111, v111, s30, s30
    v_fma_f32 v224, v224, s30, s30
    v_fma_f32 v225, v225, s30, s30
    v_fma_f32 v226, v226, s30, s30
    v_fma_f32 v227, v227, s30, s30
    v_fma_f32 v228, v228, s30, s30
    v_fma_f32 v229, v229, s30, s30
    v_fma_f32 v230, v230, s30, s30
    v_fma_f32 v231, v231, s30, s30
    v_rcp_f32 v104, v104
    v_rcp_f32 v105, v105
    v_rcp_f32 v106, v106
    v_rcp_f32 v107, v107
    v_rcp_f32 v108, v108
    v_rcp_f32 v109, v109
    v_rcp_f32 v110, v110
    v_rcp_f32 v111, v111
    v_rcp_f32 v224, v224
    v_rcp_f32 v225, v225
    v_rcp_f32 v226, v226
    v_rcp_f32 v227, v227
    v_rcp_f32 v228, v228
    v_rcp_f32 v229, v229
    v_rcp_f32 v230, v230
    v_rcp_f32 v231, v231
    v_mul_f32 v104, v104, v112
    v_mul_f32 v105, v105, v113
    v_mul_f32 v106, v106, v114
    v_mul_f32 v107, v107, v115
    v_mul_f32 v108, v108, v116
    v_mul_f32 v109, v109, v117
    v_mul_f32 v110, v110, v118
    v_mul_f32 v111, v111, v119
    v_mul_f32 v224, v224, v120
    v_mul_f32 v225, v225, v121
    v_mul_f32 v226, v226, v122
    v_mul_f32 v227, v227, v123
    v_mul_f32 v228, v228, v124
    v_mul_f32 v229, v229, v125
    v_mul_f32 v230, v230, v126
    v_mul_f32 v231, v231, v127
    v_cvt_pk_bf16_f32 v88, v104, v105
    v_cvt_pk_bf16_f32 v89, v106, v107
    v_cvt_pk_bf16_f32 v90, v108, v109
    v_cvt_pk_bf16_f32 v91, v110, v111
    v_cvt_pk_bf16_f32 v92, v224, v225
    v_cvt_pk_bf16_f32 v93, v226, v227
    v_cvt_pk_bf16_f32 v94, v228, v229
    v_cvt_pk_bf16_f32 v95, v230, v231
    v_mfma_f32_16x16x32_bf16 v[112:115], v[176:179], v[64:67], 0
    v_mfma_f32_16x16x32_bf16 v[120:123], v[176:179], v[76:79], 0
    s_add_u32 m0, s34, 5632
    ds_read_b64_tr_b16 v[176:177], v49 offset:12288
    ds_read_b64_tr_b16 v[178:179], v49 offset:12544
    ds_read_b128 v[200:203], v50 offset:0
    buffer_load_dwordx4 v54, s[36:39], 0 offen offset:512 lds
    v_mfma_f32_16x16x32_bf16 v[116:119], v[180:183], v[64:67], 0
    buffer_store_dwordx4 v[232:235], v55, s[8:11], s22 offen offset:0 sc0 sc1 nt
    v_mfma_f32_16x16x32_bf16 v[124:127], v[180:183], v[76:79], 0
    ds_read_b64_tr_b16 v[180:181], v62 offset:12288
    ds_read_b64_tr_b16 v[182:183], v62 offset:12544
    ds_read_b128 v[204:207], v50 offset:1024
    v_mfma_f32_16x16x32_bf16 v[112:115], v[184:187], v[68:71], v[112:115]
    s_add_u32 m0, s40, 0
    s_add_u32 s31, s16, 0
    buffer_load_dwordx4 v52, s[4:7], s31 offen offset:0 nt lds
    v_mfma_f32_16x16x32_bf16 v[120:123], v[184:187], v[80:83], v[120:123]
    ds_read_b64_tr_b16 v[184:185], v49 offset:14336
    ds_read_b64_tr_b16 v[186:187], v49 offset:14592
    ds_read_b128 v[208:211], v50 offset:2048
    v_mfma_f32_16x16x32_bf16 v[116:119], v[188:191], v[68:71], v[116:119]
    v_mfma_f32_16x16x32_bf16 v[124:127], v[188:191], v[80:83], v[124:127]
    ds_read_b64_tr_b16 v[188:189], v62 offset:14336
    ds_read_b64_tr_b16 v[190:191], v62 offset:14592
    ds_read_b128 v[212:215], v50 offset:3072
    v_mfma_f32_16x16x32_bf16 v[112:115], v[192:195], v[72:75], v[112:115]
    v_mfma_f32_16x16x32_bf16 v[120:123], v[192:195], v[84:87], v[120:123]
    s_add_u32 m0, s41, 0
    ds_read_b64_tr_b16 v[192:193], v49 offset:16384
    ds_read_b64_tr_b16 v[194:195], v49 offset:16640
    ds_read_b128 v[216:219], v50 offset:4096
    buffer_load_dwordx4 v53, s[4:7], s31 offen offset:0 nt lds
    v_mfma_f32_16x16x32_bf16 v[116:119], v[196:199], v[72:75], v[116:119]
    v_mfma_f32_16x16x32_bf16 v[124:127], v[196:199], v[84:87], v[124:127]
    ds_read_b64_tr_b16 v[196:197], v62 offset:16384
    ds_read_b64_tr_b16 v[198:199], v62 offset:16640
    ds_read_b128 v[220:223], v50 offset:5120
    s_waitcnt lgkmcnt(0)
    v_mfma_f32_16x16x32_bf16 v[128:131], v[200:203], v[88:91], v[128:131]
    s_setprio 3
    v_fma_f32 v104, v112, v112, s20
    v_fma_f32 v105, v113, v113, s20
    v_fma_f32 v106, v114, v114, s20
    v_fma_f32 v107, v115, v115, s20
    v_fma_f32 v108, v116, v116, s20
    v_fma_f32 v109, v117, v117, s20
    v_fma_f32 v110, v118, v118, s20
    v_mfma_f32_16x16x32_bf16 v[136:139], v[200:203], v[92:95], v[136:139]
    ds_read_b128 v[200:203], v50 offset:36864
    v_fma_f32 v111, v119, v119, s20
    v_fma_f32 v224, v120, v120, s20
    v_fma_f32 v225, v121, v121, s20
    v_fma_f32 v226, v122, v122, s20
    v_fma_f32 v227, v123, v123, s20
    v_fma_f32 v228, v124, v124, s20
    v_fma_f32 v229, v125, v125, s20
    v_fma_f32 v230, v126, v126, s20
    v_fma_f32 v231, v127, v127, s20
    v_mul_f32 v104, v104, v112
    v_mul_f32 v105, v105, v113
    v_mul_f32 v106, v106, v114
    v_mfma_f32_16x16x32_bf16 v[132:135], v[204:207], v[88:91], v[132:135]
    v_mul_f32 v107, v107, v115
    v_mul_f32 v108, v108, v116
    v_mul_f32 v109, v109, v117
    v_mul_f32 v110, v110, v118
    v_mul_f32 v111, v111, v119
    v_mul_f32 v224, v224, v120
    v_mul_f32 v225, v225, v121
    v_mul_f32 v226, v226, v122
    v_mul_f32 v227, v227, v123
    v_mul_f32 v228, v228, v124
    v_mul_f32 v229, v229, v125
    v_mfma_f32_16x16x32_bf16 v[140:143], v[204:207], v[92:95], v[140:143]
    ds_read_b128 v[204:207], v50 offset:37888
    v_mul_f32 v230, v230, v126
    v_mul_f32 v231, v231, v127
    v_exp_f32 v104, -v104
    v_exp_f32 v105, -v105
    v_exp_f32 v106, -v106
    v_exp_f32 v107, -v107
    v_exp_f32 v108, -v108
    v_mfma_f32_16x16x32_bf16 v[144:147], v[208:211], v[88:91], v[144:147]
    v_exp_f32 v109, -v109
    v_exp_f32 v110, -v110
    v_exp_f32 v111, -v111
    v_exp_f32 v224, -v224
    v_exp_f32 v225, -v225
    v_exp_f32 v226, -v226
    v_mfma_f32_16x16x32_bf16 v[152:155], v[208:211], v[92:95], v[152:155]
    ds_read_b128 v[208:211], v50 offset:38912
    v_exp_f32 v227, -v227
    v_exp_f32 v228, -v228
    v_exp_f32 v229, -v229
    v_exp_f32 v230, -v230
    v_exp_f32 v231, -v231
    v_fma_f32 v104, v104, s30, s30
    v_mfma_f32_16x16x32_bf16 v[148:151], v[212:215], v[88:91], v[148:151]
    v_fma_f32 v105, v105, s30, s30
    v_fma_f32 v106, v106, s30, s30
    v_fma_f32 v107, v107, s30, s30
    v_fma_f32 v108, v108, s30, s30
    v_fma_f32 v109, v109, s30, s30
    v_fma_f32 v110, v110, s30, s30
    v_fma_f32 v111, v111, s30, s30
    v_fma_f32 v224, v224, s30, s30
    v_fma_f32 v225, v225, s30, s30
    v_fma_f32 v226, v226, s30, s30
    v_fma_f32 v227, v227, s30, s30
    v_fma_f32 v228, v228, s30, s30
    v_mfma_f32_16x16x32_bf16 v[156:159], v[212:215], v[92:95], v[156:159]
    ds_read_b128 v[212:215], v50 offset:39936
    v_fma_f32 v229, v229, s30, s30
    v_fma_f32 v230, v230, s30, s30
    v_fma_f32 v231, v231, s30, s30
    v_rcp_f32 v104, v104
    v_rcp_f32 v105, v105
    v_rcp_f32 v106, v106
    v_rcp_f32 v107, v107
    v_mfma_f32_16x16x32_bf16 v[160:163], v[216:219], v[88:91], v[160:163]
    v_rcp_f32 v108, v108
    v_rcp_f32 v109, v109
    v_rcp_f32 v110, v110
    v_rcp_f32 v111, v111
    v_rcp_f32 v224, v224
    v_rcp_f32 v225, v225
    v_mfma_f32_16x16x32_bf16 v[168:171], v[216:219], v[92:95], v[168:171]
    ds_read_b128 v[216:219], v50 offset:40960
    v_rcp_f32 v226, v226
    v_rcp_f32 v227, v227
    v_rcp_f32 v228, v228
    v_rcp_f32 v229, v229
    v_rcp_f32 v230, v230
    v_rcp_f32 v231, v231
    v_mfma_f32_16x16x32_bf16 v[164:167], v[220:223], v[88:91], v[164:167]
    v_mul_f32 v104, v104, v112
    v_mul_f32 v105, v105, v113
    v_mul_f32 v106, v106, v114
    v_mul_f32 v107, v107, v115
    v_mul_f32 v108, v108, v116
    v_mul_f32 v109, v109, v117
    v_mul_f32 v110, v110, v118
    v_mul_f32 v111, v111, v119
    v_mul_f32 v224, v224, v120
    v_mul_f32 v225, v225, v121
    v_mul_f32 v226, v226, v122
    v_mfma_f32_16x16x32_bf16 v[172:175], v[220:223], v[92:95], v[172:175]
    ds_read_b128 v[220:223], v50 offset:41984
    v_mul_f32 v227, v227, v123
    v_mul_f32 v228, v228, v124
    v_mul_f32 v229, v229, v125
    v_mul_f32 v230, v230, v126
    v_mul_f32 v231, v231, v127
    v_cvt_pk_bf16_f32 v96, v104, v105
    v_cvt_pk_bf16_f32 v97, v106, v107
    v_cvt_pk_bf16_f32 v98, v108, v109
    v_cvt_pk_bf16_f32 v99, v110, v111
    v_cvt_pk_bf16_f32 v100, v224, v225
    v_cvt_pk_bf16_f32 v101, v226, v227
    v_cvt_pk_bf16_f32 v102, v228, v229
    v_cvt_pk_bf16_f32 v103, v230, v231
    v_mfma_f32_16x16x32_bf16 v[112:115], v[176:179], v[64:67], 0
    v_mfma_f32_16x16x32_bf16 v[120:123], v[176:179], v[76:79], 0
    ds_read_b64_tr_b16 v[176:177], v49 offset:18432
    ds_read_b64_tr_b16 v[178:179], v49 offset:18688
    v_mfma_f32_16x16x32_bf16 v[116:119], v[180:183], v[64:67], 0
    v_mfma_f32_16x16x32_bf16 v[124:127], v[180:183], v[76:79], 0
    ds_read_b64_tr_b16 v[180:181], v62 offset:18432
    ds_read_b64_tr_b16 v[182:183], v62 offset:18688
    v_mfma_f32_16x16x32_bf16 v[112:115], v[184:187], v[68:71], v[112:115]
    s_add_u32 m0, s40, 15368
    s_add_u32 s31, s16, 393216
    buffer_load_dwordx4 v52, s[4:7], s31 offen offset:0 nt lds
    v_mfma_f32_16x16x32_bf16 v[120:123], v[184:187], v[80:83], v[120:123]
    ds_read_b64_tr_b16 v[184:185], v49 offset:20480
    ds_read_b64_tr_b16 v[186:187], v49 offset:20736
    v_mfma_f32_16x16x32_bf16 v[116:119], v[188:191], v[68:71], v[116:119]
    v_mfma_f32_16x16x32_bf16 v[124:127], v[188:191], v[80:83], v[124:127]
    ds_read_b64_tr_b16 v[188:189], v62 offset:20480
    ds_read_b64_tr_b16 v[190:191], v62 offset:20736
    v_mfma_f32_16x16x32_bf16 v[112:115], v[192:195], v[72:75], v[112:115]
    v_mfma_f32_16x16x32_bf16 v[120:123], v[192:195], v[84:87], v[120:123]
    s_add_u32 m0, s41, 15368
    ds_read_b64_tr_b16 v[192:193], v49 offset:22528
    ds_read_b64_tr_b16 v[194:195], v49 offset:22784
    buffer_load_dwordx4 v53, s[4:7], s31 offen offset:0 nt lds
    v_mfma_f32_16x16x32_bf16 v[116:119], v[196:199], v[72:75], v[116:119]
    v_mfma_f32_16x16x32_bf16 v[124:127], v[196:199], v[84:87], v[124:127]
    ds_read_b64_tr_b16 v[196:197], v62 offset:22528
    ds_read_b64_tr_b16 v[198:199], v62 offset:22784
    s_waitcnt vmcnt(5) lgkmcnt(0)
    s_barrier
    v_mfma_f32_16x16x32_bf16 v[128:131], v[200:203], v[96:99], v[128:131]
    s_sub_u32 m0, s34, 12288
    s_movk_i32 s79, 12288
    buffer_load_dwordx4 v51, s[44:47], s79 offen offset:0 lds
    s_add_u32 m0, s34, 12096
    s_setprio 0
    buffer_load_dwordx4 v54, s[36:39], 0 offen offset:192 lds
    v_fma_f32 v104, v112, v112, s20
    v_fma_f32 v105, v113, v113, s20
    v_fma_f32 v106, v114, v114, s20
    v_fma_f32 v107, v115, v115, s20
    v_fma_f32 v108, v116, v116, s20
    v_fma_f32 v109, v117, v117, s20
    v_fma_f32 v110, v118, v118, s20
    v_mfma_f32_16x16x32_bf16 v[136:139], v[200:203], v[100:103], v[136:139]
    ds_read_b128 v[200:203], v50 offset:6144
    v_fma_f32 v111, v119, v119, s20
    v_fma_f32 v224, v120, v120, s20
    v_fma_f32 v225, v121, v121, s20
    v_fma_f32 v226, v122, v122, s20
    v_fma_f32 v227, v123, v123, s20
    v_fma_f32 v228, v124, v124, s20
    v_fma_f32 v229, v125, v125, s20
    v_fma_f32 v230, v126, v126, s20
    v_fma_f32 v231, v127, v127, s20
    v_mul_f32 v104, v104, v112
    v_mul_f32 v105, v105, v113
    v_mul_f32 v106, v106, v114
    v_mfma_f32_16x16x32_bf16 v[132:135], v[204:207], v[96:99], v[132:135]
    v_mul_f32 v107, v107, v115
    v_mul_f32 v108, v108, v116
    v_mul_f32 v109, v109, v117
    v_mul_f32 v110, v110, v118
    v_mul_f32 v111, v111, v119
    v_mul_f32 v224, v224, v120
    v_mul_f32 v225, v225, v121
    v_mul_f32 v226, v226, v122
    v_mul_f32 v227, v227, v123
    v_mul_f32 v228, v228, v124
    v_mul_f32 v229, v229, v125
    v_mfma_f32_16x16x32_bf16 v[140:143], v[204:207], v[100:103], v[140:143]
    ds_read_b128 v[204:207], v50 offset:7168
    v_mul_f32 v230, v230, v126
    v_mul_f32 v231, v231, v127
    v_exp_f32 v104, -v104
    v_exp_f32 v105, -v105
    v_exp_f32 v106, -v106
    v_exp_f32 v107, -v107
    v_exp_f32 v108, -v108
    v_mfma_f32_16x16x32_bf16 v[144:147], v[208:211], v[96:99], v[144:147]
    v_exp_f32 v109, -v109
    v_exp_f32 v110, -v110
    v_exp_f32 v111, -v111
    v_exp_f32 v224, -v224
    v_exp_f32 v225, -v225
    v_exp_f32 v226, -v226
    v_mfma_f32_16x16x32_bf16 v[152:155], v[208:211], v[100:103], v[152:155]
    ds_read_b128 v[208:211], v50 offset:8192
    v_exp_f32 v227, -v227
    v_exp_f32 v228, -v228
    v_exp_f32 v229, -v229
    v_exp_f32 v230, -v230
    v_exp_f32 v231, -v231
    v_fma_f32 v104, v104, s30, s30
    v_mfma_f32_16x16x32_bf16 v[148:151], v[212:215], v[96:99], v[148:151]
    v_fma_f32 v105, v105, s30, s30
    v_fma_f32 v106, v106, s30, s30
    v_fma_f32 v107, v107, s30, s30
    v_fma_f32 v108, v108, s30, s30
    v_fma_f32 v109, v109, s30, s30
    v_fma_f32 v110, v110, s30, s30
    v_fma_f32 v111, v111, s30, s30
    v_fma_f32 v224, v224, s30, s30
    v_fma_f32 v225, v225, s30, s30
    v_fma_f32 v226, v226, s30, s30
    v_fma_f32 v227, v227, s30, s30
    v_fma_f32 v228, v228, s30, s30
    v_mfma_f32_16x16x32_bf16 v[156:159], v[212:215], v[100:103], v[156:159]
    ds_read_b128 v[212:215], v50 offset:9216
    v_fma_f32 v229, v229, s30, s30
    v_fma_f32 v230, v230, s30, s30
    v_fma_f32 v231, v231, s30, s30
    v_rcp_f32 v104, v104
    v_rcp_f32 v105, v105
    v_rcp_f32 v106, v106
    v_rcp_f32 v107, v107
    v_mfma_f32_16x16x32_bf16 v[160:163], v[216:219], v[96:99], v[160:163]
    v_rcp_f32 v108, v108
    v_rcp_f32 v109, v109
    v_rcp_f32 v110, v110
    v_rcp_f32 v111, v111
    v_rcp_f32 v224, v224
    v_rcp_f32 v225, v225
    v_mfma_f32_16x16x32_bf16 v[168:171], v[216:219], v[100:103], v[168:171]
    ds_read_b128 v[216:219], v50 offset:10240
    v_rcp_f32 v226, v226
    v_rcp_f32 v227, v227
    v_rcp_f32 v228, v228
    v_rcp_f32 v229, v229
    v_rcp_f32 v230, v230
    v_rcp_f32 v231, v231
    v_mfma_f32_16x16x32_bf16 v[164:167], v[220:223], v[96:99], v[164:167]
    v_mul_f32 v104, v104, v112
    v_mul_f32 v105, v105, v113
    v_mul_f32 v106, v106, v114
    v_mul_f32 v107, v107, v115
    v_mul_f32 v108, v108, v116
    v_mul_f32 v109, v109, v117
    v_mul_f32 v110, v110, v118
    v_mul_f32 v111, v111, v119
    v_mul_f32 v224, v224, v120
    v_mul_f32 v225, v225, v121
    v_mul_f32 v226, v226, v122
    v_mfma_f32_16x16x32_bf16 v[172:175], v[220:223], v[100:103], v[172:175]
    ds_read_b128 v[220:223], v50 offset:11264
    v_mul_f32 v227, v227, v123
    v_mul_f32 v228, v228, v124
    v_mul_f32 v229, v229, v125
    v_mul_f32 v230, v230, v126
    v_mul_f32 v231, v231, v127
    v_cvt_pk_bf16_f32 v88, v104, v105
    v_cvt_pk_bf16_f32 v89, v106, v107
    v_cvt_pk_bf16_f32 v90, v108, v109
    v_cvt_pk_bf16_f32 v91, v110, v111
    v_cvt_pk_bf16_f32 v92, v224, v225
    v_cvt_pk_bf16_f32 v93, v226, v227
    v_cvt_pk_bf16_f32 v94, v228, v229
    v_cvt_pk_bf16_f32 v95, v230, v231
    v_mfma_f32_16x16x32_bf16 v[112:115], v[176:179], v[64:67], 0
    v_mfma_f32_16x16x32_bf16 v[120:123], v[176:179], v[76:79], 0
    s_add_u32 m0, s34, 17856
    ds_read_b64_tr_b16 v[176:177], v49 offset:0
    ds_read_b64_tr_b16 v[178:179], v49 offset:256
    buffer_load_dwordx4 v54, s[36:39], 0 offen offset:576 lds
    v_mfma_f32_16x16x32_bf16 v[116:119], v[180:183], v[64:67], 0
    buffer_store_dwordx4 v[236:239], v55, s[8:11], s22 offen offset:1536 sc0 sc1 nt
    v_mfma_f32_16x16x32_bf16 v[124:127], v[180:183], v[76:79], 0
    ds_read_b64_tr_b16 v[180:181], v62 offset:0
    ds_read_b64_tr_b16 v[182:183], v62 offset:256
    v_mfma_f32_16x16x32_bf16 v[112:115], v[184:187], v[68:71], v[112:115]
    s_add_u32 m0, s40, 30784
    s_add_u32 s31, s16, 786432
    buffer_load_dwordx4 v52, s[4:7], s31 offen offset:0 nt lds
    v_mfma_f32_16x16x32_bf16 v[120:123], v[184:187], v[80:83], v[120:123]
    ds_read_b64_tr_b16 v[184:185], v49 offset:2048
    ds_read_b64_tr_b16 v[186:187], v49 offset:2304
    v_mfma_f32_16x16x32_bf16 v[116:119], v[188:191], v[68:71], v[116:119]
    v_mfma_f32_16x16x32_bf16 v[124:127], v[188:191], v[80:83], v[124:127]
    ds_read_b64_tr_b16 v[188:189], v62 offset:2048
    ds_read_b64_tr_b16 v[190:191], v62 offset:2304
    v_mfma_f32_16x16x32_bf16 v[112:115], v[192:195], v[72:75], v[112:115]
    v_mfma_f32_16x16x32_bf16 v[120:123], v[192:195], v[84:87], v[120:123]
    ds_read_b64_tr_b16 v[192:193], v49 offset:4096
    ds_read_b64_tr_b16 v[194:195], v49 offset:4352
    v_mfma_f32_16x16x32_bf16 v[116:119], v[196:199], v[72:75], v[116:119]
    v_mfma_f32_16x16x32_bf16 v[124:127], v[196:199], v[84:87], v[124:127]
    ds_read_b64_tr_b16 v[196:197], v62 offset:4096
    ds_read_b64_tr_b16 v[198:199], v62 offset:4352
    s_waitcnt lgkmcnt(0)
    v_mfma_f32_16x16x32_bf16 v[128:131], v[200:203], v[88:91], v[128:131]
    s_setprio 3
    v_fma_f32 v104, v112, v112, s20
    v_fma_f32 v105, v113, v113, s20
    v_fma_f32 v106, v114, v114, s20
    v_fma_f32 v107, v115, v115, s20
    v_fma_f32 v108, v116, v116, s20
    v_fma_f32 v109, v117, v117, s20
    v_fma_f32 v110, v118, v118, s20
    v_mfma_f32_16x16x32_bf16 v[136:139], v[200:203], v[92:95], v[136:139]
    ds_read_b128 v[200:203], v50 offset:43008
    v_fma_f32 v111, v119, v119, s20
    v_fma_f32 v224, v120, v120, s20
    v_fma_f32 v225, v121, v121, s20
    v_fma_f32 v226, v122, v122, s20
    v_fma_f32 v227, v123, v123, s20
    v_fma_f32 v228, v124, v124, s20
    v_fma_f32 v229, v125, v125, s20
    v_fma_f32 v230, v126, v126, s20
    v_fma_f32 v231, v127, v127, s20
    v_mul_f32 v104, v104, v112
    v_mul_f32 v105, v105, v113
    v_mul_f32 v106, v106, v114
    v_mfma_f32_16x16x32_bf16 v[132:135], v[204:207], v[88:91], v[132:135]
    v_mul_f32 v107, v107, v115
    v_mul_f32 v108, v108, v116
    v_mul_f32 v109, v109, v117
    v_mul_f32 v110, v110, v118
    v_mul_f32 v111, v111, v119
    v_mul_f32 v224, v224, v120
    v_mul_f32 v225, v225, v121
    v_mul_f32 v226, v226, v122
    v_mul_f32 v227, v227, v123
    v_mul_f32 v228, v228, v124
    v_mul_f32 v229, v229, v125
    v_mfma_f32_16x16x32_bf16 v[140:143], v[204:207], v[92:95], v[140:143]
    ds_read_b128 v[204:207], v50 offset:44032
    v_mul_f32 v230, v230, v126
    v_mul_f32 v231, v231, v127
    v_exp_f32 v104, -v104
    v_exp_f32 v105, -v105
    v_exp_f32 v106, -v106
    v_exp_f32 v107, -v107
    v_exp_f32 v108, -v108
    v_mfma_f32_16x16x32_bf16 v[144:147], v[208:211], v[88:91], v[144:147]
    v_exp_f32 v109, -v109
    v_exp_f32 v110, -v110
    v_exp_f32 v111, -v111
    v_exp_f32 v224, -v224
    v_exp_f32 v225, -v225
    v_exp_f32 v226, -v226
    v_mfma_f32_16x16x32_bf16 v[152:155], v[208:211], v[92:95], v[152:155]
    ds_read_b128 v[208:211], v50 offset:45056
    v_exp_f32 v227, -v227
    v_exp_f32 v228, -v228
    v_exp_f32 v229, -v229
    v_exp_f32 v230, -v230
    v_exp_f32 v231, -v231
    v_fma_f32 v104, v104, s30, s30
    v_mfma_f32_16x16x32_bf16 v[148:151], v[212:215], v[88:91], v[148:151]
    v_fma_f32 v105, v105, s30, s30
    v_fma_f32 v106, v106, s30, s30
    v_fma_f32 v107, v107, s30, s30
    v_fma_f32 v108, v108, s30, s30
    v_fma_f32 v109, v109, s30, s30
    v_fma_f32 v110, v110, s30, s30
    v_fma_f32 v111, v111, s30, s30
    v_fma_f32 v224, v224, s30, s30
    v_fma_f32 v225, v225, s30, s30
    v_fma_f32 v226, v226, s30, s30
    v_fma_f32 v227, v227, s30, s30
    v_fma_f32 v228, v228, s30, s30
    v_mfma_f32_16x16x32_bf16 v[156:159], v[212:215], v[92:95], v[156:159]
    ds_read_b128 v[212:215], v50 offset:46080
    v_fma_f32 v229, v229, s30, s30
    v_fma_f32 v230, v230, s30, s30
    v_fma_f32 v231, v231, s30, s30
    v_rcp_f32 v104, v104
    v_rcp_f32 v105, v105
    v_rcp_f32 v106, v106
    v_rcp_f32 v107, v107
    v_mfma_f32_16x16x32_bf16 v[160:163], v[216:219], v[88:91], v[160:163]
    v_rcp_f32 v108, v108
    v_rcp_f32 v109, v109
    v_rcp_f32 v110, v110
    v_rcp_f32 v111, v111
    v_rcp_f32 v224, v224
    v_rcp_f32 v225, v225
    v_mfma_f32_16x16x32_bf16 v[168:171], v[216:219], v[92:95], v[168:171]
    ds_read_b128 v[216:219], v50 offset:47104
    v_rcp_f32 v226, v226
    v_rcp_f32 v227, v227
    v_rcp_f32 v228, v228
    v_rcp_f32 v229, v229
    v_rcp_f32 v230, v230
    v_rcp_f32 v231, v231
    v_mfma_f32_16x16x32_bf16 v[164:167], v[220:223], v[88:91], v[164:167]
    v_mul_f32 v104, v104, v112
    v_mul_f32 v105, v105, v113
    v_mul_f32 v106, v106, v114
    v_mul_f32 v107, v107, v115
    v_mul_f32 v108, v108, v116
    v_mul_f32 v109, v109, v117
    v_mul_f32 v110, v110, v118
    v_mul_f32 v111, v111, v119
    v_mul_f32 v224, v224, v120
    v_mul_f32 v225, v225, v121
    v_mul_f32 v226, v226, v122
    v_mfma_f32_16x16x32_bf16 v[172:175], v[220:223], v[92:95], v[172:175]
    ds_read_b128 v[220:223], v50 offset:48128
    v_mul_f32 v227, v227, v123
    v_mul_f32 v228, v228, v124
    v_mul_f32 v229, v229, v125
    v_mul_f32 v230, v230, v126
    v_mul_f32 v231, v231, v127
    v_cvt_pk_bf16_f32 v96, v104, v105
    v_cvt_pk_bf16_f32 v97, v106, v107
    v_cvt_pk_bf16_f32 v98, v108, v109
    v_cvt_pk_bf16_f32 v99, v110, v111
    v_cvt_pk_bf16_f32 v100, v224, v225
    v_cvt_pk_bf16_f32 v101, v226, v227
    v_cvt_pk_bf16_f32 v102, v228, v229
    v_cvt_pk_bf16_f32 v103, v230, v231
    v_mfma_f32_16x16x32_bf16 v[112:115], v[176:179], v[64:67], 0
    v_mfma_f32_16x16x32_bf16 v[120:123], v[176:179], v[76:79], 0
    ds_read_b64_tr_b16 v[176:177], v49 offset:6144
    ds_read_b64_tr_b16 v[178:179], v49 offset:6400
    v_mfma_f32_16x16x32_bf16 v[116:119], v[180:183], v[64:67], 0
    v_mfma_f32_16x16x32_bf16 v[124:127], v[180:183], v[76:79], 0
    ds_read_b64_tr_b16 v[180:181], v62 offset:6144
    ds_read_b64_tr_b16 v[182:183], v62 offset:6400
    v_mfma_f32_16x16x32_bf16 v[112:115], v[184:187], v[68:71], v[112:115]
    v_mfma_f32_16x16x32_bf16 v[120:123], v[184:187], v[80:83], v[120:123]
    s_add_u32 m0, s41, 30784
    ds_read_b64_tr_b16 v[184:185], v49 offset:8192
    ds_read_b64_tr_b16 v[186:187], v49 offset:8448
    buffer_load_dwordx4 v53, s[4:7], s31 offen offset:0 nt lds
    v_mfma_f32_16x16x32_bf16 v[116:119], v[188:191], v[68:71], v[116:119]
    v_mfma_f32_16x16x32_bf16 v[124:127], v[188:191], v[80:83], v[124:127]
    ds_read_b64_tr_b16 v[188:189], v62 offset:8192
    ds_read_b64_tr_b16 v[190:191], v62 offset:8448
    v_mfma_f32_16x16x32_bf16 v[112:115], v[192:195], v[72:75], v[112:115]
    v_mfma_f32_16x16x32_bf16 v[120:123], v[192:195], v[84:87], v[120:123]
    ds_read_b64_tr_b16 v[192:193], v49 offset:10240
    ds_read_b64_tr_b16 v[194:195], v49 offset:10496
    v_mfma_f32_16x16x32_bf16 v[116:119], v[196:199], v[72:75], v[116:119]
    v_mfma_f32_16x16x32_bf16 v[124:127], v[196:199], v[84:87], v[124:127]
    ds_read_b64_tr_b16 v[196:197], v62 offset:10240
    ds_read_b64_tr_b16 v[198:199], v62 offset:10496
    s_waitcnt vmcnt(3) lgkmcnt(0)
    s_barrier
    v_mfma_f32_16x16x32_bf16 v[128:131], v[200:203], v[96:99], v[128:131]
    s_sub_u32 m0, s34, 6144
    s_movk_i32 s79, 18432
    buffer_load_dwordx4 v51, s[44:47], s79 offen offset:0 lds
    s_add_u32 m0, s34, -256
    s_setprio 0
    buffer_load_dwordx4 v54, s[36:39], 0 offen offset:256 lds
    v_fma_f32 v104, v112, v112, s20
    v_fma_f32 v105, v113, v113, s20
    v_fma_f32 v106, v114, v114, s20
    v_fma_f32 v107, v115, v115, s20
    v_fma_f32 v108, v116, v116, s20
    v_fma_f32 v109, v117, v117, s20
    v_fma_f32 v110, v118, v118, s20
    v_mfma_f32_16x16x32_bf16 v[136:139], v[200:203], v[100:103], v[136:139]
    ds_read_b128 v[200:203], v50 offset:12288
    v_fma_f32 v111, v119, v119, s20
    v_fma_f32 v224, v120, v120, s20
    v_fma_f32 v225, v121, v121, s20
    v_fma_f32 v226, v122, v122, s20
    v_fma_f32 v227, v123, v123, s20
    v_fma_f32 v228, v124, v124, s20
    v_fma_f32 v229, v125, v125, s20
    v_fma_f32 v230, v126, v126, s20
    v_fma_f32 v231, v127, v127, s20
    v_mul_f32 v104, v104, v112
    v_mul_f32 v105, v105, v113
    v_mul_f32 v106, v106, v114
    v_mfma_f32_16x16x32_bf16 v[132:135], v[204:207], v[96:99], v[132:135]
    v_mul_f32 v107, v107, v115
    v_mul_f32 v108, v108, v116
    v_mul_f32 v109, v109, v117
    v_mul_f32 v110, v110, v118
    v_mul_f32 v111, v111, v119
    v_mul_f32 v224, v224, v120
    v_mul_f32 v225, v225, v121
    v_mul_f32 v226, v226, v122
    v_mul_f32 v227, v227, v123
    v_mul_f32 v228, v228, v124
    v_mul_f32 v229, v229, v125
    v_mfma_f32_16x16x32_bf16 v[140:143], v[204:207], v[100:103], v[140:143]
    ds_read_b128 v[204:207], v50 offset:13312
    v_mul_f32 v230, v230, v126
    v_mul_f32 v231, v231, v127
    v_exp_f32 v104, -v104
    v_exp_f32 v105, -v105
    v_exp_f32 v106, -v106
    v_exp_f32 v107, -v107
    v_exp_f32 v108, -v108
    v_mfma_f32_16x16x32_bf16 v[144:147], v[208:211], v[96:99], v[144:147]
    v_exp_f32 v109, -v109
    v_exp_f32 v110, -v110
    v_exp_f32 v111, -v111
    v_exp_f32 v224, -v224
    v_exp_f32 v225, -v225
    v_exp_f32 v226, -v226
    v_mfma_f32_16x16x32_bf16 v[152:155], v[208:211], v[100:103], v[152:155]
    ds_read_b128 v[208:211], v50 offset:14336
    v_exp_f32 v227, -v227
    v_exp_f32 v228, -v228
    v_exp_f32 v229, -v229
    v_exp_f32 v230, -v230
    v_exp_f32 v231, -v231
    v_fma_f32 v104, v104, s30, s30
    v_mfma_f32_16x16x32_bf16 v[148:151], v[212:215], v[96:99], v[148:151]
    v_fma_f32 v105, v105, s30, s30
    v_fma_f32 v106, v106, s30, s30
    v_fma_f32 v107, v107, s30, s30
    v_fma_f32 v108, v108, s30, s30
    v_fma_f32 v109, v109, s30, s30
    v_fma_f32 v110, v110, s30, s30
    v_fma_f32 v111, v111, s30, s30
    v_fma_f32 v224, v224, s30, s30
    v_fma_f32 v225, v225, s30, s30
    v_fma_f32 v226, v226, s30, s30
    v_fma_f32 v227, v227, s30, s30
    v_fma_f32 v228, v228, s30, s30
    v_mfma_f32_16x16x32_bf16 v[156:159], v[212:215], v[100:103], v[156:159]
    ds_read_b128 v[212:215], v50 offset:15360
    v_fma_f32 v229, v229, s30, s30
    v_fma_f32 v230, v230, s30, s30
    v_fma_f32 v231, v231, s30, s30
    v_rcp_f32 v104, v104
    v_rcp_f32 v105, v105
    v_rcp_f32 v106, v106
    v_rcp_f32 v107, v107
    v_mfma_f32_16x16x32_bf16 v[160:163], v[216:219], v[96:99], v[160:163]
    v_rcp_f32 v108, v108
    v_rcp_f32 v109, v109
    v_rcp_f32 v110, v110
    v_rcp_f32 v111, v111
    v_rcp_f32 v224, v224
    v_rcp_f32 v225, v225
    v_mfma_f32_16x16x32_bf16 v[168:171], v[216:219], v[100:103], v[168:171]
    ds_read_b128 v[216:219], v50 offset:16384
    v_rcp_f32 v226, v226
    v_rcp_f32 v227, v227
    v_rcp_f32 v228, v228
    v_rcp_f32 v229, v229
    v_rcp_f32 v230, v230
    v_rcp_f32 v231, v231
    v_mfma_f32_16x16x32_bf16 v[164:167], v[220:223], v[96:99], v[164:167]
    v_mul_f32 v104, v104, v112
    v_mul_f32 v105, v105, v113
    v_mul_f32 v106, v106, v114
    v_mul_f32 v107, v107, v115
    v_mul_f32 v108, v108, v116
    v_mul_f32 v109, v109, v117
    v_mul_f32 v110, v110, v118
    v_mul_f32 v111, v111, v119
    v_mul_f32 v224, v224, v120
    v_mul_f32 v225, v225, v121
    v_mul_f32 v226, v226, v122
    v_mfma_f32_16x16x32_bf16 v[172:175], v[220:223], v[100:103], v[172:175]
    ds_read_b128 v[220:223], v50 offset:17408
    v_mul_f32 v227, v227, v123
    v_mul_f32 v228, v228, v124
    v_mul_f32 v229, v229, v125
    v_mul_f32 v230, v230, v126
    v_mul_f32 v231, v231, v127
    v_cvt_pk_bf16_f32 v88, v104, v105
    v_cvt_pk_bf16_f32 v89, v106, v107
    v_cvt_pk_bf16_f32 v90, v108, v109
    v_cvt_pk_bf16_f32 v91, v110, v111
    v_cvt_pk_bf16_f32 v92, v224, v225
    v_cvt_pk_bf16_f32 v93, v226, v227
    v_cvt_pk_bf16_f32 v94, v228, v229
    v_cvt_pk_bf16_f32 v95, v230, v231
    v_mfma_f32_16x16x32_bf16 v[112:115], v[176:179], v[64:67], 0
    v_mfma_f32_16x16x32_bf16 v[120:123], v[176:179], v[76:79], 0
    s_add_u32 m0, s34, 5504
    ds_read_b64_tr_b16 v[176:177], v49 offset:12288
    ds_read_b64_tr_b16 v[178:179], v49 offset:12544
    buffer_load_dwordx4 v54, s[36:39], 0 offen offset:640 lds
    v_mfma_f32_16x16x32_bf16 v[116:119], v[180:183], v[64:67], 0
    buffer_store_dwordx4 v[240:243], v55, s[8:11], s22 offen offset:64 sc0 sc1 nt
    v_mfma_f32_16x16x32_bf16 v[124:127], v[180:183], v[76:79], 0
    ds_read_b64_tr_b16 v[180:181], v62 offset:12288
    ds_read_b64_tr_b16 v[182:183], v62 offset:12544
    v_mfma_f32_16x16x32_bf16 v[112:115], v[184:187], v[68:71], v[112:115]
    s_add_u32 m0, s40, 46152
    s_add_u32 s31, s16, 1179648
    buffer_load_dwordx4 v52, s[4:7], s31 offen offset:0 nt lds
    v_mfma_f32_16x16x32_bf16 v[120:123], v[184:187], v[80:83], v[120:123]
    ds_read_b64_tr_b16 v[184:185], v49 offset:14336
    ds_read_b64_tr_b16 v[186:187], v49 offset:14592
    v_mfma_f32_16x16x32_bf16 v[116:119], v[188:191], v[68:71], v[116:119]
    v_mfma_f32_16x16x32_bf16 v[124:127], v[188:191], v[80:83], v[124:127]
    ds_read_b64_tr_b16 v[188:189], v62 offset:14336
    ds_read_b64_tr_b16 v[190:191], v62 offset:14592
    v_mfma_f32_16x16x32_bf16 v[112:115], v[192:195], v[72:75], v[112:115]
    v_mfma_f32_16x16x32_bf16 v[120:123], v[192:195], v[84:87], v[120:123]
    ds_read_b64_tr_b16 v[192:193], v49 offset:16384
    ds_read_b64_tr_b16 v[194:195], v49 offset:16640
    v_mfma_f32_16x16x32_bf16 v[116:119], v[196:199], v[72:75], v[116:119]
    v_mfma_f32_16x16x32_bf16 v[124:127], v[196:199], v[84:87], v[124:127]
    ds_read_b64_tr_b16 v[196:197], v62 offset:16384
    ds_read_b64_tr_b16 v[198:199], v62 offset:16640
    s_waitcnt lgkmcnt(0)
    v_mfma_f32_16x16x32_bf16 v[128:131], v[200:203], v[88:91], v[128:131]
    s_setprio 3
    v_fma_f32 v104, v112, v112, s20
    v_fma_f32 v105, v113, v113, s20
    v_fma_f32 v106, v114, v114, s20
    v_fma_f32 v107, v115, v115, s20
    v_fma_f32 v108, v116, v116, s20
    v_fma_f32 v109, v117, v117, s20
    v_fma_f32 v110, v118, v118, s20
    v_mfma_f32_16x16x32_bf16 v[136:139], v[200:203], v[92:95], v[136:139]
    ds_read_b128 v[200:203], v50 offset:36864
    v_fma_f32 v111, v119, v119, s20
    v_fma_f32 v224, v120, v120, s20
    v_fma_f32 v225, v121, v121, s20
    v_fma_f32 v226, v122, v122, s20
    v_fma_f32 v227, v123, v123, s20
    v_fma_f32 v228, v124, v124, s20
    v_fma_f32 v229, v125, v125, s20
    v_fma_f32 v230, v126, v126, s20
    v_fma_f32 v231, v127, v127, s20
    v_mul_f32 v104, v104, v112
    v_mul_f32 v105, v105, v113
    v_mul_f32 v106, v106, v114
    v_mfma_f32_16x16x32_bf16 v[132:135], v[204:207], v[88:91], v[132:135]
    v_mul_f32 v107, v107, v115
    v_mul_f32 v108, v108, v116
    v_mul_f32 v109, v109, v117
    v_mul_f32 v110, v110, v118
    v_mul_f32 v111, v111, v119
    v_mul_f32 v224, v224, v120
    v_mul_f32 v225, v225, v121
    v_mul_f32 v226, v226, v122
    v_mul_f32 v227, v227, v123
    v_mul_f32 v228, v228, v124
    v_mul_f32 v229, v229, v125
    v_mfma_f32_16x16x32_bf16 v[140:143], v[204:207], v[92:95], v[140:143]
    ds_read_b128 v[204:207], v50 offset:37888
    v_mul_f32 v230, v230, v126
    v_mul_f32 v231, v231, v127
    v_exp_f32 v104, -v104
    v_exp_f32 v105, -v105
    v_exp_f32 v106, -v106
    v_exp_f32 v107, -v107
    v_exp_f32 v108, -v108
    v_mfma_f32_16x16x32_bf16 v[144:147], v[208:211], v[88:91], v[144:147]
    v_exp_f32 v109, -v109
    v_exp_f32 v110, -v110
    v_exp_f32 v111, -v111
    v_exp_f32 v224, -v224
    v_exp_f32 v225, -v225
    v_exp_f32 v226, -v226
    v_mfma_f32_16x16x32_bf16 v[152:155], v[208:211], v[92:95], v[152:155]
    ds_read_b128 v[208:211], v50 offset:38912
    v_exp_f32 v227, -v227
    v_exp_f32 v228, -v228
    v_exp_f32 v229, -v229
    v_exp_f32 v230, -v230
    v_exp_f32 v231, -v231
    v_fma_f32 v104, v104, s30, s30
    v_mfma_f32_16x16x32_bf16 v[148:151], v[212:215], v[88:91], v[148:151]
    v_fma_f32 v105, v105, s30, s30
    v_fma_f32 v106, v106, s30, s30
    v_fma_f32 v107, v107, s30, s30
    v_fma_f32 v108, v108, s30, s30
    v_fma_f32 v109, v109, s30, s30
    v_fma_f32 v110, v110, s30, s30
    v_fma_f32 v111, v111, s30, s30
    v_fma_f32 v224, v224, s30, s30
    v_fma_f32 v225, v225, s30, s30
    v_fma_f32 v226, v226, s30, s30
    v_fma_f32 v227, v227, s30, s30
    v_fma_f32 v228, v228, s30, s30
    v_mfma_f32_16x16x32_bf16 v[156:159], v[212:215], v[92:95], v[156:159]
    ds_read_b128 v[212:215], v50 offset:39936
    v_fma_f32 v229, v229, s30, s30
    v_fma_f32 v230, v230, s30, s30
    v_fma_f32 v231, v231, s30, s30
    v_rcp_f32 v104, v104
    v_rcp_f32 v105, v105
    v_rcp_f32 v106, v106
    v_rcp_f32 v107, v107
    v_mfma_f32_16x16x32_bf16 v[160:163], v[216:219], v[88:91], v[160:163]
    v_rcp_f32 v108, v108
    v_rcp_f32 v109, v109
    v_rcp_f32 v110, v110
    v_rcp_f32 v111, v111
    v_rcp_f32 v224, v224
    v_rcp_f32 v225, v225
    v_mfma_f32_16x16x32_bf16 v[168:171], v[216:219], v[92:95], v[168:171]
    ds_read_b128 v[216:219], v50 offset:40960
    v_rcp_f32 v226, v226
    v_rcp_f32 v227, v227
    v_rcp_f32 v228, v228
    v_rcp_f32 v229, v229
    v_rcp_f32 v230, v230
    v_rcp_f32 v231, v231
    v_mfma_f32_16x16x32_bf16 v[164:167], v[220:223], v[88:91], v[164:167]
    v_mul_f32 v104, v104, v112
    v_mul_f32 v105, v105, v113
    v_mul_f32 v106, v106, v114
    v_mul_f32 v107, v107, v115
    v_mul_f32 v108, v108, v116
    v_mul_f32 v109, v109, v117
    v_mul_f32 v110, v110, v118
    v_mul_f32 v111, v111, v119
    v_mul_f32 v224, v224, v120
    v_mul_f32 v225, v225, v121
    v_mul_f32 v226, v226, v122
    v_mfma_f32_16x16x32_bf16 v[172:175], v[220:223], v[92:95], v[172:175]
    ds_read_b128 v[220:223], v50 offset:41984
    v_mul_f32 v227, v227, v123
    v_mul_f32 v228, v228, v124
    v_mul_f32 v229, v229, v125
    v_mul_f32 v230, v230, v126
    v_mul_f32 v231, v231, v127
    v_cvt_pk_bf16_f32 v96, v104, v105
    v_cvt_pk_bf16_f32 v97, v106, v107
    v_cvt_pk_bf16_f32 v98, v108, v109
    v_cvt_pk_bf16_f32 v99, v110, v111
    v_cvt_pk_bf16_f32 v100, v224, v225
    v_cvt_pk_bf16_f32 v101, v226, v227
    v_cvt_pk_bf16_f32 v102, v228, v229
    v_cvt_pk_bf16_f32 v103, v230, v231
    v_mfma_f32_16x16x32_bf16 v[112:115], v[176:179], v[64:67], 0
    v_mfma_f32_16x16x32_bf16 v[120:123], v[176:179], v[76:79], 0
    ds_read_b64_tr_b16 v[176:177], v49 offset:18432
    ds_read_b64_tr_b16 v[178:179], v49 offset:18688
    v_mfma_f32_16x16x32_bf16 v[116:119], v[180:183], v[64:67], 0
    v_mfma_f32_16x16x32_bf16 v[124:127], v[180:183], v[76:79], 0
    ds_read_b64_tr_b16 v[180:181], v62 offset:18432
    ds_read_b64_tr_b16 v[182:183], v62 offset:18688
    v_mfma_f32_16x16x32_bf16 v[112:115], v[184:187], v[68:71], v[112:115]
    v_mfma_f32_16x16x32_bf16 v[120:123], v[184:187], v[80:83], v[120:123]
    s_add_u32 m0, s41, 46152
    ds_read_b64_tr_b16 v[184:185], v49 offset:20480
    ds_read_b64_tr_b16 v[186:187], v49 offset:20736
    buffer_load_dwordx4 v53, s[4:7], s31 offen offset:0 nt lds
    v_mfma_f32_16x16x32_bf16 v[116:119], v[188:191], v[68:71], v[116:119]
    v_mfma_f32_16x16x32_bf16 v[124:127], v[188:191], v[80:83], v[124:127]
    ds_read_b64_tr_b16 v[188:189], v62 offset:20480
    ds_read_b64_tr_b16 v[190:191], v62 offset:20736
    v_mfma_f32_16x16x32_bf16 v[112:115], v[192:195], v[72:75], v[112:115]
    v_mfma_f32_16x16x32_bf16 v[120:123], v[192:195], v[84:87], v[120:123]
    ds_read_b64_tr_b16 v[192:193], v49 offset:22528
    ds_read_b64_tr_b16 v[194:195], v49 offset:22784
    v_mfma_f32_16x16x32_bf16 v[116:119], v[196:199], v[72:75], v[116:119]
    v_mfma_f32_16x16x32_bf16 v[124:127], v[196:199], v[84:87], v[124:127]
    ds_read_b64_tr_b16 v[196:197], v62 offset:22528
    ds_read_b64_tr_b16 v[198:199], v62 offset:22784
    s_waitcnt vmcnt(3) lgkmcnt(0)
    s_barrier
    v_mfma_f32_16x16x32_bf16 v[128:131], v[200:203], v[96:99], v[128:131]
    s_sub_u32 m0, s34, 12288
    s_movk_i32 s79, 24576
    buffer_load_dwordx4 v51, s[44:47], s79 offen offset:0 lds
    s_add_u32 m0, s34, 11968
    s_setprio 0
    buffer_load_dwordx4 v54, s[36:39], 0 offen offset:320 lds
    v_fma_f32 v104, v112, v112, s20
    v_fma_f32 v105, v113, v113, s20
    v_fma_f32 v106, v114, v114, s20
    v_fma_f32 v107, v115, v115, s20
    v_fma_f32 v108, v116, v116, s20
    v_fma_f32 v109, v117, v117, s20
    v_fma_f32 v110, v118, v118, s20
    v_mfma_f32_16x16x32_bf16 v[136:139], v[200:203], v[100:103], v[136:139]
    ds_read_b128 v[200:203], v50 offset:18432
    v_fma_f32 v111, v119, v119, s20
    v_fma_f32 v224, v120, v120, s20
    v_fma_f32 v225, v121, v121, s20
    v_fma_f32 v226, v122, v122, s20
    v_fma_f32 v227, v123, v123, s20
    v_fma_f32 v228, v124, v124, s20
    v_fma_f32 v229, v125, v125, s20
    v_fma_f32 v230, v126, v126, s20
    v_fma_f32 v231, v127, v127, s20
    v_mul_f32 v104, v104, v112
    v_mul_f32 v105, v105, v113
    v_mul_f32 v106, v106, v114
    v_mfma_f32_16x16x32_bf16 v[132:135], v[204:207], v[96:99], v[132:135]
    v_mul_f32 v107, v107, v115
    v_mul_f32 v108, v108, v116
    v_mul_f32 v109, v109, v117
    v_mul_f32 v110, v110, v118
    v_mul_f32 v111, v111, v119
    v_mul_f32 v224, v224, v120
    v_mul_f32 v225, v225, v121
    v_mul_f32 v226, v226, v122
    v_mul_f32 v227, v227, v123
    v_mul_f32 v228, v228, v124
    v_mul_f32 v229, v229, v125
    v_mfma_f32_16x16x32_bf16 v[140:143], v[204:207], v[100:103], v[140:143]
    ds_read_b128 v[204:207], v50 offset:19456
    v_mul_f32 v230, v230, v126
    v_mul_f32 v231, v231, v127
    v_exp_f32 v104, -v104
    v_exp_f32 v105, -v105
    v_exp_f32 v106, -v106
    v_exp_f32 v107, -v107
    v_exp_f32 v108, -v108
    v_mfma_f32_16x16x32_bf16 v[144:147], v[208:211], v[96:99], v[144:147]
    v_exp_f32 v109, -v109
    v_exp_f32 v110, -v110
    v_exp_f32 v111, -v111
    v_exp_f32 v224, -v224
    v_exp_f32 v225, -v225
    v_exp_f32 v226, -v226
    v_mfma_f32_16x16x32_bf16 v[152:155], v[208:211], v[100:103], v[152:155]
    ds_read_b128 v[208:211], v50 offset:20480
    v_exp_f32 v227, -v227
    v_exp_f32 v228, -v228
    v_exp_f32 v229, -v229
    v_exp_f32 v230, -v230
    v_exp_f32 v231, -v231
    v_fma_f32 v104, v104, s30, s30
    v_mfma_f32_16x16x32_bf16 v[148:151], v[212:215], v[96:99], v[148:151]
    v_fma_f32 v105, v105, s30, s30
    v_fma_f32 v106, v106, s30, s30
    v_fma_f32 v107, v107, s30, s30
    v_fma_f32 v108, v108, s30, s30
    v_fma_f32 v109, v109, s30, s30
    v_fma_f32 v110, v110, s30, s30
    v_fma_f32 v111, v111, s30, s30
    v_fma_f32 v224, v224, s30, s30
    v_fma_f32 v225, v225, s30, s30
    v_fma_f32 v226, v226, s30, s30
    v_fma_f32 v227, v227, s30, s30
    v_fma_f32 v228, v228, s30, s30
    v_mfma_f32_16x16x32_bf16 v[156:159], v[212:215], v[100:103], v[156:159]
    ds_read_b128 v[212:215], v50 offset:21504
    v_fma_f32 v229, v229, s30, s30
    v_fma_f32 v230, v230, s30, s30
    v_fma_f32 v231, v231, s30, s30
    v_rcp_f32 v104, v104
    v_rcp_f32 v105, v105
    v_rcp_f32 v106, v106
    v_rcp_f32 v107, v107
    v_mfma_f32_16x16x32_bf16 v[160:163], v[216:219], v[96:99], v[160:163]
    v_rcp_f32 v108, v108
    v_rcp_f32 v109, v109
    v_rcp_f32 v110, v110
    v_rcp_f32 v111, v111
    v_rcp_f32 v224, v224
    v_rcp_f32 v225, v225
    v_mfma_f32_16x16x32_bf16 v[168:171], v[216:219], v[100:103], v[168:171]
    ds_read_b128 v[216:219], v50 offset:22528
    v_rcp_f32 v226, v226
    v_rcp_f32 v227, v227
    v_rcp_f32 v228, v228
    v_rcp_f32 v229, v229
    v_rcp_f32 v230, v230
    v_rcp_f32 v231, v231
    v_mfma_f32_16x16x32_bf16 v[164:167], v[220:223], v[96:99], v[164:167]
    v_mul_f32 v104, v104, v112
    v_mul_f32 v105, v105, v113
    v_mul_f32 v106, v106, v114
    v_mul_f32 v107, v107, v115
    v_mul_f32 v108, v108, v116
    v_mul_f32 v109, v109, v117
    v_mul_f32 v110, v110, v118
    v_mul_f32 v111, v111, v119
    v_mul_f32 v224, v224, v120
    v_mul_f32 v225, v225, v121
    v_mul_f32 v226, v226, v122
    v_mfma_f32_16x16x32_bf16 v[172:175], v[220:223], v[100:103], v[172:175]
    ds_read_b128 v[220:223], v50 offset:23552
    v_mul_f32 v227, v227, v123
    v_mul_f32 v228, v228, v124
    v_mul_f32 v229, v229, v125
    v_mul_f32 v230, v230, v126
    v_mul_f32 v231, v231, v127
    v_cvt_pk_bf16_f32 v88, v104, v105
    v_cvt_pk_bf16_f32 v89, v106, v107
    v_cvt_pk_bf16_f32 v90, v108, v109
    v_cvt_pk_bf16_f32 v91, v110, v111
    v_cvt_pk_bf16_f32 v92, v224, v225
    v_cvt_pk_bf16_f32 v93, v226, v227
    v_cvt_pk_bf16_f32 v94, v228, v229
    v_cvt_pk_bf16_f32 v95, v230, v231
    v_mfma_f32_16x16x32_bf16 v[112:115], v[176:179], v[64:67], 0
    v_mfma_f32_16x16x32_bf16 v[120:123], v[176:179], v[76:79], 0
    s_add_u32 m0, s34, 17728
    ds_read_b64_tr_b16 v[176:177], v49 offset:0
    ds_read_b64_tr_b16 v[178:179], v49 offset:256
    buffer_load_dwordx4 v54, s[36:39], 0 offen offset:704 lds
    v_mfma_f32_16x16x32_bf16 v[116:119], v[180:183], v[64:67], 0
    buffer_store_dwordx4 v[244:247], v55, s[8:11], s22 offen offset:1600 sc0 sc1 nt
    v_mfma_f32_16x16x32_bf16 v[124:127], v[180:183], v[76:79], 0
    ds_read_b64_tr_b16 v[180:181], v62 offset:0
    ds_read_b64_tr_b16 v[182:183], v62 offset:256
    v_mfma_f32_16x16x32_bf16 v[112:115], v[184:187], v[68:71], v[112:115]
    s_add_u32 m0, s40, 61696
    s_add_u32 s31, s16, 1572864
    buffer_load_dwordx4 v52, s[4:7], s31 offen offset:0 nt lds
    v_mfma_f32_16x16x32_bf16 v[120:123], v[184:187], v[80:83], v[120:123]
    ds_read_b64_tr_b16 v[184:185], v49 offset:2048
    ds_read_b64_tr_b16 v[186:187], v49 offset:2304
    v_mfma_f32_16x16x32_bf16 v[116:119], v[188:191], v[68:71], v[116:119]
    v_mfma_f32_16x16x32_bf16 v[124:127], v[188:191], v[80:83], v[124:127]
    ds_read_b64_tr_b16 v[188:189], v62 offset:2048
    ds_read_b64_tr_b16 v[190:191], v62 offset:2304
    v_mfma_f32_16x16x32_bf16 v[112:115], v[192:195], v[72:75], v[112:115]
    v_mfma_f32_16x16x32_bf16 v[120:123], v[192:195], v[84:87], v[120:123]
    ds_read_b64_tr_b16 v[192:193], v49 offset:4096
    ds_read_b64_tr_b16 v[194:195], v49 offset:4352
    v_mfma_f32_16x16x32_bf16 v[116:119], v[196:199], v[72:75], v[116:119]
    v_mfma_f32_16x16x32_bf16 v[124:127], v[196:199], v[84:87], v[124:127]
    ds_read_b64_tr_b16 v[196:197], v62 offset:4096
    ds_read_b64_tr_b16 v[198:199], v62 offset:4352
    s_waitcnt lgkmcnt(0)
    v_mfma_f32_16x16x32_bf16 v[128:131], v[200:203], v[88:91], v[128:131]
    s_setprio 3
    v_fma_f32 v104, v112, v112, s20
    v_fma_f32 v105, v113, v113, s20
    v_fma_f32 v106, v114, v114, s20
    v_fma_f32 v107, v115, v115, s20
    v_fma_f32 v108, v116, v116, s20
    v_fma_f32 v109, v117, v117, s20
    v_fma_f32 v110, v118, v118, s20
    v_mfma_f32_16x16x32_bf16 v[136:139], v[200:203], v[92:95], v[136:139]
    ds_read_b128 v[200:203], v50 offset:43008
    v_fma_f32 v111, v119, v119, s20
    v_fma_f32 v224, v120, v120, s20
    v_fma_f32 v225, v121, v121, s20
    v_fma_f32 v226, v122, v122, s20
    v_fma_f32 v227, v123, v123, s20
    v_fma_f32 v228, v124, v124, s20
    v_fma_f32 v229, v125, v125, s20
    v_fma_f32 v230, v126, v126, s20
    v_fma_f32 v231, v127, v127, s20
    v_mul_f32 v104, v104, v112
    v_mul_f32 v105, v105, v113
    v_mul_f32 v106, v106, v114
    v_mfma_f32_16x16x32_bf16 v[132:135], v[204:207], v[88:91], v[132:135]
    v_mul_f32 v107, v107, v115
    v_mul_f32 v108, v108, v116
    v_mul_f32 v109, v109, v117
    v_mul_f32 v110, v110, v118
    v_mul_f32 v111, v111, v119
    v_mul_f32 v224, v224, v120
    v_mul_f32 v225, v225, v121
    v_mul_f32 v226, v226, v122
    v_mul_f32 v227, v227, v123
    v_mul_f32 v228, v228, v124
    v_mul_f32 v229, v229, v125
    v_mfma_f32_16x16x32_bf16 v[140:143], v[204:207], v[92:95], v[140:143]
    ds_read_b128 v[204:207], v50 offset:44032
    v_mul_f32 v230, v230, v126
    v_mul_f32 v231, v231, v127
    v_exp_f32 v104, -v104
    v_exp_f32 v105, -v105
    v_exp_f32 v106, -v106
    v_exp_f32 v107, -v107
    v_exp_f32 v108, -v108
    v_mfma_f32_16x16x32_bf16 v[144:147], v[208:211], v[88:91], v[144:147]
    v_exp_f32 v109, -v109
    v_exp_f32 v110, -v110
    v_exp_f32 v111, -v111
    v_exp_f32 v224, -v224
    v_exp_f32 v225, -v225
    v_exp_f32 v226, -v226
    v_mfma_f32_16x16x32_bf16 v[152:155], v[208:211], v[92:95], v[152:155]
    ds_read_b128 v[208:211], v50 offset:45056
    v_exp_f32 v227, -v227
    v_exp_f32 v228, -v228
    v_exp_f32 v229, -v229
    v_exp_f32 v230, -v230
    v_exp_f32 v231, -v231
    v_fma_f32 v104, v104, s30, s30
    v_mfma_f32_16x16x32_bf16 v[148:151], v[212:215], v[88:91], v[148:151]
    v_fma_f32 v105, v105, s30, s30
    v_fma_f32 v106, v106, s30, s30
    v_fma_f32 v107, v107, s30, s30
    v_fma_f32 v108, v108, s30, s30
    v_fma_f32 v109, v109, s30, s30
    v_fma_f32 v110, v110, s30, s30
    v_fma_f32 v111, v111, s30, s30
    v_fma_f32 v224, v224, s30, s30
    v_fma_f32 v225, v225, s30, s30
    v_fma_f32 v226, v226, s30, s30
    v_fma_f32 v227, v227, s30, s30
    v_fma_f32 v228, v228, s30, s30
    v_mfma_f32_16x16x32_bf16 v[156:159], v[212:215], v[92:95], v[156:159]
    ds_read_b128 v[212:215], v50 offset:46080
    v_fma_f32 v229, v229, s30, s30
    v_fma_f32 v230, v230, s30, s30
    v_fma_f32 v231, v231, s30, s30
    v_rcp_f32 v104, v104
    v_rcp_f32 v105, v105
    v_rcp_f32 v106, v106
    v_rcp_f32 v107, v107
    v_mfma_f32_16x16x32_bf16 v[160:163], v[216:219], v[88:91], v[160:163]
    v_rcp_f32 v108, v108
    v_rcp_f32 v109, v109
    v_rcp_f32 v110, v110
    v_rcp_f32 v111, v111
    v_rcp_f32 v224, v224
    v_rcp_f32 v225, v225
    v_mfma_f32_16x16x32_bf16 v[168:171], v[216:219], v[92:95], v[168:171]
    ds_read_b128 v[216:219], v50 offset:47104
    v_rcp_f32 v226, v226
    v_rcp_f32 v227, v227
    v_rcp_f32 v228, v228
    v_rcp_f32 v229, v229
    v_rcp_f32 v230, v230
    v_rcp_f32 v231, v231
    v_mfma_f32_16x16x32_bf16 v[164:167], v[220:223], v[88:91], v[164:167]
    v_mul_f32 v104, v104, v112
    v_mul_f32 v105, v105, v113
    v_mul_f32 v106, v106, v114
    v_mul_f32 v107, v107, v115
    v_mul_f32 v108, v108, v116
    v_mul_f32 v109, v109, v117
    v_mul_f32 v110, v110, v118
    v_mul_f32 v111, v111, v119
    v_mul_f32 v224, v224, v120
    v_mul_f32 v225, v225, v121
    v_mul_f32 v226, v226, v122
    v_mfma_f32_16x16x32_bf16 v[172:175], v[220:223], v[92:95], v[172:175]
    ds_read_b128 v[220:223], v50 offset:48128
    v_mul_f32 v227, v227, v123
    v_mul_f32 v228, v228, v124
    v_mul_f32 v229, v229, v125
    v_mul_f32 v230, v230, v126
    v_mul_f32 v231, v231, v127
    v_cvt_pk_bf16_f32 v96, v104, v105
    v_cvt_pk_bf16_f32 v97, v106, v107
    v_cvt_pk_bf16_f32 v98, v108, v109
    v_cvt_pk_bf16_f32 v99, v110, v111
    v_cvt_pk_bf16_f32 v100, v224, v225
    v_cvt_pk_bf16_f32 v101, v226, v227
    v_cvt_pk_bf16_f32 v102, v228, v229
    v_cvt_pk_bf16_f32 v103, v230, v231
    v_mfma_f32_16x16x32_bf16 v[112:115], v[176:179], v[64:67], 0
    v_mfma_f32_16x16x32_bf16 v[120:123], v[176:179], v[76:79], 0
    ds_read_b64_tr_b16 v[176:177], v49 offset:6144
    ds_read_b64_tr_b16 v[178:179], v49 offset:6400
    v_mfma_f32_16x16x32_bf16 v[116:119], v[180:183], v[64:67], 0
    v_mfma_f32_16x16x32_bf16 v[124:127], v[180:183], v[76:79], 0
    ds_read_b64_tr_b16 v[180:181], v62 offset:6144
    ds_read_b64_tr_b16 v[182:183], v62 offset:6400
    v_mfma_f32_16x16x32_bf16 v[112:115], v[184:187], v[68:71], v[112:115]
    v_mfma_f32_16x16x32_bf16 v[120:123], v[184:187], v[80:83], v[120:123]
    s_add_u32 m0, s41, 61696
    ds_read_b64_tr_b16 v[184:185], v49 offset:8192
    ds_read_b64_tr_b16 v[186:187], v49 offset:8448
    buffer_load_dwordx4 v53, s[4:7], s31 offen offset:0 nt lds
    v_mfma_f32_16x16x32_bf16 v[116:119], v[188:191], v[68:71], v[116:119]
    v_mfma_f32_16x16x32_bf16 v[124:127], v[188:191], v[80:83], v[124:127]
    ds_read_b64_tr_b16 v[188:189], v62 offset:8192
    ds_read_b64_tr_b16 v[190:191], v62 offset:8448
    v_mfma_f32_16x16x32_bf16 v[112:115], v[192:195], v[72:75], v[112:115]
    v_mfma_f32_16x16x32_bf16 v[120:123], v[192:195], v[84:87], v[120:123]
    ds_read_b64_tr_b16 v[192:193], v49 offset:10240
    ds_read_b64_tr_b16 v[194:195], v49 offset:10496
    v_mfma_f32_16x16x32_bf16 v[116:119], v[196:199], v[72:75], v[116:119]
    v_mfma_f32_16x16x32_bf16 v[124:127], v[196:199], v[84:87], v[124:127]
    ds_read_b64_tr_b16 v[196:197], v62 offset:10240
    ds_read_b64_tr_b16 v[198:199], v62 offset:10496
    s_waitcnt vmcnt(3) lgkmcnt(0)
    s_barrier
    v_mfma_f32_16x16x32_bf16 v[128:131], v[200:203], v[96:99], v[128:131]
    s_sub_u32 m0, s34, 6144
    s_movk_i32 s79, 30720
    buffer_load_dwordx4 v51, s[44:47], s79 offen offset:0 lds
    s_add_u32 m0, s34, 0
    s_setprio 0
    buffer_load_dwordx4 v54, s[36:39], 0 offen offset:0 lds
    v_fma_f32 v104, v112, v112, s20
    v_fma_f32 v105, v113, v113, s20
    v_fma_f32 v106, v114, v114, s20
    v_fma_f32 v107, v115, v115, s20
    v_fma_f32 v108, v116, v116, s20
    v_fma_f32 v109, v117, v117, s20
    v_fma_f32 v110, v118, v118, s20
    v_mfma_f32_16x16x32_bf16 v[136:139], v[200:203], v[100:103], v[136:139]
    ds_read_b128 v[200:203], v50 offset:24576
    v_fma_f32 v111, v119, v119, s20
    v_fma_f32 v224, v120, v120, s20
    v_fma_f32 v225, v121, v121, s20
    v_fma_f32 v226, v122, v122, s20
    v_fma_f32 v227, v123, v123, s20
    v_fma_f32 v228, v124, v124, s20
    v_fma_f32 v229, v125, v125, s20
    v_fma_f32 v230, v126, v126, s20
    v_fma_f32 v231, v127, v127, s20
    v_mul_f32 v104, v104, v112
    v_mul_f32 v105, v105, v113
    v_mul_f32 v106, v106, v114
    v_mfma_f32_16x16x32_bf16 v[132:135], v[204:207], v[96:99], v[132:135]
    v_mul_f32 v107, v107, v115
    v_mul_f32 v108, v108, v116
    v_mul_f32 v109, v109, v117
    v_mul_f32 v110, v110, v118
    v_mul_f32 v111, v111, v119
    v_mul_f32 v224, v224, v120
    v_mul_f32 v225, v225, v121
    v_mul_f32 v226, v226, v122
    v_mul_f32 v227, v227, v123
    v_mul_f32 v228, v228, v124
    v_mul_f32 v229, v229, v125
    v_mfma_f32_16x16x32_bf16 v[140:143], v[204:207], v[100:103], v[140:143]
    ds_read_b128 v[204:207], v50 offset:25600
    v_mul_f32 v230, v230, v126
    v_mul_f32 v231, v231, v127
    v_exp_f32 v104, -v104
    v_exp_f32 v105, -v105
    v_exp_f32 v106, -v106
    v_exp_f32 v107, -v107
    v_exp_f32 v108, -v108
    v_mfma_f32_16x16x32_bf16 v[144:147], v[208:211], v[96:99], v[144:147]
    v_exp_f32 v109, -v109
    v_exp_f32 v110, -v110
    v_exp_f32 v111, -v111
    v_exp_f32 v224, -v224
    v_exp_f32 v225, -v225
    v_exp_f32 v226, -v226
    v_mfma_f32_16x16x32_bf16 v[152:155], v[208:211], v[100:103], v[152:155]
    ds_read_b128 v[208:211], v50 offset:26624
    v_exp_f32 v227, -v227
    v_exp_f32 v228, -v228
    v_exp_f32 v229, -v229
    v_exp_f32 v230, -v230
    v_exp_f32 v231, -v231
    v_fma_f32 v104, v104, s30, s30
    v_mfma_f32_16x16x32_bf16 v[148:151], v[212:215], v[96:99], v[148:151]
    v_fma_f32 v105, v105, s30, s30
    v_fma_f32 v106, v106, s30, s30
    v_fma_f32 v107, v107, s30, s30
    v_fma_f32 v108, v108, s30, s30
    v_fma_f32 v109, v109, s30, s30
    v_fma_f32 v110, v110, s30, s30
    v_fma_f32 v111, v111, s30, s30
    v_fma_f32 v224, v224, s30, s30
    v_fma_f32 v225, v225, s30, s30
    v_fma_f32 v226, v226, s30, s30
    v_fma_f32 v227, v227, s30, s30
    v_fma_f32 v228, v228, s30, s30
    v_mfma_f32_16x16x32_bf16 v[156:159], v[212:215], v[100:103], v[156:159]
    ds_read_b128 v[212:215], v50 offset:27648
    v_fma_f32 v229, v229, s30, s30
    v_fma_f32 v230, v230, s30, s30
    v_fma_f32 v231, v231, s30, s30
    v_rcp_f32 v104, v104
    v_rcp_f32 v105, v105
    v_rcp_f32 v106, v106
    v_rcp_f32 v107, v107
    v_mfma_f32_16x16x32_bf16 v[160:163], v[216:219], v[96:99], v[160:163]
    v_rcp_f32 v108, v108
    v_rcp_f32 v109, v109
    v_rcp_f32 v110, v110
    v_rcp_f32 v111, v111
    v_rcp_f32 v224, v224
    v_rcp_f32 v225, v225
    v_mfma_f32_16x16x32_bf16 v[168:171], v[216:219], v[100:103], v[168:171]
    ds_read_b128 v[216:219], v50 offset:28672
    v_rcp_f32 v226, v226
    v_rcp_f32 v227, v227
    v_rcp_f32 v228, v228
    v_rcp_f32 v229, v229
    v_rcp_f32 v230, v230
    v_rcp_f32 v231, v231
    v_mfma_f32_16x16x32_bf16 v[164:167], v[220:223], v[96:99], v[164:167]
    v_mul_f32 v104, v104, v112
    v_mul_f32 v105, v105, v113
    v_mul_f32 v106, v106, v114
    v_mul_f32 v107, v107, v115
    v_mul_f32 v108, v108, v116
    v_mul_f32 v109, v109, v117
    v_mul_f32 v110, v110, v118
    v_mul_f32 v111, v111, v119
    v_mul_f32 v224, v224, v120
    v_mul_f32 v225, v225, v121
    v_mul_f32 v226, v226, v122
    v_mfma_f32_16x16x32_bf16 v[172:175], v[220:223], v[100:103], v[172:175]
    ds_read_b128 v[220:223], v50 offset:29696
    v_mul_f32 v227, v227, v123
    v_mul_f32 v228, v228, v124
    v_mul_f32 v229, v229, v125
    v_mul_f32 v230, v230, v126
    v_mul_f32 v231, v231, v127
    v_cvt_pk_bf16_f32 v88, v104, v105
    v_cvt_pk_bf16_f32 v89, v106, v107
    v_cvt_pk_bf16_f32 v90, v108, v109
    v_cvt_pk_bf16_f32 v91, v110, v111
    v_cvt_pk_bf16_f32 v92, v224, v225
    v_cvt_pk_bf16_f32 v93, v226, v227
    v_cvt_pk_bf16_f32 v94, v228, v229
    v_cvt_pk_bf16_f32 v95, v230, v231
    v_mfma_f32_16x16x32_bf16 v[112:115], v[176:179], v[64:67], 0
    v_mfma_f32_16x16x32_bf16 v[120:123], v[176:179], v[76:79], 0
    s_add_u32 m0, s34, 5760
    ds_read_b64_tr_b16 v[176:177], v49 offset:12288
    ds_read_b64_tr_b16 v[178:179], v49 offset:12544
    buffer_load_dwordx4 v54, s[36:39], 0 offen offset:384 lds
    v_mfma_f32_16x16x32_bf16 v[116:119], v[180:183], v[64:67], 0
    buffer_store_dwordx4 v[248:251], v55, s[8:11], s22 offen offset:128 sc0 sc1 nt
    v_mfma_f32_16x16x32_bf16 v[124:127], v[180:183], v[76:79], 0
    ds_read_b64_tr_b16 v[180:181], v62 offset:12288
    ds_read_b64_tr_b16 v[182:183], v62 offset:12544
    v_mfma_f32_16x16x32_bf16 v[112:115], v[184:187], v[68:71], v[112:115]
    v_mfma_f32_16x16x32_bf16 v[120:123], v[184:187], v[80:83], v[120:123]
    ds_read_b64_tr_b16 v[184:185], v49 offset:14336
    ds_read_b64_tr_b16 v[186:187], v49 offset:14592
    v_mfma_f32_16x16x32_bf16 v[116:119], v[188:191], v[68:71], v[116:119]
    v_mfma_f32_16x16x32_bf16 v[124:127], v[188:191], v[80:83], v[124:127]
    ds_read_b64_tr_b16 v[188:189], v62 offset:14336
    ds_read_b64_tr_b16 v[190:191], v62 offset:14592
    v_mfma_f32_16x16x32_bf16 v[112:115], v[192:195], v[72:75], v[112:115]
    v_mfma_f32_16x16x32_bf16 v[120:123], v[192:195], v[84:87], v[120:123]
    ds_read_b64_tr_b16 v[192:193], v49 offset:16384
    ds_read_b64_tr_b16 v[194:195], v49 offset:16640
    v_mfma_f32_16x16x32_bf16 v[116:119], v[196:199], v[72:75], v[116:119]
    v_mfma_f32_16x16x32_bf16 v[124:127], v[196:199], v[84:87], v[124:127]
    ds_read_b64_tr_b16 v[196:197], v62 offset:16384
    ds_read_b64_tr_b16 v[198:199], v62 offset:16640
    s_waitcnt lgkmcnt(0)
    v_mfma_f32_16x16x32_bf16 v[128:131], v[200:203], v[88:91], v[128:131]
    s_setprio 3
    v_fma_f32 v104, v112, v112, s20
    v_fma_f32 v105, v113, v113, s20
    v_fma_f32 v106, v114, v114, s20
    v_fma_f32 v107, v115, v115, s20
    v_fma_f32 v108, v116, v116, s20
    v_fma_f32 v109, v117, v117, s20
    v_fma_f32 v110, v118, v118, s20
    v_mfma_f32_16x16x32_bf16 v[136:139], v[200:203], v[92:95], v[136:139]
    ds_read_b128 v[200:203], v50 offset:36864
    v_fma_f32 v111, v119, v119, s20
    v_fma_f32 v224, v120, v120, s20
    v_fma_f32 v225, v121, v121, s20
    v_fma_f32 v226, v122, v122, s20
    v_fma_f32 v227, v123, v123, s20
    v_fma_f32 v228, v124, v124, s20
    v_fma_f32 v229, v125, v125, s20
    v_fma_f32 v230, v126, v126, s20
    v_fma_f32 v231, v127, v127, s20
    v_mul_f32 v104, v104, v112
    v_mul_f32 v105, v105, v113
    v_mul_f32 v106, v106, v114
    v_mfma_f32_16x16x32_bf16 v[132:135], v[204:207], v[88:91], v[132:135]
    v_mul_f32 v107, v107, v115
    v_mul_f32 v108, v108, v116
    v_mul_f32 v109, v109, v117
    v_mul_f32 v110, v110, v118
    v_mul_f32 v111, v111, v119
    v_mul_f32 v224, v224, v120
    v_mul_f32 v225, v225, v121
    v_mul_f32 v226, v226, v122
    v_mul_f32 v227, v227, v123
    v_mul_f32 v228, v228, v124
    v_mul_f32 v229, v229, v125
    v_mfma_f32_16x16x32_bf16 v[140:143], v[204:207], v[92:95], v[140:143]
    ds_read_b128 v[204:207], v50 offset:37888
    v_mul_f32 v230, v230, v126
    v_mul_f32 v231, v231, v127
    v_exp_f32 v104, -v104
    v_exp_f32 v105, -v105
    v_exp_f32 v106, -v106
    v_exp_f32 v107, -v107
    v_exp_f32 v108, -v108
    v_mfma_f32_16x16x32_bf16 v[144:147], v[208:211], v[88:91], v[144:147]
    v_exp_f32 v109, -v109
    v_exp_f32 v110, -v110
    v_exp_f32 v111, -v111
    v_exp_f32 v224, -v224
    v_exp_f32 v225, -v225
    v_exp_f32 v226, -v226
    v_mfma_f32_16x16x32_bf16 v[152:155], v[208:211], v[92:95], v[152:155]
    ds_read_b128 v[208:211], v50 offset:38912
    v_exp_f32 v227, -v227
    v_exp_f32 v228, -v228
    v_exp_f32 v229, -v229
    v_exp_f32 v230, -v230
    v_exp_f32 v231, -v231
    v_fma_f32 v104, v104, s30, s30
    v_mfma_f32_16x16x32_bf16 v[148:151], v[212:215], v[88:91], v[148:151]
    v_fma_f32 v105, v105, s30, s30
    v_fma_f32 v106, v106, s30, s30
    v_fma_f32 v107, v107, s30, s30
    v_fma_f32 v108, v108, s30, s30
    v_fma_f32 v109, v109, s30, s30
    v_fma_f32 v110, v110, s30, s30
    v_fma_f32 v111, v111, s30, s30
    v_fma_f32 v224, v224, s30, s30
    v_fma_f32 v225, v225, s30, s30
    v_fma_f32 v226, v226, s30, s30
    v_fma_f32 v227, v227, s30, s30
    v_fma_f32 v228, v228, s30, s30
    v_mfma_f32_16x16x32_bf16 v[156:159], v[212:215], v[92:95], v[156:159]
    ds_read_b128 v[212:215], v50 offset:39936
    v_fma_f32 v229, v229, s30, s30
    v_fma_f32 v230, v230, s30, s30
    v_fma_f32 v231, v231, s30, s30
    v_rcp_f32 v104, v104
    v_rcp_f32 v105, v105
    v_rcp_f32 v106, v106
    v_rcp_f32 v107, v107
    v_mfma_f32_16x16x32_bf16 v[160:163], v[216:219], v[88:91], v[160:163]
    v_rcp_f32 v108, v108
    v_rcp_f32 v109, v109
    v_rcp_f32 v110, v110
    v_rcp_f32 v111, v111
    v_rcp_f32 v224, v224
    v_rcp_f32 v225, v225
    v_mfma_f32_16x16x32_bf16 v[168:171], v[216:219], v[92:95], v[168:171]
    ds_read_b128 v[216:219], v50 offset:40960
    v_rcp_f32 v226, v226
    v_rcp_f32 v227, v227
    v_rcp_f32 v228, v228
    v_rcp_f32 v229, v229
    v_rcp_f32 v230, v230
    v_rcp_f32 v231, v231
    v_mfma_f32_16x16x32_bf16 v[164:167], v[220:223], v[88:91], v[164:167]
    v_mul_f32 v104, v104, v112
    v_mul_f32 v105, v105, v113
    v_mul_f32 v106, v106, v114
    v_mul_f32 v107, v107, v115
    v_mul_f32 v108, v108, v116
    v_mul_f32 v109, v109, v117
    v_mul_f32 v110, v110, v118
    v_mul_f32 v111, v111, v119
    v_mul_f32 v224, v224, v120
    v_mul_f32 v225, v225, v121
    v_mul_f32 v226, v226, v122
    v_mfma_f32_16x16x32_bf16 v[172:175], v[220:223], v[92:95], v[172:175]
    ds_read_b128 v[220:223], v50 offset:41984
    v_mul_f32 v227, v227, v123
    v_mul_f32 v228, v228, v124
    v_mul_f32 v229, v229, v125
    v_mul_f32 v230, v230, v126
    v_mul_f32 v231, v231, v127
    v_cvt_pk_bf16_f32 v96, v104, v105
    v_cvt_pk_bf16_f32 v97, v106, v107
    v_cvt_pk_bf16_f32 v98, v108, v109
    v_cvt_pk_bf16_f32 v99, v110, v111
    v_cvt_pk_bf16_f32 v100, v224, v225
    v_cvt_pk_bf16_f32 v101, v226, v227
    v_cvt_pk_bf16_f32 v102, v228, v229
    v_cvt_pk_bf16_f32 v103, v230, v231
    v_mfma_f32_16x16x32_bf16 v[112:115], v[176:179], v[64:67], 0
    v_mfma_f32_16x16x32_bf16 v[120:123], v[176:179], v[76:79], 0
    ds_read_b64_tr_b16 v[176:177], v49 offset:18432
    ds_read_b64_tr_b16 v[178:179], v49 offset:18688
    v_mfma_f32_16x16x32_bf16 v[116:119], v[180:183], v[64:67], 0
    v_mfma_f32_16x16x32_bf16 v[124:127], v[180:183], v[76:79], 0
    ds_read_b64_tr_b16 v[180:181], v62 offset:18432
    ds_read_b64_tr_b16 v[182:183], v62 offset:18688
    v_mfma_f32_16x16x32_bf16 v[112:115], v[184:187], v[68:71], v[112:115]
    v_mfma_f32_16x16x32_bf16 v[120:123], v[184:187], v[80:83], v[120:123]
    ds_read_b64_tr_b16 v[184:185], v49 offset:20480
    ds_read_b64_tr_b16 v[186:187], v49 offset:20736
    v_mfma_f32_16x16x32_bf16 v[116:119], v[188:191], v[68:71], v[116:119]
    v_mfma_f32_16x16x32_bf16 v[124:127], v[188:191], v[80:83], v[124:127]
    ds_read_b64_tr_b16 v[188:189], v62 offset:20480
    ds_read_b64_tr_b16 v[190:191], v62 offset:20736
    v_mfma_f32_16x16x32_bf16 v[112:115], v[192:195], v[72:75], v[112:115]
    v_mfma_f32_16x16x32_bf16 v[120:123], v[192:195], v[84:87], v[120:123]
    ds_read_b64_tr_b16 v[192:193], v49 offset:22528
    ds_read_b64_tr_b16 v[194:195], v49 offset:22784
    v_mfma_f32_16x16x32_bf16 v[116:119], v[196:199], v[72:75], v[116:119]
    v_mfma_f32_16x16x32_bf16 v[124:127], v[196:199], v[84:87], v[124:127]
    ds_read_b64_tr_b16 v[196:197], v62 offset:22528
    ds_read_b64_tr_b16 v[198:199], v62 offset:22784
    s_waitcnt vmcnt(1) lgkmcnt(0)
    s_barrier
    v_mfma_f32_16x16x32_bf16 v[128:131], v[200:203], v[96:99], v[128:131]
    s_sub_u32 m0, s34, 12288
    s_movk_i32 s79, 0
    buffer_load_dwordx4 v51, s[44:47], s79 offen offset:0 lds
    s_add_u32 m0, s34, 12224
    s_setprio 0
    buffer_load_dwordx4 v54, s[36:39], 0 offen offset:64 lds
    v_fma_f32 v104, v112, v112, s20
    v_fma_f32 v105, v113, v113, s20
    v_fma_f32 v106, v114, v114, s20
    v_fma_f32 v107, v115, v115, s20
    v_fma_f32 v108, v116, v116, s20
    v_fma_f32 v109, v117, v117, s20
    v_fma_f32 v110, v118, v118, s20
    v_mfma_f32_16x16x32_bf16 v[136:139], v[200:203], v[100:103], v[136:139]
    ds_read_b128 v[200:203], v50 offset:30720
    v_fma_f32 v111, v119, v119, s20
    v_fma_f32 v224, v120, v120, s20
    v_fma_f32 v225, v121, v121, s20
    v_fma_f32 v226, v122, v122, s20
    v_fma_f32 v227, v123, v123, s20
    v_fma_f32 v228, v124, v124, s20
    v_fma_f32 v229, v125, v125, s20
    v_fma_f32 v230, v126, v126, s20
    v_fma_f32 v231, v127, v127, s20
    v_mul_f32 v104, v104, v112
    v_mul_f32 v105, v105, v113
    v_mul_f32 v106, v106, v114
    v_mfma_f32_16x16x32_bf16 v[132:135], v[204:207], v[96:99], v[132:135]
    v_mul_f32 v107, v107, v115
    v_mul_f32 v108, v108, v116
    v_mul_f32 v109, v109, v117
    v_mul_f32 v110, v110, v118
    v_mul_f32 v111, v111, v119
    v_mul_f32 v224, v224, v120
    v_mul_f32 v225, v225, v121
    v_mul_f32 v226, v226, v122
    v_mul_f32 v227, v227, v123
    v_mul_f32 v228, v228, v124
    v_mul_f32 v229, v229, v125
    v_mfma_f32_16x16x32_bf16 v[140:143], v[204:207], v[100:103], v[140:143]
    ds_read_b128 v[204:207], v50 offset:31744
    v_mul_f32 v230, v230, v126
    v_mul_f32 v231, v231, v127
    v_exp_f32 v104, -v104
    v_exp_f32 v105, -v105
    v_exp_f32 v106, -v106
    v_exp_f32 v107, -v107
    v_exp_f32 v108, -v108
    v_mfma_f32_16x16x32_bf16 v[144:147], v[208:211], v[96:99], v[144:147]
    v_exp_f32 v109, -v109
    v_exp_f32 v110, -v110
    v_exp_f32 v111, -v111
    v_exp_f32 v224, -v224
    v_exp_f32 v225, -v225
    v_exp_f32 v226, -v226
    v_mfma_f32_16x16x32_bf16 v[152:155], v[208:211], v[100:103], v[152:155]
    ds_read_b128 v[208:211], v50 offset:32768
    v_exp_f32 v227, -v227
    v_exp_f32 v228, -v228
    v_exp_f32 v229, -v229
    v_exp_f32 v230, -v230
    v_exp_f32 v231, -v231
    v_fma_f32 v104, v104, s30, s30
    v_mfma_f32_16x16x32_bf16 v[148:151], v[212:215], v[96:99], v[148:151]
    v_fma_f32 v105, v105, s30, s30
    v_fma_f32 v106, v106, s30, s30
    v_fma_f32 v107, v107, s30, s30
    v_fma_f32 v108, v108, s30, s30
    v_fma_f32 v109, v109, s30, s30
    v_fma_f32 v110, v110, s30, s30
    v_fma_f32 v111, v111, s30, s30
    v_fma_f32 v224, v224, s30, s30
    v_fma_f32 v225, v225, s30, s30
    v_fma_f32 v226, v226, s30, s30
    v_fma_f32 v227, v227, s30, s30
    v_fma_f32 v228, v228, s30, s30
    v_mfma_f32_16x16x32_bf16 v[156:159], v[212:215], v[100:103], v[156:159]
    ds_read_b128 v[212:215], v50 offset:33792
    v_fma_f32 v229, v229, s30, s30
    v_fma_f32 v230, v230, s30, s30
    v_fma_f32 v231, v231, s30, s30
    v_rcp_f32 v104, v104
    v_rcp_f32 v105, v105
    v_rcp_f32 v106, v106
    v_rcp_f32 v107, v107
    v_mfma_f32_16x16x32_bf16 v[160:163], v[216:219], v[96:99], v[160:163]
    v_rcp_f32 v108, v108
    v_rcp_f32 v109, v109
    v_rcp_f32 v110, v110
    v_rcp_f32 v111, v111
    v_rcp_f32 v224, v224
    v_rcp_f32 v225, v225
    v_mfma_f32_16x16x32_bf16 v[168:171], v[216:219], v[100:103], v[168:171]
    ds_read_b128 v[216:219], v50 offset:34816
    v_rcp_f32 v226, v226
    v_rcp_f32 v227, v227
    v_rcp_f32 v228, v228
    v_rcp_f32 v229, v229
    v_rcp_f32 v230, v230
    v_rcp_f32 v231, v231
    v_mfma_f32_16x16x32_bf16 v[164:167], v[220:223], v[96:99], v[164:167]
    v_mul_f32 v104, v104, v112
    v_mul_f32 v105, v105, v113
    v_mul_f32 v106, v106, v114
    v_mul_f32 v107, v107, v115
    v_mul_f32 v108, v108, v116
    v_mul_f32 v109, v109, v117
    v_mul_f32 v110, v110, v118
    v_mul_f32 v111, v111, v119
    v_mul_f32 v224, v224, v120
    v_mul_f32 v225, v225, v121
    v_mul_f32 v226, v226, v122
    v_mfma_f32_16x16x32_bf16 v[172:175], v[220:223], v[100:103], v[172:175]
    ds_read_b128 v[220:223], v50 offset:35840
    v_mul_f32 v227, v227, v123
    v_mul_f32 v228, v228, v124
    v_mul_f32 v229, v229, v125
    v_mul_f32 v230, v230, v126
    v_mul_f32 v231, v231, v127
    v_cvt_pk_bf16_f32 v88, v104, v105
    v_cvt_pk_bf16_f32 v89, v106, v107
    v_cvt_pk_bf16_f32 v90, v108, v109
    v_cvt_pk_bf16_f32 v91, v110, v111
    v_cvt_pk_bf16_f32 v92, v224, v225
    v_cvt_pk_bf16_f32 v93, v226, v227
    v_cvt_pk_bf16_f32 v94, v228, v229
    v_cvt_pk_bf16_f32 v95, v230, v231
    v_mfma_f32_16x16x32_bf16 v[112:115], v[176:179], v[64:67], 0
    v_mfma_f32_16x16x32_bf16 v[120:123], v[176:179], v[76:79], 0
    s_add_u32 m0, s34, 17984
    ds_read_b64_tr_b16 v[176:177], v49 offset:0
    ds_read_b64_tr_b16 v[178:179], v49 offset:256
    buffer_load_dwordx4 v54, s[36:39], 0 offen offset:448 lds
    v_mfma_f32_16x16x32_bf16 v[116:119], v[180:183], v[64:67], 0
    buffer_store_dwordx4 v[252:255], v55, s[8:11], s22 offen offset:1664 sc0 sc1 nt
    s_add_u32 s16, s16, 1572864
    s_add_u32 s21, s21, 1
    v_mfma_f32_16x16x32_bf16 v[124:127], v[180:183], v[76:79], 0
    ds_read_b64_tr_b16 v[180:181], v62 offset:0
    ds_read_b64_tr_b16 v[182:183], v62 offset:256
    v_mfma_f32_16x16x32_bf16 v[112:115], v[184:187], v[68:71], v[112:115]
    v_mfma_f32_16x16x32_bf16 v[120:123], v[184:187], v[80:83], v[120:123]
    ds_read_b64_tr_b16 v[184:185], v49 offset:2048
    ds_read_b64_tr_b16 v[186:187], v49 offset:2304
    v_mfma_f32_16x16x32_bf16 v[116:119], v[188:191], v[68:71], v[116:119]
    v_mfma_f32_16x16x32_bf16 v[124:127], v[188:191], v[80:83], v[124:127]
    ds_read_b64_tr_b16 v[188:189], v62 offset:2048
    ds_read_b64_tr_b16 v[190:191], v62 offset:2304
    v_mfma_f32_16x16x32_bf16 v[112:115], v[192:195], v[72:75], v[112:115]
    v_mfma_f32_16x16x32_bf16 v[120:123], v[192:195], v[84:87], v[120:123]
    ds_read_b64_tr_b16 v[192:193], v49 offset:4096
    ds_read_b64_tr_b16 v[194:195], v49 offset:4352
    v_mfma_f32_16x16x32_bf16 v[116:119], v[196:199], v[72:75], v[116:119]
    v_mfma_f32_16x16x32_bf16 v[124:127], v[196:199], v[84:87], v[124:127]
    ds_read_b64_tr_b16 v[196:197], v62 offset:4096
    ds_read_b64_tr_b16 v[198:199], v62 offset:4352
    s_waitcnt lgkmcnt(0)
    s_setprio 3
    v_mfma_f32_16x16x32_bf16 v[128:131], v[200:203], v[88:91], v[128:131]
    ds_read_b64 v[64:65], v47 offset:0
    v_add_u32 v3, v41, v45
    v_fma_f32 v104, v112, v112, s20
    v_fma_f32 v105, v113, v113, s20
    v_fma_f32 v106, v114, v114, s20
    v_fma_f32 v107, v115, v115, s20
    v_fma_f32 v108, v116, v116, s20
    v_fma_f32 v109, v117, v117, s20
    v_fma_f32 v110, v118, v118, s20
    v_mfma_f32_16x16x32_bf16 v[136:139], v[200:203], v[92:95], v[136:139]
    ds_read_b128 v[200:203], v50 offset:43008
    ds_read_b64 v[66:67], v47 offset:8
    v_fma_f32 v111, v119, v119, s20
    v_fma_f32 v224, v120, v120, s20
    v_fma_f32 v225, v121, v121, s20
    v_fma_f32 v226, v122, v122, s20
    v_fma_f32 v227, v123, v123, s20
    v_fma_f32 v228, v124, v124, s20
    v_fma_f32 v229, v125, v125, s20
    v_fma_f32 v230, v126, v126, s20
    v_fma_f32 v231, v127, v127, s20
    v_mul_f32 v104, v104, v112
    v_mul_f32 v105, v105, v113
    v_mul_f32 v106, v106, v114
    v_mfma_f32_16x16x32_bf16 v[132:135], v[204:207], v[88:91], v[132:135]
    ds_read_b64 v[68:69], v47 offset:64
    v_mul_f32 v107, v107, v115
    v_mul_f32 v108, v108, v116
    v_mul_f32 v109, v109, v117
    v_mul_f32 v110, v110, v118
    v_mul_f32 v111, v111, v119
    v_mul_f32 v224, v224, v120
    v_mul_f32 v225, v225, v121
    v_mul_f32 v226, v226, v122
    v_mul_f32 v227, v227, v123
    v_mul_f32 v228, v228, v124
    v_mul_f32 v229, v229, v125
    v_mfma_f32_16x16x32_bf16 v[140:143], v[204:207], v[92:95], v[140:143]
    ds_read_b128 v[204:207], v50 offset:44032
    ds_read_b64 v[70:71], v47 offset:72
    v_mul_f32 v230, v230, v126
    v_mul_f32 v231, v231, v127
    v_exp_f32 v104, -v104
    v_exp_f32 v105, -v105
    v_exp_f32 v106, -v106
    v_exp_f32 v107, -v107
    v_exp_f32 v108, -v108
    v_mfma_f32_16x16x32_bf16 v[144:147], v[208:211], v[88:91], v[144:147]
    ds_read_b64 v[72:73], v47 offset:128
    v_exp_f32 v109, -v109
    v_exp_f32 v110, -v110
    v_exp_f32 v111, -v111
    v_exp_f32 v224, -v224
    v_exp_f32 v225, -v225
    v_exp_f32 v226, -v226
    v_mfma_f32_16x16x32_bf16 v[152:155], v[208:211], v[92:95], v[152:155]
    ds_read_b128 v[208:211], v50 offset:45056
    ds_read_b64 v[74:75], v47 offset:136
    v_exp_f32 v227, -v227
    v_exp_f32 v228, -v228
    v_exp_f32 v229, -v229
    v_exp_f32 v230, -v230
    v_exp_f32 v231, -v231
    v_fma_f32 v104, v104, s30, s30
    v_mfma_f32_16x16x32_bf16 v[148:151], v[212:215], v[88:91], v[148:151]
    ds_read_b64 v[76:77], v48 offset:0
    v_fma_f32 v105, v105, s30, s30
    v_fma_f32 v106, v106, s30, s30
    v_fma_f32 v107, v107, s30, s30
    v_fma_f32 v108, v108, s30, s30
    v_fma_f32 v109, v109, s30, s30
    v_fma_f32 v110, v110, s30, s30
    v_fma_f32 v111, v111, s30, s30
    v_fma_f32 v224, v224, s30, s30
    v_fma_f32 v225, v225, s30, s30
    v_fma_f32 v226, v226, s30, s30
    v_fma_f32 v227, v227, s30, s30
    v_fma_f32 v228, v228, s30, s30
    v_mfma_f32_16x16x32_bf16 v[156:159], v[212:215], v[92:95], v[156:159]
    ds_read_b128 v[212:215], v50 offset:46080
    ds_read_b64 v[78:79], v48 offset:8
    v_fma_f32 v229, v229, s30, s30
    v_fma_f32 v230, v230, s30, s30
    v_fma_f32 v231, v231, s30, s30
    v_rcp_f32 v104, v104
    v_rcp_f32 v105, v105
    v_rcp_f32 v106, v106
    v_rcp_f32 v107, v107
    v_mfma_f32_16x16x32_bf16 v[160:163], v[216:219], v[88:91], v[160:163]
    ds_read_b64 v[80:81], v48 offset:64
    v_rcp_f32 v108, v108
    v_rcp_f32 v109, v109
    v_rcp_f32 v110, v110
    v_rcp_f32 v111, v111
    v_rcp_f32 v224, v224
    v_rcp_f32 v225, v225
    v_mfma_f32_16x16x32_bf16 v[168:171], v[216:219], v[92:95], v[168:171]
    ds_read_b128 v[216:219], v50 offset:47104
    ds_read_b64 v[82:83], v48 offset:72
    v_rcp_f32 v226, v226
    v_rcp_f32 v227, v227
    v_rcp_f32 v228, v228
    v_rcp_f32 v229, v229
    v_rcp_f32 v230, v230
    v_rcp_f32 v231, v231
    v_mfma_f32_16x16x32_bf16 v[164:167], v[220:223], v[88:91], v[164:167]
    ds_read_b64 v[84:85], v48 offset:128
    v_mul_f32 v104, v104, v112
    v_mul_f32 v105, v105, v113
    v_mul_f32 v106, v106, v114
    v_mul_f32 v107, v107, v115
    v_mul_f32 v108, v108, v116
    v_mul_f32 v109, v109, v117
    v_mul_f32 v110, v110, v118
    v_mul_f32 v111, v111, v119
    v_mul_f32 v224, v224, v120
    v_mul_f32 v225, v225, v121
    v_mul_f32 v226, v226, v122
    v_mfma_f32_16x16x32_bf16 v[172:175], v[220:223], v[92:95], v[172:175]
    ds_read_b128 v[220:223], v50 offset:48128
    ds_read_b64 v[86:87], v48 offset:136
    s_cmp_eq_u32 s21, 1
    s_cselect_b32 s79, 0, 1572864
    s_add_u32 s22, s22, s79
    v_mul_f32 v227, v227, v123
    v_mul_f32 v228, v228, v124
    v_mul_f32 v229, v229, v125
    v_mul_f32 v230, v230, v126
    v_mul_f32 v231, v231, v127
    v_cvt_pk_bf16_f32 v96, v104, v105
    v_cvt_pk_bf16_f32 v97, v106, v107
    v_cvt_pk_bf16_f32 v98, v108, v109
    v_cvt_pk_bf16_f32 v99, v110, v111
    v_cvt_pk_bf16_f32 v100, v224, v225
    v_cvt_pk_bf16_f32 v101, v226, v227
    v_cvt_pk_bf16_f32 v102, v228, v229
    v_cvt_pk_bf16_f32 v103, v230, v231
    s_waitcnt lgkmcnt(0)
    ds_read_b64 v[224:225], v3 offset:7680
    ds_read_b64 v[226:227], v3 offset:7872
    ds_read_b64 v[228:229], v3 offset:11520
    ds_read_b64 v[230:231], v3 offset:11712
    v_mfma_f32_16x16x32_bf16 v[128:131], v[200:203], v[96:99], v[128:131]
    v_mfma_f32_16x16x32_bf16 v[132:135], v[204:207], v[96:99], v[132:135]
    v_mfma_f32_16x16x32_bf16 v[144:147], v[208:211], v[96:99], v[144:147]
    v_mfma_f32_16x16x32_bf16 v[148:151], v[212:215], v[96:99], v[148:151]
    v_mfma_f32_16x16x32_bf16 v[160:163], v[216:219], v[96:99], v[160:163]
    v_mfma_f32_16x16x32_bf16 v[164:167], v[220:223], v[96:99], v[164:167]
    s_cmp_ge_u32 s21, 4
    s_cbranch_scc1 L_fin_s
    s_setprio 3
    s_waitcnt lgkmcnt(4)
    s_barrier
    v_mfma_f32_16x16x32_bf16 v[136:139], v[200:203], v[100:103], v[136:139]
    ds_read_b64 v[200:201], v41 offset:0
    ds_read_b64 v[202:203], v41 offset:192
    v_cvt_pk_bf16_f32 v232, v128, v129
    v_cvt_pk_bf16_f32 v233, v130, v131
    v_cvt_pk_bf16_f32 v234, v132, v133
    v_mfma_f32_16x16x32_bf16 v[140:143], v[204:207], v[100:103], v[140:143]
    ds_read_b64 v[204:205], v41 offset:3840
    ds_read_b64 v[206:207], v41 offset:4032
    v_cvt_pk_bf16_f32 v235, v134, v135
    v_cvt_pk_bf16_f32 v240, v144, v145
    v_cvt_pk_bf16_f32 v241, v146, v147
    v_mfma_f32_16x16x32_bf16 v[152:155], v[208:211], v[100:103], v[152:155]
    ds_read_b64 v[208:209], v41 offset:7680
    ds_read_b64 v[210:211], v41 offset:7872
    v_cvt_pk_bf16_f32 v242, v148, v149
    v_cvt_pk_bf16_f32 v243, v150, v151
    v_cvt_pk_bf16_f32 v248, v160, v161
    v_mfma_f32_16x16x32_bf16 v[156:159], v[212:215], v[100:103], v[156:159]
    ds_read_b64 v[212:213], v41 offset:11520
    ds_read_b64 v[214:215], v41 offset:11712
    v_cvt_pk_bf16_f32 v249, v162, v163
    v_cvt_pk_bf16_f32 v250, v164, v165
    v_cvt_pk_bf16_f32 v251, v166, v167
    v_mfma_f32_16x16x32_bf16 v[168:171], v[216:219], v[100:103], v[168:171]
    ds_read_b64 v[216:217], v3 offset:0
    ds_read_b64 v[218:219], v3 offset:192
    v_mfma_f32_16x16x32_bf16 v[172:175], v[220:223], v[100:103], v[172:175]
    ds_read_b64 v[220:221], v3 offset:3840
    ds_read_b64 v[222:223], v3 offset:4032
    s_mov_b32 s10, 50331648
    s_cmp_lt_u32 s21, 3
    s_cselect_b32 s6, 50331648, 0
    v_mfma_f32_16x16x32_bf16 v[128:131], v[58:61], v[64:67], 0
    v_cvt_pk_bf16_f32 v236, v136, v137
    v_cvt_pk_bf16_f32 v237, v138, v139
    v_cvt_pk_bf16_f32 v238, v140, v141
    v_mfma_f32_16x16x32_bf16 v[132:135], v[56:59], v[64:67], 0
    v_cvt_pk_bf16_f32 v239, v142, v143
    v_cvt_pk_bf16_f32 v244, v152, v153
    v_cvt_pk_bf16_f32 v245, v154, v155
    v_mfma_f32_16x16x32_bf16 v[144:147], v[58:61], v[68:71], 0
    v_cvt_pk_bf16_f32 v246, v156, v157
    v_cvt_pk_bf16_f32 v247, v158, v159
    v_cvt_pk_bf16_f32 v252, v168, v169
    v_mfma_f32_16x16x32_bf16 v[148:151], v[56:59], v[68:71], 0
    v_cvt_pk_bf16_f32 v253, v170, v171
    v_cvt_pk_bf16_f32 v254, v172, v173
    v_cvt_pk_bf16_f32 v255, v174, v175
    v_mfma_f32_16x16x32_bf16 v[160:163], v[58:61], v[72:75], 0
    v_mfma_f32_16x16x32_bf16 v[164:167], v[56:59], v[72:75], 0
    v_mfma_f32_16x16x32_bf16 v[136:139], v[58:61], v[76:79], 0
    v_mfma_f32_16x16x32_bf16 v[140:143], v[56:59], v[76:79], 0
    v_mfma_f32_16x16x32_bf16 v[152:155], v[58:61], v[80:83], 0
    v_mfma_f32_16x16x32_bf16 v[156:159], v[56:59], v[80:83], 0
    v_mfma_f32_16x16x32_bf16 v[168:171], v[58:61], v[84:87], 0
    v_mfma_f32_16x16x32_bf16 v[172:175], v[56:59], v[84:87], 0
    s_waitcnt lgkmcnt(0)
    s_setprio 2
    v_mfma_f32_16x16x32_bf16 v[112:115], v[4:7], v[216:219], 0
    v_add_u32 v3, v42, v45
    v_add_u32 v72, v41, v44
    v_add_u32 v73, v72, v45
    ds_read_b64 v[80:81], v42 offset:0
    ds_read_b64 v[82:83], v42 offset:192
    v_smfmac_f32_16x16x64_bf16 v[112:115], v[8:11], v[200:207], v40
    ds_read_b64 v[84:85], v42 offset:3840
    ds_read_b64 v[86:87], v42 offset:4032
    v_smfmac_f32_16x16x64_bf16 v[112:115], v[12:15], v[208:215], v40
    ds_read_b64 v[88:89], v42 offset:7680
    ds_read_b64 v[90:91], v42 offset:7872
    v_mfma_f32_16x16x32_bf16 v[116:119], v[4:7], v[220:223], 0
    ds_read_b64 v[92:93], v42 offset:11520
    ds_read_b64 v[94:95], v42 offset:11712
    v_smfmac_f32_16x16x64_bf16 v[116:119], v[8:11], v[204:211], v40
    ds_read_b64 v[96:97], v3 offset:0
    ds_read_b64 v[98:99], v3 offset:192
    v_smfmac_f32_16x16x64_bf16 v[116:119], v[12:15], v[212:219], v40
    ds_read_b64 v[100:101], v3 offset:3840
    ds_read_b64 v[102:103], v3 offset:4032
    v_cvt_pk_bf16_f32 v64, v112, v113
    v_cvt_pk_bf16_f32 v65, v114, v115
    ds_write_b64 v72, v[64:65] offset:7680
    v_mfma_f32_16x16x32_bf16 v[120:123], v[4:7], v[224:227], 0
    ds_read_b64 v[104:105], v3 offset:7680
    v_smfmac_f32_16x16x64_bf16 v[120:123], v[8:11], v[208:215], v40
    ds_read_b64 v[106:107], v3 offset:7872
    v_smfmac_f32_16x16x64_bf16 v[120:123], v[12:15], v[216:223], v40
    ds_read_b64 v[108:109], v3 offset:11520
    v_cvt_pk_bf16_f32 v66, v116, v117
    v_cvt_pk_bf16_f32 v67, v118, v119
    ds_write_b64 v72, v[66:67] offset:11520
    v_mfma_f32_16x16x32_bf16 v[124:127], v[4:7], v[228:231], 0
    ds_read_b64 v[110:111], v3 offset:11712
    v_smfmac_f32_16x16x64_bf16 v[124:127], v[8:11], v[212:219], v40
    v_smfmac_f32_16x16x64_bf16 v[124:127], v[12:15], v[220:227], v40
    v_cvt_pk_bf16_f32 v68, v120, v121
    v_cvt_pk_bf16_f32 v69, v122, v123
    ds_write_b64 v73, v[68:69] offset:0
    s_waitcnt lgkmcnt(1)
    s_setprio 1
    v_mfma_f32_16x16x32_bf16 v[112:115], v[16:19], v[96:99], 0
    v_add_u32 v3, v43, v45
    v_add_u32 v74, v42, v44
    v_add_u32 v75, v74, v45
    ds_read_b64 v[200:201], v43 offset:0
    ds_read_b64 v[202:203], v43 offset:192
    v_smfmac_f32_16x16x64_bf16 v[112:115], v[20:23], v[80:87], v40
    ds_read_b64 v[204:205], v43 offset:3840
    ds_read_b64 v[206:207], v43 offset:4032
    v_smfmac_f32_16x16x64_bf16 v[112:115], v[24:27], v[88:95], v40
    ds_read_b64 v[208:209], v43 offset:7680
    ds_read_b64 v[210:211], v43 offset:7872
    v_cvt_pk_bf16_f32 v70, v124, v125
    v_cvt_pk_bf16_f32 v71, v126, v127
    ds_write_b64 v73, v[70:71] offset:3840
    v_mfma_f32_16x16x32_bf16 v[116:119], v[16:19], v[100:103], 0
    ds_read_b64 v[212:213], v43 offset:11520
    ds_read_b64 v[214:215], v43 offset:11712
    v_smfmac_f32_16x16x64_bf16 v[116:119], v[20:23], v[84:91], v40
    ds_read_b64 v[216:217], v3 offset:0
    ds_read_b64 v[218:219], v3 offset:192
    v_smfmac_f32_16x16x64_bf16 v[116:119], v[24:27], v[92:99], v40
    ds_read_b64 v[220:221], v3 offset:3840
    ds_read_b64 v[222:223], v3 offset:4032
    v_cvt_pk_bf16_f32 v64, v112, v113
    v_cvt_pk_bf16_f32 v65, v114, v115
    ds_write_b64 v74, v[64:65] offset:7680
    v_mfma_f32_16x16x32_bf16 v[120:123], v[16:19], v[104:107], 0
    ds_read_b64 v[224:225], v3 offset:7680
    v_smfmac_f32_16x16x64_bf16 v[120:123], v[20:23], v[88:95], v40
    ds_read_b64 v[226:227], v3 offset:7872
    v_smfmac_f32_16x16x64_bf16 v[120:123], v[24:27], v[96:103], v40
    ds_read_b64 v[228:229], v3 offset:11520
    v_cvt_pk_bf16_f32 v66, v116, v117
    v_cvt_pk_bf16_f32 v67, v118, v119
    ds_write_b64 v74, v[66:67] offset:11520
    v_mfma_f32_16x16x32_bf16 v[124:127], v[16:19], v[108:111], 0
    ds_read_b64 v[230:231], v3 offset:11712
    v_smfmac_f32_16x16x64_bf16 v[124:127], v[20:23], v[92:99], v40
    v_smfmac_f32_16x16x64_bf16 v[124:127], v[24:27], v[100:107], v40
    v_cvt_pk_bf16_f32 v68, v120, v121
    v_cvt_pk_bf16_f32 v69, v122, v123
    ds_write_b64 v75, v[68:69] offset:0
    s_waitcnt lgkmcnt(1)
    s_setprio 0
    v_mfma_f32_16x16x32_bf16 v[112:115], v[28:31], v[216:219], 0
    v_add_u32 v72, v43, v44
    v_add_u32 v73, v72, v45
    v_smfmac_f32_16x16x64_bf16 v[112:115], v[32:35], v[200:207], v40
    v_smfmac_f32_16x16x64_bf16 v[112:115], v[36:39], v[208:215], v40
    v_cvt_pk_bf16_f32 v70, v124, v125
    v_cvt_pk_bf16_f32 v71, v126, v127
    ds_write_b64 v75, v[70:71] offset:3840
    v_mfma_f32_16x16x32_bf16 v[116:119], v[28:31], v[220:223], 0
    v_smfmac_f32_16x16x64_bf16 v[116:119], v[32:35], v[204:211], v40
    v_smfmac_f32_16x16x64_bf16 v[116:119], v[36:39], v[212:219], v40
    s_nop 1
    v_cvt_pk_bf16_f32 v64, v112, v113
    v_cvt_pk_bf16_f32 v65, v114, v115
    ds_write_b64 v72, v[64:65] offset:7680
    v_mfma_f32_16x16x32_bf16 v[120:123], v[28:31], v[224:227], 0
    v_smfmac_f32_16x16x64_bf16 v[120:123], v[32:35], v[208:215], v40
    v_smfmac_f32_16x16x64_bf16 v[120:123], v[36:39], v[216:223], v40
    v_cvt_pk_bf16_f32 v66, v116, v117
    v_cvt_pk_bf16_f32 v67, v118, v119
    ds_write_b64 v72, v[66:67] offset:11520
    v_mfma_f32_16x16x32_bf16 v[124:127], v[28:31], v[228:231], 0
    v_smfmac_f32_16x16x64_bf16 v[124:127], v[32:35], v[212:219], v40
    v_smfmac_f32_16x16x64_bf16 v[124:127], v[36:39], v[220:227], v40
    s_nop 1
    v_cvt_pk_bf16_f32 v68, v120, v121
    v_cvt_pk_bf16_f32 v69, v122, v123
    ds_write_b64 v73, v[68:69] offset:0
    s_nop 2
    v_cvt_pk_bf16_f32 v70, v124, v125
    v_cvt_pk_bf16_f32 v71, v126, v127
    ds_write_b64 v73, v[70:71] offset:3840
    s_waitcnt lgkmcnt(0)
    s_barrier
    ds_read_b64 v[64:65], v47 offset:0
    ds_read_b64 v[66:67], v47 offset:8
    ds_read_b64 v[68:69], v47 offset:64
    ds_read_b64 v[70:71], v47 offset:72
    ds_read_b64 v[72:73], v47 offset:128
    ds_read_b64 v[74:75], v47 offset:136
    ds_read_b64 v[76:77], v48 offset:0
    ds_read_b64 v[78:79], v48 offset:8
    ds_read_b64 v[80:81], v48 offset:64
    ds_read_b64 v[82:83], v48 offset:72
    ds_read_b64 v[84:85], v48 offset:128
    ds_read_b64 v[86:87], v48 offset:136
    s_branch L_stats_s
L_fin_s:
    s_waitcnt lgkmcnt(0)
    v_mfma_f32_16x16x32_bf16 v[136:139], v[200:203], v[100:103], v[136:139]
    v_mfma_f32_16x16x32_bf16 v[140:143], v[204:207], v[100:103], v[140:143]
    v_mfma_f32_16x16x32_bf16 v[152:155], v[208:211], v[100:103], v[152:155]
    v_mfma_f32_16x16x32_bf16 v[156:159], v[212:215], v[100:103], v[156:159]
    v_mfma_f32_16x16x32_bf16 v[168:171], v[216:219], v[100:103], v[168:171]
    v_mfma_f32_16x16x32_bf16 v[172:175], v[220:223], v[100:103], v[172:175]
    s_add_u32 s23, s22, 393216
    s_mul_i32 s79, s24, 6656
    v_mbcnt_lo_u32_b32 v0, -1, 0
    v_mbcnt_hi_u32_b32 v0, -1, v0
    v_and_b32 v1, 7, v0
    v_bfe_u32 v2, v0, 3, 1
    v_lshl_add_u32 v1, v2, 4, v1
    v_mul_u32_u24 v1, 208, v1
    v_lshrrev_b32 v2, 4, v0
    v_lshl_add_u32 v1, v2, 4, v1
    v_add_u32 v1, s79, v1
    v_add_u32 v2, 0, v0
    v_mul_u32_u24 v3, 171, v2
    v_lshrrev_b32 v3, 11, v3
    v_add_u32 v2, v2, v3
    v_lshlrev_b32 v2, 4, v2
    v_add_u32 v64, s79, v2
    v_add_u32 v2, 64, v0
    v_mul_u32_u24 v3, 171, v2
    v_lshrrev_b32 v3, 11, v3
    v_add_u32 v2, v2, v3
    v_lshlrev_b32 v2, 4, v2
    v_add_u32 v65, s79, v2
    v_add_u32 v2, 128, v0
    v_mul_u32_u24 v3, 171, v2
    v_lshrrev_b32 v3, 11, v3
    v_add_u32 v2, v2, v3
    v_lshlrev_b32 v2, 4, v2
    v_add_u32 v66, s79, v2
    v_lshlrev_b32 v0, 4, v0
    v_add_u32 v0, s59, v0
    v_cvt_pk_bf16_f32 v232, v128, v129
    v_cvt_pk_bf16_f32 v233, v130, v131
    v_cvt_pk_bf16_f32 v234, v132, v133
    v_cvt_pk_bf16_f32 v235, v134, v135
    ds_write_b128 v1, v[232:235] offset:0
    v_cvt_pk_bf16_f32 v240, v144, v145
    v_cvt_pk_bf16_f32 v241, v146, v147
    v_cvt_pk_bf16_f32 v242, v148, v149
    v_cvt_pk_bf16_f32 v243, v150, v151
    ds_write_b128 v1, v[240:243] offset:64
    v_cvt_pk_bf16_f32 v248, v160, v161
    v_cvt_pk_bf16_f32 v249, v162, v163
    v_cvt_pk_bf16_f32 v250, v164, v165
    v_cvt_pk_bf16_f32 v251, v166, v167
    ds_write_b128 v1, v[248:251] offset:128
    v_cvt_pk_bf16_f32 v236, v136, v137
    v_cvt_pk_bf16_f32 v237, v138, v139
    v_cvt_pk_bf16_f32 v238, v140, v141
    v_cvt_pk_bf16_f32 v239, v142, v143
    ds_write_b128 v1, v[236:239] offset:1664
    v_cvt_pk_bf16_f32 v244, v152, v153
    v_cvt_pk_bf16_f32 v245, v154, v155
    v_cvt_pk_bf16_f32 v246, v156, v157
    v_cvt_pk_bf16_f32 v247, v158, v159
    ds_write_b128 v1, v[244:247] offset:1728
    v_cvt_pk_bf16_f32 v252, v168, v169
    v_cvt_pk_bf16_f32 v253, v170, v171
    v_cvt_pk_bf16_f32 v254, v172, v173
    v_cvt_pk_bf16_f32 v255, v174, v175
    ds_write_b128 v1, v[252:255] offset:1792
    s_waitcnt lgkmcnt(0)
    ds_read_b128 v[88:91], v64 offset:0
    ds_read_b128 v[92:95], v65 offset:0
    ds_read_b128 v[96:99], v66 offset:0
    ds_read_b128 v[100:103], v64 offset:3328
    ds_read_b128 v[104:107], v65 offset:3328
    ds_read_b128 v[108:111], v66 offset:3328
    s_waitcnt lgkmcnt(5)
    buffer_store_dwordx4 v[88:91], v0, s[8:11], s22 offen offset:0 sc0 sc1 nt
    s_waitcnt lgkmcnt(4)
    buffer_store_dwordx4 v[92:95], v0, s[8:11], s22 offen offset:1024 sc0 sc1 nt
    s_waitcnt lgkmcnt(3)
    buffer_store_dwordx4 v[96:99], v0, s[8:11], s22 offen offset:2048 sc0 sc1 nt
    s_waitcnt lgkmcnt(2)
    buffer_store_dwordx4 v[100:103], v0, s[8:11], s23 offen offset:0 sc0 sc1 nt
    s_waitcnt lgkmcnt(1)
    buffer_store_dwordx4 v[104:107], v0, s[8:11], s23 offen offset:1024 sc0 sc1 nt
    s_waitcnt lgkmcnt(0)
    buffer_store_dwordx4 v[108:111], v0, s[8:11], s23 offen offset:2048 sc0 sc1 nt
    s_endpgm
.section .rodata,"a"
.p2align 6
.amdhsa_kernel standalone__modern_conv_block_replknet__vision_kernel
  .amdhsa_next_free_vgpr 256
  .amdhsa_next_free_sgpr 96
  .amdhsa_accum_offset 256
  .amdhsa_group_segment_fixed_size 0
  .amdhsa_kernarg_size 64
  .amdhsa_user_sgpr_count 2
  .amdhsa_user_sgpr_kernarg_segment_ptr 1
  .amdhsa_system_sgpr_workgroup_id_x 1
.end_amdhsa_kernel
```
